```python
import torch

def _softmax(x, axis=-1):
    return torch.softmax(x, dim=axis)
def _gelu(x):
    return torch.nn.functional.gelu(x, approximate="tanh")
def _silu(x):
    return torch.nn.functional.silu(x)
def _sigmoid(x):
    return torch.sigmoid(x)
def _layernorm(x, axis=-1, eps=1e-5):
    m = x.mean(dim=axis, keepdim=True)
    v = x.var(dim=axis, keepdim=True, unbiased=False)
    return (x - m) / torch.sqrt(v + eps)
def _scatter_add(tgt, idx, src, axis=0):
    return tgt.clone().index_add_(axis, idx, src)
def _segment_sum(src, seg, n):
    out = torch.zeros((n,) + src.shape[1:], dtype=src.dtype)
    return out.index_add_(0, seg, src)
def _pad(x, pw):
    flat = tuple(v for pair in reversed(pw) for v in pair)
    return torch.nn.functional.pad(x, flat)

kernel_name = 'standalone__mha_block_cached__near_ridge'

def setup_inputs():

    _w = (lambda a: (lambda t: t.to(torch.bfloat16) if t.is_floating_point() else t)(torch.as_tensor(a)))
    B, Sq, D = 8, 224, 1024
    H, Sk, Dh = 32, 1024, 128
    return {
        "x": _w((lambda *s: torch.randn(*s, dtype=torch.bfloat16) * 0.8)(B, Sq, D)),
        "k_cache": _w((lambda *s: torch.randn(*s, dtype=torch.bfloat16) * 0.8)(B, H, Sk, Dh)),
        "v_cache": _w((lambda *s: torch.randn(*s, dtype=torch.bfloat16) * 0.05)(B, H, Sk, Dh)),
        "wq": _w((lambda *s: torch.randn(*s, dtype=torch.bfloat16) * 0.8)(D, H * Dh) * (D ** -0.5)),
        "wo": _w((lambda *s: torch.randn(*s, dtype=torch.bfloat16) * 0.05)(H * Dh, D) * ((H * Dh) ** -0.5)),
    }

def reference(x, k_cache, v_cache, wq, wo):
    B, Sq, D = x.shape
    H, Dh = 32, 128
    q = (lambda x, *d: x.permute(*d))((x @ wq).reshape(B, Sq, H, Dh), 0, 2, 1, 3)
    scores = torch.einsum("bhqd,bhkd->bhqk", q, k_cache) * (Dh ** -0.5)
    p = _softmax(scores, axis=-1)
    o = torch.einsum("bhqk,bhkd->bhqd", p, v_cache)
    return (lambda x, *d: x.permute(*d))(o, 0, 2, 1, 3).reshape(B, Sq, H * Dh) @ wo
```

```asm
; @launch grid=(256,1,1) block=(256,1,1) lds=163840
.amdgcn_target "amdgcn-amd-amdhsa--gfx950"
.text
.globl standalone__mha_block_cached__near_ridge_kernel
.p2align 8
.type standalone__mha_block_cached__near_ridge_kernel,@function
standalone__mha_block_cached__near_ridge_kernel:
  s_cmp_ge_u32 s2, 256
  s_cbranch_scc1 L_end
  s_load_dwordx8 s[4:11], s[0:1], 0
  s_load_dwordx8 s[12:19], s[0:1], 32
  s_getpc_b64 s[82:83]
L_pc:
  v_and_b32 v1, 63, v0
  v_lshrrev_b32 v2, 6, v0
  s_and_b32 s65, s2, 7
  s_lshr_b32 s66, s2, 3
  v_readfirstlane_b32 s48, v2
  v_min_u32 v0, 2, v1
  v_lshl_add_u32 v0, v0, 2, v2
  v_lshlrev_b32 v0, 5, v0
  v_add_lshl_u32 v0, v0, s66, 7
  v_min_u32 v2, L_end-L_pc-4, v0
  v_add_u32 v2, L_pc-L_pc, v2
  v_mov_b32 v3, s83
  v_add_co_u32 v2, vcc, s82, v2
  s_nop 1
  v_addc_co_u32 v3, vcc, 0, v3, vcc
  global_load_dword v253, v[2:3], off
  s_mov_b32 s64, 0
  s_and_b32 s49, s65, 1
  s_lshl_b32 s49, s49, 2
  s_and_b32 s61, s66, 3
  s_add_u32 s49, s49, s61
  s_lshr_b32 s50, s65, 1
  s_lshl_b32 s67, s50, 2
  s_add_u32 s67, s67, s61
  s_lshl_b32 s50, s50, 3
  s_lshr_b32 s68, s66, 2
  s_add_u32 s50, s50, s68
  s_and_b32 s51, s48, 1
  s_lshr_b32 s52, s48, 1
  s_lshl_b32 s56, s52, 15
  s_mul_i32 s65, s51, 7168
  s_add_u32 s56, s56, s65
  s_add_u32 s56, s56, 16384
  s_lshl_b32 s57, s48, 11
  s_add_u32 s57, s57, 131072
  s_lshl_b32 s58, s48, 15
  s_mov_b32 s22, 458752
  s_mov_b32 s23, 0x20000
  s_mov_b32 s27, 0x20000
  s_mul_i32 s70, s49, 458752
  s_lshl_b32 s71, s50, 8
  s_sub_u32 s26, 0x800000, s71
  v_lshrrev_b32 v2, 3, v1
  v_and_b32 v3, 7, v1
  v_and_b32 v4, 6, v2
  v_xor_b32 v4, v4, v3
  v_lshlrev_b32 v4, 4, v4
  v_lshl_add_u32 v240, v2, 11, v4
  s_mul_i32 s65, s48, 114688
  v_add_u32 v240, s65, v240
  v_add_u32 v241, 15360, v240
  v_add_u32 v242, 30720, v240
  v_add_u32 v243, 46080, v240
  v_add_u32 v244, 65536, v240
  v_add_u32 v245, 80896, v240
  v_add_u32 v246, 96256, v240
  v_and_b32 v4, 2, v2
  v_lshlrev_b32 v4, 1, v4
  v_xor_b32 v4, v4, v3
  v_lshlrev_b32 v4, 4, v4
  v_lshl_add_u32 v10, v2, 13, v4
  s_lshl_b32 s65, s51, 17
  s_lshl_b32 s61, s52, 7
  s_add_u32 s65, s65, s61
  v_add_u32 v10, s65, v10
  v_add_u32 v11, 64512, v10
  s_waitcnt lgkmcnt(0)
  s_add_u32 s24, s10, s71
  s_addc_u32 s25, s11, 0
  s_add_u32 s20, s4, s70
  s_addc_u32 s21, s5, 0
L_restart:
  s_mov_b32 s10, 0
  s_mov_b32 s11, 0
  s_xor_b32 s65, s49, s50
  s_and_b32 s65, s65, 0
  s_lshl_b32 s63, s65, 19
  s_lshl_b32 s69, s65, 7
  s_mov_b32 s54, s63
  s_mov_b32 s53, s69
  s_add_u32 m0, s57, 0
  s_nop 0
  buffer_load_dwordx4 v10, s[24:27], s54 offen offset:0  lds
  buffer_load_dwordx4 v11, s[24:27], s54 offen offset:1024  lds
  s_add_u32 m0, s56, 0
  s_add_u32 s11, s11, 262144
  s_xor_b32 s54, s11, s63
  buffer_load_dwordx4 v240, s[20:23], s53 offen offset:0  lds
  buffer_load_dwordx4 v241, s[20:23], s53 offen offset:1024  lds
  buffer_load_dwordx4 v242, s[20:23], s53 offen offset:2048  lds
  buffer_load_dwordx4 v243, s[20:23], s53 offen offset:3072  lds
  s_add_u32 m0, s56, 4096
  s_nop 0
  buffer_load_dwordx4 v244, s[20:23], s53 offen offset:0  lds
  buffer_load_dwordx4 v245, s[20:23], s53 offen offset:1024  lds
  buffer_load_dwordx4 v246, s[20:23], s53 offen offset:2048  lds
  s_add_u32 m0, s57, 8192
  s_add_u32 s10, s10, 128
  s_xor_b32 s53, s10, s69
  buffer_load_dwordx4 v10, s[24:27], s54 offen offset:0  lds
  buffer_load_dwordx4 v11, s[24:27], s54 offen offset:1024  lds
  s_add_u32 s11, s11, 262144
  s_xor_b32 s54, s11, s63
  v_mov_b32 v12, 0
  v_mov_b32 v13, 0
  v_mov_b32 v14, 0
  v_mov_b32 v15, 0
  s_lshl_b32 s65, s49, 5
  s_add_u32 s65, s65, s50
  s_lshl_b32 s65, s65, 18
  v_mfma_f32_32x32x16_bf16 v[128:143], v[12:15], v[12:15], 0
  s_add_u32 s28, s6, s65
  s_addc_u32 s29, s7, 0
  s_mov_b32 s30, 0x40000
  s_mov_b32 s31, 0x20000
  s_add_u32 s84, s8, s65
  s_addc_u32 s85, s9, 0
  s_mov_b32 s86, 0x40000
  v_mfma_f32_32x32x16_bf16 v[144:159], v[12:15], v[12:15], 0
  s_mov_b32 s87, 0x20000
  v_bfe_u32 v2, v1, 2, 2
  v_lshrrev_b32 v3, 4, v1
  v_lshlrev_b32 v3, 6, v3
  v_lshl_add_u32 v3, v2, 8, v3
  v_and_b32 v2, 3, v1
  v_lshl_add_u32 v3, v2, 4, v3
  v_mfma_f32_32x32x16_bf16 v[160:175], v[12:15], v[12:15], 0
  s_lshl_b32 s61, s51, 5
  v_xor_b32 v3, s61, v3
  s_lshl_b32 s61, s48, 11
  v_add_u32 v6, s61, v3
  v_xor_b32 v7, 48, v6
  v_xor_b32 v8, 0x80, v6
  v_xor_b32 v9, 0x80, v7
  v_mfma_f32_32x32x16_bf16 v[176:191], v[12:15], v[12:15], 0
  s_mul_i32 s65, s50, 14336
  s_lshl_b32 s61, s48, 12
  s_add_u32 s65, s65, s61
  v_and_b32 v36, 31, v1
  v_lshlrev_b32 v36, 7, v36
  v_add_u32 v36, s65, v36
  s_lshl_b32 s65, s49, 2
  v_mfma_f32_32x32x16_bf16 v[192:207], v[12:15], v[12:15], 0
  s_add_u32 s65, s65, s48
  s_lshl_b32 s65, s65, 18
  v_lshrrev_b32 v37, 1, v1
  v_lshlrev_b32 v37, 13, v37
  v_and_b32 v3, 1, v1
  v_lshl_add_u32 v37, v3, 7, v37
  v_add_u32 v37, s65, v37
  v_mfma_f32_32x32x16_bf16 v[208:223], v[12:15], v[12:15], 0
  v_lshlrev_b32 v5, 4, v1
  v_and_b32 v2, 15, v1
  v_lshrrev_b32 v3, 4, v1
  v_and_b32 v4, 6, v2
  v_xor_b32 v4, v4, v3
  v_lshlrev_b32 v4, 4, v4
  v_lshl_add_u32 v4, v2, 7, v4
  v_mfma_f32_32x32x16_bf16 v[224:239], v[12:15], v[12:15], 0
  s_lshl_b32 s65, s51, 15
  s_add_u32 s65, s65, 16384
  v_add_u32 v247, s65, v4
  v_xor_b32 v248, 64, v247
  v_add_u32 v249, 0x10000, v247
  v_add_u32 v250, 0x10000, v248
  v_bfe_u32 v2, v1, 2, 2
  v_mfma_f32_32x32x16_bf16 v[48:63], v[12:15], v[12:15], 0
  v_lshl_add_u32 v2, v3, 3, v2
  v_and_b32 v4, 2, v2
  v_lshlrev_b32 v4, 1, v4
  v_and_b32 v3, 3, v1
  v_xor_b32 v4, v4, v3
  v_lshlrev_b32 v4, 4, v4
  v_lshl_add_u32 v4, v2, 7, v4
  v_mfma_f32_32x32x16_bf16 v[64:79], v[12:15], v[12:15], 0
  s_lshl_b32 s65, s52, 12
  s_add_u32 s65, s65, 131072
  v_add_u32 v251, s65, v4
  v_xor_b32 v252, 64, v251
  s_mul_i32 s65, s49, 14
  s_mul_i32 s61, s51, 7
  s_add_u32 s65, s65, s61
  v_mfma_f32_32x32x16_bf16 v[80:95], v[12:15], v[12:15], 0
  s_lshl_b32 s65, s65, 7
  s_lshl_b32 s61, s50, 2
  s_add_u32 s65, s65, s61
  s_lshl_b32 s61, s52, 1
  s_add_u32 s65, s65, s61
  s_lshl_b32 s65, s65, 10
  s_add_u32 s32, s18, s65
  v_mfma_f32_32x32x16_bf16 v[96:111], v[12:15], v[12:15], 0
  s_addc_u32 s33, s19, 0
  s_mov_b32 s34, 788480
  s_mov_b32 s35, 0x20000
  s_mov_b32 s72, 0x3e0293ee
  s_mov_b32 s73, 0x3e0293ee
  s_and_b32 s0, s49, 4
  s_add_u32 s0, s0, s48
  v_mfma_f32_32x32x16_bf16 v[112:127], v[12:15], v[12:15], 0
  s_mul_i32 s65, s67, 917504
  s_lshl_b32 s61, s0, 14
  s_add_u32 s65, s65, s61
  s_add_u32 s36, s18, s65
  s_addc_u32 s37, s19, 0
  s_mov_b32 s38, 802816
  s_mov_b32 s39, 0x20000
  v_mfma_f32_32x32x16_bf16 a[112:127], v[12:15], v[12:15], 0
  s_lshl_b32 s65, s0, 20
  s_lshl_b32 s61, s68, 8
  s_add_u32 s65, s65, s61
  s_add_u32 s40, s12, s65
  s_addc_u32 s41, s13, 0
  s_sub_u32 s42, 0x100000, s61
  s_mov_b32 s43, 0x20000
  v_mfma_f32_32x32x16_bf16 a[128:143], v[12:15], v[12:15], 0
  s_mul_i32 s65, s67, 229376
  s_add_u32 s44, s14, s65
  s_addc_u32 s45, s15, 0
  s_mov_b32 s46, 229376
  s_mov_b32 s47, 0x20000
  s_xor_b32 s59, s58, 0x10000
  s_lshl_b32 s60, s48, 13
  v_mfma_f32_32x32x16_bf16 a[144:159], v[12:15], v[12:15], 0
  s_add_u32 s60, s60, 131072
  s_sub_u32 s70, s60, s58
  s_sub_u32 s71, s59, s60
  s_mov_b32 s74, 0
  s_mov_b32 s75, 131072
  s_mov_b32 s76, 262144
  s_mov_b32 s77, 393216
  v_mfma_f32_32x32x16_bf16 a[160:175], v[12:15], v[12:15], 0
  s_mov_b32 s78, 524288
  s_mov_b32 s79, 655360
  s_mov_b32 s80, 786432
  s_and_b32 s65, s49, 1
  s_lshl_b32 s65, s65, 6
  s_lshr_b32 s61, s49, 1
  s_lshl_b32 s61, s61, 3
  s_add_u32 s65, s65, s61
  s_lshr_b32 s61, s50, 2
  s_add_u32 s65, s65, s61
  s_lshl_b32 s65, s65, 7
  s_and_b32 s61, s50, 3
  s_lshl_b32 s61, s61, 2
  s_add_u32 s65, s65, s61
  s_add_u32 s65, s65, 0x1000000
  v_lshrrev_b32 v28, 1, v1
  v_lshlrev_b32 v28, 14, v28
  v_and_b32 v3, 1, v1
  v_lshl_add_u32 v28, v3, 12, v28
  v_add_u32 v28, s65, v28
  s_xor_b32 s65, s2, 1
  s_lshl_b32 s65, s65, 9
  s_add_u32 s65, s65, 0x1000010
  v_and_b32 v3, 3, v1
  v_lshlrev_b32 v3, 7, v3
  v_cmp_gt_u32 vcc, 16, v1
  v_add_u32 v3, s65, v3
  s_nop 0
  v_cndmask_b32 v28, v3, v28, vcc
  s_lshl_b32 s65, s2, 2
  s_add_u32 s65, s65, s48
  s_lshl_b32 s65, s65, 7
  s_add_u32 s65, s65, 0x1000000
  v_min_u32 v29, 5, v1
  v_lshlrev_b32 v29, 2, v29
  v_add_u32 v29, s65, v29
  s_mov_b64 exec, 64
  v_xor_b32 v29, 0x200, v29
  s_mov_b64 exec, -1
  v_bfe_u32 v2, v1, 2, 2
  v_sub_u32 v3, 0, v2
  v_lshrrev_b32 v4, 4, v1
  v_xor_b32 v3, v3, v4
  v_and_b32 v3, 3, v3
  v_lshlrev_b32 v3, 4, v3
  v_lshl_add_u32 v3, v2, 10, v3
  v_and_b32 v19, 3, v1
  v_lshlrev_b32 v19, 6, v19
  s_lshl_b32 s61, s52, 16
  v_add3_u32 v16, v19, v3, s61
  v_lshl_add_u32 v19, v4, 4, v19
  v_sub_u32 v3, 0, v4
  v_bfe_u32 v18, v1, 1, 1
  v_xor_b32 v3, v3, v18
  v_and_b32 v3, 3, v3
  v_lshlrev_b32 v3, 4, v3
  v_lshl_add_u32 v3, v4, 10, v3
  v_lshl_add_u32 v3, v2, 6, v3
  v_and_b32 v18, 1, v1
  v_lshl_add_u32 v3, v18, 3, v3
  s_add_u32 s61, s61, 32768
  v_add_u32 v17, s61, v3
  v_xor_b32 v18, 32, v17
  v_add_u32 v24, s58, v3
  v_xor_b32 v25, 32, v24
  v_lshlrev_b32 v3, 6, v4
  v_lshl_add_u32 v3, v2, 11, v3
  v_and_b32 v2, 3, v1
  v_lshl_add_u32 v3, v2, 4, v3
  s_lshl_b32 s65, s0, 5
  v_xor_b32 v20, s65, v3
  v_xor_b32 v21, 48, v20
  v_add_u32 v21, 7168, v21
  v_xor_b32 v22, 32, v20
  v_add_u32 v22, 14336, v22
  v_xor_b32 v23, 16, v20
  v_add_u32 v23, 21504, v23
  v_add_u32 v26, s57, v5
  s_lshl_b32 s65, s51, 11
  s_add_u32 s65, s65, 131072
  v_add_u32 v27, s65, v5
  s_lshl_b32 s65, s2, 2
  s_add_u32 s65, s65, s48
  s_lshl_b32 s65, s65, 13
  v_lshlrev_b32 v30, 7, v1
  v_add_u32 v30, s65, v30
  s_lshl_b32 s1, s67, 1
  s_xor_b32 s1, s1, s68
  s_and_b32 s1, s1, 7
  s_lshl_b32 s1, s1, 16
  v_min_u32 v32, L_epi-L_tr-4, v0
  v_add_u32 v32, L_tr-L_pc, v32
  v_mov_b32 v33, s83
  v_add_co_u32 v32, vcc, s82, v32
  s_nop 1
  v_addc_co_u32 v33, vcc, 0, v33, vcc
  s_lshl_b32 s65, s2, 15
  s_lshl_b32 s61, s48, 10
  s_add_u32 s65, s65, s61
  v_and_b32 v4, 7, v1
  v_lshlrev_b32 v4, 7, v4
  v_add_u32 v4, s65, v4
  s_mov_b32 s3, 0
  s_add_u32 m0, s57, 16384
  s_nop 0
  buffer_load_dwordx4 v10, s[24:27], s54 offen offset:0  lds
  buffer_load_dwordx4 v11, s[24:27], s54 offen offset:1024  lds
  s_add_u32 m0, s56, 65536
  s_add_u32 s11, s11, 262144
  s_xor_b32 s54, s11, s63
  buffer_load_dwordx4 v240, s[20:23], s53 offen offset:0  lds
  buffer_load_dwordx4 v241, s[20:23], s53 offen offset:1024  lds
  buffer_load_dwordx4 v242, s[20:23], s53 offen offset:2048  lds
  buffer_load_dwordx4 v243, s[20:23], s53 offen offset:3072  lds
  s_add_u32 m0, s56, 69632
  s_nop 0
  buffer_load_dwordx4 v244, s[20:23], s53 offen offset:0  lds
  buffer_load_dwordx4 v245, s[20:23], s53 offen offset:1024  lds
  buffer_load_dwordx4 v246, s[20:23], s53 offen offset:2048  lds
  s_add_u32 m0, s57, 24576
  s_add_u32 s10, s10, 128
  s_xor_b32 s53, s10, s69
  buffer_load_dwordx4 v10, s[24:27], s54 offen offset:0  lds
  buffer_load_dwordx4 v11, s[24:27], s54 offen offset:1024  lds
  s_add_u32 s11, s11, 262144
  s_xor_b32 s54, s11, s63
  buffer_load_dword v253, v36, s[20:23], 0 offen
  buffer_load_dword v253, v37, s[24:27], 0 offen
  global_load_dword v253, v4, s[12:13]
  s_waitcnt vmcnt(16)
  s_barrier
  ds_read_b64_tr_b16 a[224:225], v251 offset:0
  ds_read_b64_tr_b16 a[226:227], v251 offset:512
  ds_read_b64_tr_b16 a[228:229], v251 offset:8
  ds_read_b64_tr_b16 a[230:231], v251 offset:520
  ds_read_b64_tr_b16 a[232:233], v252 offset:0
  ds_read_b64_tr_b16 a[234:235], v252 offset:512
  ds_read_b64_tr_b16 a[236:237], v252 offset:8
  ds_read_b64_tr_b16 a[238:239], v252 offset:520
  ds_read_b128 a[0:3], v247 offset:0
  ds_read_b128 a[16:19], v247 offset:2048
  ds_read_b128 a[32:35], v247 offset:4096
  ds_read_b128 a[48:51], v247 offset:6144
  ds_read_b128 a[64:67], v247 offset:8192
  ds_read_b128 a[80:83], v247 offset:10240
  ds_read_b128 a[96:99], v247 offset:12288
  ds_read_b128 a[4:7], v248 offset:0
  ds_read_b128 a[20:23], v248 offset:2048
  ds_read_b128 a[36:39], v248 offset:4096
  ds_read_b128 a[52:55], v248 offset:6144
  ds_read_b128 a[68:71], v248 offset:8192
  ds_read_b128 a[84:87], v248 offset:10240
  ds_read_b128 a[100:103], v248 offset:12288
  s_mov_b32 s55, 7
  s_waitcnt vmcnt(14) lgkmcnt(0)
  s_barrier
.p2align 5
L_p1:
  v_mfma_f32_16x16x32_bf16 v[128:131], a[224:227], a[0:3], v[128:131]
  ds_read_b64_tr_b16 a[240:241], v251 offset:8192
  s_add_u32 m0, s57, 0
  v_mfma_f32_16x16x32_bf16 v[132:135], a[228:231], a[0:3], v[132:135]
  buffer_load_dwordx4 v10, s[24:27], s54 offen offset:0  lds
  ds_read_b64_tr_b16 a[242:243], v251 offset:8704
  v_mfma_f32_16x16x32_bf16 v[136:139], a[232:235], a[0:3], v[136:139]
  ds_read_b64_tr_b16 a[244:245], v251 offset:8200
  v_mfma_f32_16x16x32_bf16 v[140:143], a[236:239], a[0:3], v[140:143]
  ds_read_b64_tr_b16 a[246:247], v251 offset:8712
  v_mfma_f32_16x16x32_bf16 v[144:147], a[224:227], a[16:19], v[144:147]
  buffer_load_dwordx4 v11, s[24:27], s54 offen offset:1024  lds
  ds_read_b64_tr_b16 a[248:249], v252 offset:8192
  v_mfma_f32_16x16x32_bf16 v[148:151], a[228:231], a[16:19], v[148:151]
  ds_read_b64_tr_b16 a[250:251], v252 offset:8704
  s_add_u32 m0, s56, 0
  v_mfma_f32_16x16x32_bf16 v[152:155], a[232:235], a[16:19], v[152:155]
  ds_read_b64_tr_b16 a[252:253], v252 offset:8200
  s_add_u32 s11, s11, 262144
  v_mfma_f32_16x16x32_bf16 v[156:159], a[236:239], a[16:19], v[156:159]
  ds_read_b64_tr_b16 a[254:255], v252 offset:8712
  s_xor_b32 s54, s11, s63
  v_mfma_f32_16x16x32_bf16 v[160:163], a[224:227], a[32:35], v[160:163]
  buffer_load_dwordx4 v240, s[20:23], s53 offen offset:0  lds
  v_mfma_f32_16x16x32_bf16 v[164:167], a[228:231], a[32:35], v[164:167]
  v_mfma_f32_16x16x32_bf16 v[168:171], a[232:235], a[32:35], v[168:171]
  v_mfma_f32_16x16x32_bf16 v[172:175], a[236:239], a[32:35], v[172:175]
  v_mfma_f32_16x16x32_bf16 v[176:179], a[224:227], a[48:51], v[176:179]
  buffer_load_dwordx4 v241, s[20:23], s53 offen offset:1024  lds
  v_mfma_f32_16x16x32_bf16 v[180:183], a[228:231], a[48:51], v[180:183]
  v_mfma_f32_16x16x32_bf16 v[184:187], a[232:235], a[48:51], v[184:187]
  v_mfma_f32_16x16x32_bf16 v[188:191], a[236:239], a[48:51], v[188:191]
  buffer_load_dwordx4 v242, s[20:23], s53 offen offset:2048  lds
  v_mfma_f32_16x16x32_bf16 v[192:195], a[224:227], a[64:67], v[192:195]
  v_mfma_f32_16x16x32_bf16 v[196:199], a[228:231], a[64:67], v[196:199]
  v_mfma_f32_16x16x32_bf16 v[200:203], a[232:235], a[64:67], v[200:203]
  v_mfma_f32_16x16x32_bf16 v[204:207], a[236:239], a[64:67], v[204:207]
  buffer_load_dwordx4 v243, s[20:23], s53 offen offset:3072  lds
  s_add_u32 m0, s56, 4096
  v_mfma_f32_16x16x32_bf16 v[208:211], a[224:227], a[80:83], v[208:211]
  v_mfma_f32_16x16x32_bf16 v[212:215], a[228:231], a[80:83], v[212:215]
  v_mfma_f32_16x16x32_bf16 v[216:219], a[232:235], a[80:83], v[216:219]
  v_mfma_f32_16x16x32_bf16 v[220:223], a[236:239], a[80:83], v[220:223]
  buffer_load_dwordx4 v244, s[20:23], s53 offen offset:0  lds
  v_mfma_f32_16x16x32_bf16 v[224:227], a[224:227], a[96:99], v[224:227]
  v_mfma_f32_16x16x32_bf16 v[228:231], a[228:231], a[96:99], v[228:231]
  v_mfma_f32_16x16x32_bf16 v[232:235], a[232:235], a[96:99], v[232:235]
  s_waitcnt vmcnt(12) lgkmcnt(0)
  v_mfma_f32_16x16x32_bf16 v[236:239], a[236:239], a[96:99], v[236:239]
  s_barrier
  v_mfma_f32_16x16x32_bf16 v[128:131], a[240:243], a[4:7], v[128:131]
  ds_read_b64_tr_b16 a[224:225], v251 offset:16384
  v_mfma_f32_16x16x32_bf16 v[132:135], a[244:247], a[4:7], v[132:135]
  buffer_load_dwordx4 v245, s[20:23], s53 offen offset:1024  lds
  ds_read_b64_tr_b16 a[226:227], v251 offset:16896
  v_mfma_f32_16x16x32_bf16 v[136:139], a[248:251], a[4:7], v[136:139]
  ds_read_b64_tr_b16 a[228:229], v251 offset:16392
  v_mfma_f32_16x16x32_bf16 v[140:143], a[252:255], a[4:7], v[140:143]
  ds_read_b64_tr_b16 a[230:231], v251 offset:16904
  v_mfma_f32_16x16x32_bf16 v[144:147], a[240:243], a[20:23], v[144:147]
  ds_read_b64_tr_b16 a[232:233], v252 offset:16384
  v_mfma_f32_16x16x32_bf16 v[148:151], a[244:247], a[20:23], v[148:151]
  ds_read_b64_tr_b16 a[234:235], v252 offset:16896
  v_mfma_f32_16x16x32_bf16 v[152:155], a[248:251], a[20:23], v[152:155]
  ds_read_b64_tr_b16 a[236:237], v252 offset:16392
  v_mfma_f32_16x16x32_bf16 v[156:159], a[252:255], a[20:23], v[156:159]
  buffer_load_dwordx4 v246, s[20:23], s53 offen offset:2048  lds
  ds_read_b64_tr_b16 a[238:239], v252 offset:16904
  v_mfma_f32_16x16x32_bf16 v[160:163], a[240:243], a[36:39], v[160:163]
  ds_read_b128 a[8:11], v249 offset:0
  s_add_u32 m0, s57, 8192
  v_mfma_f32_16x16x32_bf16 v[164:167], a[244:247], a[36:39], v[164:167]
  ds_read_b128 a[24:27], v249 offset:2048
  s_add_u32 s10, s10, 128
  v_mfma_f32_16x16x32_bf16 v[168:171], a[248:251], a[36:39], v[168:171]
  ds_read_b128 a[40:43], v249 offset:4096
  s_xor_b32 s53, s10, s69
  v_mfma_f32_16x16x32_bf16 v[172:175], a[252:255], a[36:39], v[172:175]
  ds_read_b128 a[56:59], v249 offset:6144
  v_mfma_f32_16x16x32_bf16 v[176:179], a[240:243], a[52:55], v[176:179]
  ds_read_b128 a[72:75], v249 offset:8192
  v_mfma_f32_16x16x32_bf16 v[180:183], a[244:247], a[52:55], v[180:183]
  ds_read_b128 a[88:91], v249 offset:10240
  v_mfma_f32_16x16x32_bf16 v[184:187], a[248:251], a[52:55], v[184:187]
  buffer_load_dwordx4 v10, s[24:27], s54 offen offset:0  lds
  ds_read_b128 a[104:107], v249 offset:12288
  v_mfma_f32_16x16x32_bf16 v[188:191], a[252:255], a[52:55], v[188:191]
  ds_read_b128 a[12:15], v250 offset:0
  v_mfma_f32_16x16x32_bf16 v[192:195], a[240:243], a[68:71], v[192:195]
  ds_read_b128 a[28:31], v250 offset:2048
  v_mfma_f32_16x16x32_bf16 v[196:199], a[244:247], a[68:71], v[196:199]
  ds_read_b128 a[44:47], v250 offset:4096
  v_mfma_f32_16x16x32_bf16 v[200:203], a[248:251], a[68:71], v[200:203]
  ds_read_b128 a[60:63], v250 offset:6144
  v_mfma_f32_16x16x32_bf16 v[204:207], a[252:255], a[68:71], v[204:207]
  ds_read_b128 a[76:79], v250 offset:8192
  v_mfma_f32_16x16x32_bf16 v[208:211], a[240:243], a[84:87], v[208:211]
  buffer_load_dwordx4 v11, s[24:27], s54 offen offset:1024  lds
  ds_read_b128 a[92:95], v250 offset:10240
  v_mfma_f32_16x16x32_bf16 v[212:215], a[244:247], a[84:87], v[212:215]
  ds_read_b128 a[108:111], v250 offset:12288
  s_add_u32 s11, s11, 262144
  v_mfma_f32_16x16x32_bf16 v[216:219], a[248:251], a[84:87], v[216:219]
  s_xor_b32 s54, s11, s63
  v_mfma_f32_16x16x32_bf16 v[220:223], a[252:255], a[84:87], v[220:223]
  v_mfma_f32_16x16x32_bf16 v[224:227], a[240:243], a[100:103], v[224:227]
  v_mfma_f32_16x16x32_bf16 v[228:231], a[244:247], a[100:103], v[228:231]
  v_mfma_f32_16x16x32_bf16 v[232:235], a[248:251], a[100:103], v[232:235]
  s_waitcnt vmcnt(14) lgkmcnt(0)
  v_mfma_f32_16x16x32_bf16 v[236:239], a[252:255], a[100:103], v[236:239]
  s_barrier
  v_mfma_f32_16x16x32_bf16 v[128:131], a[224:227], a[8:11], v[128:131]
  ds_read_b64_tr_b16 a[240:241], v251 offset:24576
  s_add_u32 m0, s57, 16384
  v_mfma_f32_16x16x32_bf16 v[132:135], a[228:231], a[8:11], v[132:135]
  buffer_load_dwordx4 v10, s[24:27], s54 offen offset:0  lds
  ds_read_b64_tr_b16 a[242:243], v251 offset:25088
  v_mfma_f32_16x16x32_bf16 v[136:139], a[232:235], a[8:11], v[136:139]
  ds_read_b64_tr_b16 a[244:245], v251 offset:24584
  v_mfma_f32_16x16x32_bf16 v[140:143], a[236:239], a[8:11], v[140:143]
  ds_read_b64_tr_b16 a[246:247], v251 offset:25096
  v_mfma_f32_16x16x32_bf16 v[144:147], a[224:227], a[24:27], v[144:147]
  buffer_load_dwordx4 v11, s[24:27], s54 offen offset:1024  lds
  ds_read_b64_tr_b16 a[248:249], v252 offset:24576
  v_mfma_f32_16x16x32_bf16 v[148:151], a[228:231], a[24:27], v[148:151]
  ds_read_b64_tr_b16 a[250:251], v252 offset:25088
  s_add_u32 m0, s56, 65536
  v_mfma_f32_16x16x32_bf16 v[152:155], a[232:235], a[24:27], v[152:155]
  ds_read_b64_tr_b16 a[252:253], v252 offset:24584
  s_add_u32 s11, s11, 262144
  v_mfma_f32_16x16x32_bf16 v[156:159], a[236:239], a[24:27], v[156:159]
  ds_read_b64_tr_b16 a[254:255], v252 offset:25096
  s_xor_b32 s54, s11, s63
  v_mfma_f32_16x16x32_bf16 v[160:163], a[224:227], a[40:43], v[160:163]
  buffer_load_dwordx4 v240, s[20:23], s53 offen offset:0  lds
  s_cmp_lt_u32 s3, 4
  v_mfma_f32_16x16x32_bf16 v[164:167], a[228:231], a[40:43], v[164:167]
  s_cselect_b32 s4, s28, s84
  s_cselect_b32 s5, s29, s85
  v_mfma_f32_16x16x32_bf16 v[168:171], a[232:235], a[40:43], v[168:171]
  s_and_b32 s65, s3, 1
  s_and_b32 s61, s3, 2
  v_mfma_f32_16x16x32_bf16 v[172:175], a[236:239], a[40:43], v[172:175]
  s_lshl_b32 s61, s61, 12
  s_lshl_b32 s66, s65, 16
  v_mfma_f32_16x16x32_bf16 v[176:179], a[224:227], a[56:59], v[176:179]
  buffer_load_dwordx4 v241, s[20:23], s53 offen offset:1024  lds
  s_add_u32 s66, s66, s61
  v_mfma_f32_16x16x32_bf16 v[180:183], a[228:231], a[56:59], v[180:183]
  s_mul_i32 s65, s65, 8192
  s_mul_i32 s61, s61, 2
  v_mfma_f32_16x16x32_bf16 v[184:187], a[232:235], a[56:59], v[184:187]
  s_add_u32 s65, s65, s61
  v_add_u32 v2, s65, v6
  v_mfma_f32_16x16x32_bf16 v[188:191], a[236:239], a[56:59], v[188:191]
  buffer_load_dwordx4 v242, s[20:23], s53 offen offset:2048  lds
  v_add_u32 v3, s65, v7
  v_mfma_f32_16x16x32_bf16 v[192:195], a[224:227], a[72:75], v[192:195]
  s_and_b32 s61, s3, 4
  s_lshl_b32 s61, s61, 13
  v_mfma_f32_16x16x32_bf16 v[196:199], a[228:231], a[72:75], v[196:199]
  s_add_u32 s66, s66, s61
  s_and_b32 s65, s3, 5
  v_mfma_f32_16x16x32_bf16 v[200:203], a[232:235], a[72:75], v[200:203]
  s_cmp_eq_u32 s65, 5
  s_cselect_b32 s65, 128, 0
  v_mfma_f32_16x16x32_bf16 v[204:207], a[236:239], a[72:75], v[204:207]
  buffer_load_dwordx4 v243, s[20:23], s53 offen offset:3072  lds
  s_add_u32 m0, s56, 69632
  v_mfma_f32_16x16x32_bf16 v[208:211], a[224:227], a[88:91], v[208:211]
  v_xor_b32 v2, s65, v2
  v_xor_b32 v3, s65, v3
  v_mfma_f32_16x16x32_bf16 v[212:215], a[228:231], a[88:91], v[212:215]
  s_add_u32 s66, s66, s57
  s_add_u32 s3, s3, 1
  v_mfma_f32_16x16x32_bf16 v[216:219], a[232:235], a[88:91], v[216:219]
  v_add_u32 v4, 4096, v4
  v_mfma_f32_16x16x32_bf16 v[220:223], a[236:239], a[88:91], v[220:223]
  buffer_load_dwordx4 v244, s[20:23], s53 offen offset:0  lds
  v_mfma_f32_16x16x32_bf16 v[224:227], a[224:227], a[104:107], v[224:227]
  v_mfma_f32_16x16x32_bf16 v[228:231], a[228:231], a[104:107], v[228:231]
  v_mfma_f32_16x16x32_bf16 v[232:235], a[232:235], a[104:107], v[232:235]
  s_waitcnt vmcnt(9) lgkmcnt(0)
  v_mfma_f32_16x16x32_bf16 v[236:239], a[236:239], a[104:107], v[236:239]
  s_barrier
  v_mfma_f32_16x16x32_bf16 v[128:131], a[240:243], a[12:15], v[128:131]
  ds_read_b64_tr_b16 a[224:225], v251 offset:0
  v_mfma_f32_16x16x32_bf16 v[132:135], a[244:247], a[12:15], v[132:135]
  buffer_load_dwordx4 v245, s[20:23], s53 offen offset:1024  lds
  ds_read_b64_tr_b16 a[226:227], v251 offset:512
  v_mfma_f32_16x16x32_bf16 v[136:139], a[248:251], a[12:15], v[136:139]
  ds_read_b64_tr_b16 a[228:229], v251 offset:8
  v_mfma_f32_16x16x32_bf16 v[140:143], a[252:255], a[12:15], v[140:143]
  ds_read_b64_tr_b16 a[230:231], v251 offset:520
  v_mfma_f32_16x16x32_bf16 v[144:147], a[240:243], a[28:31], v[144:147]
  ds_read_b64_tr_b16 a[232:233], v252 offset:0
  v_mfma_f32_16x16x32_bf16 v[148:151], a[244:247], a[28:31], v[148:151]
  ds_read_b64_tr_b16 a[234:235], v252 offset:512
  v_mfma_f32_16x16x32_bf16 v[152:155], a[248:251], a[28:31], v[152:155]
  ds_read_b64_tr_b16 a[236:237], v252 offset:8
  v_mfma_f32_16x16x32_bf16 v[156:159], a[252:255], a[28:31], v[156:159]
  buffer_load_dwordx4 v246, s[20:23], s53 offen offset:2048  lds
  ds_read_b64_tr_b16 a[238:239], v252 offset:520
  v_mfma_f32_16x16x32_bf16 v[160:163], a[240:243], a[44:47], v[160:163]
  ds_read_b128 a[0:3], v247 offset:0
  s_add_u32 m0, s57, 24576
  v_mfma_f32_16x16x32_bf16 v[164:167], a[244:247], a[44:47], v[164:167]
  ds_read_b128 a[16:19], v247 offset:2048
  s_add_u32 s10, s10, 128
  v_mfma_f32_16x16x32_bf16 v[168:171], a[248:251], a[44:47], v[168:171]
  ds_read_b128 a[32:35], v247 offset:4096
  s_xor_b32 s53, s10, s69
  v_mfma_f32_16x16x32_bf16 v[172:175], a[252:255], a[44:47], v[172:175]
  ds_read_b128 a[48:51], v247 offset:6144
  v_mfma_f32_16x16x32_bf16 v[176:179], a[240:243], a[60:63], v[176:179]
  ds_read_b128 a[64:67], v247 offset:8192
  v_mfma_f32_16x16x32_bf16 v[180:183], a[244:247], a[60:63], v[180:183]
  ds_read_b128 a[80:83], v247 offset:10240
  v_mfma_f32_16x16x32_bf16 v[184:187], a[248:251], a[60:63], v[184:187]
  buffer_load_dwordx4 v10, s[24:27], s54 offen offset:0  lds
  ds_read_b128 a[96:99], v247 offset:12288
  v_mfma_f32_16x16x32_bf16 v[188:191], a[252:255], a[60:63], v[188:191]
  ds_read_b128 a[4:7], v248 offset:0
  v_mfma_f32_16x16x32_bf16 v[192:195], a[240:243], a[76:79], v[192:195]
  ds_read_b128 a[20:23], v248 offset:2048
  v_mfma_f32_16x16x32_bf16 v[196:199], a[244:247], a[76:79], v[196:199]
  ds_read_b128 a[36:39], v248 offset:4096
  v_mfma_f32_16x16x32_bf16 v[200:203], a[248:251], a[76:79], v[200:203]
  ds_read_b128 a[52:55], v248 offset:6144
  v_mfma_f32_16x16x32_bf16 v[204:207], a[252:255], a[76:79], v[204:207]
  ds_read_b128 a[68:71], v248 offset:8192
  v_mfma_f32_16x16x32_bf16 v[208:211], a[240:243], a[92:95], v[208:211]
  buffer_load_dwordx4 v11, s[24:27], s54 offen offset:1024  lds
  ds_read_b128 a[84:87], v248 offset:10240
  v_mfma_f32_16x16x32_bf16 v[212:215], a[244:247], a[92:95], v[212:215]
  ds_read_b128 a[100:103], v248 offset:12288
  s_add_u32 s11, s11, 262144
  v_mfma_f32_16x16x32_bf16 v[216:219], a[248:251], a[92:95], v[216:219]
  s_xor_b32 s54, s11, s63
  s_sub_u32 m0, s66, 0x20000
  v_mfma_f32_16x16x32_bf16 v[220:223], a[252:255], a[92:95], v[220:223]
  global_load_lds_dwordx4 v2, s[4:5] offset:0 nt
  v_mfma_f32_16x16x32_bf16 v[224:227], a[240:243], a[108:111], v[224:227]
  global_load_lds_dwordx4 v3, s[4:5] offset:1024 nt
  global_load_dword v253, v4, s[12:13]
  v_mfma_f32_16x16x32_bf16 v[228:231], a[244:247], a[108:111], v[228:231]
  s_sub_u32 s55, s55, 1
  v_mfma_f32_16x16x32_bf16 v[232:235], a[248:251], a[108:111], v[232:235]
  s_waitcnt vmcnt(14) lgkmcnt(0)
  s_cmp_lg_u32 s55, 0
  v_mfma_f32_16x16x32_bf16 v[236:239], a[252:255], a[108:111], v[236:239]
  s_barrier
  s_cbranch_scc1 L_p1
  v_mfma_f32_16x16x32_bf16 v[128:131], a[224:227], a[0:3], v[128:131]
  ds_read_b64_tr_b16 a[240:241], v251 offset:8192
  s_cmp_lt_u32 s3, 4
  v_mfma_f32_16x16x32_bf16 v[132:135], a[228:231], a[0:3], v[132:135]
  ds_read_b64_tr_b16 a[242:243], v251 offset:8704
  s_cselect_b32 s4, s28, s84
  v_mfma_f32_16x16x32_bf16 v[136:139], a[232:235], a[0:3], v[136:139]
  ds_read_b64_tr_b16 a[244:245], v251 offset:8200
  s_cselect_b32 s5, s29, s85
  v_mfma_f32_16x16x32_bf16 v[140:143], a[236:239], a[0:3], v[140:143]
  ds_read_b64_tr_b16 a[246:247], v251 offset:8712
  s_and_b32 s65, s3, 1
  v_mfma_f32_16x16x32_bf16 v[144:147], a[224:227], a[16:19], v[144:147]
  ds_read_b64_tr_b16 a[248:249], v252 offset:8192
  s_and_b32 s61, s3, 2
  v_mfma_f32_16x16x32_bf16 v[148:151], a[228:231], a[16:19], v[148:151]
  ds_read_b64_tr_b16 a[250:251], v252 offset:8704
  s_lshl_b32 s61, s61, 12
  v_mfma_f32_16x16x32_bf16 v[152:155], a[232:235], a[16:19], v[152:155]
  ds_read_b64_tr_b16 a[252:253], v252 offset:8200
  s_lshl_b32 s66, s65, 16
  v_mfma_f32_16x16x32_bf16 v[156:159], a[236:239], a[16:19], v[156:159]
  ds_read_b64_tr_b16 a[254:255], v252 offset:8712
  s_add_u32 s66, s66, s61
  v_mfma_f32_16x16x32_bf16 v[160:163], a[224:227], a[32:35], v[160:163]
  s_mul_i32 s65, s65, 8192
  s_mul_i32 s61, s61, 2
  v_mfma_f32_16x16x32_bf16 v[164:167], a[228:231], a[32:35], v[164:167]
  s_add_u32 s65, s65, s61
  v_add_u32 v2, s65, v6
  v_mfma_f32_16x16x32_bf16 v[168:171], a[232:235], a[32:35], v[168:171]
  v_add_u32 v3, s65, v7
  s_and_b32 s61, s3, 4
  v_mfma_f32_16x16x32_bf16 v[172:175], a[236:239], a[32:35], v[172:175]
  s_lshl_b32 s61, s61, 13
  s_add_u32 s66, s66, s61
  v_mfma_f32_16x16x32_bf16 v[176:179], a[224:227], a[48:51], v[176:179]
  s_and_b32 s65, s3, 5
  s_cmp_eq_u32 s65, 5
  v_mfma_f32_16x16x32_bf16 v[180:183], a[228:231], a[48:51], v[180:183]
  s_cselect_b32 s65, 128, 0
  v_xor_b32 v2, s65, v2
  v_mfma_f32_16x16x32_bf16 v[184:187], a[232:235], a[48:51], v[184:187]
  v_xor_b32 v3, s65, v3
  s_add_u32 s66, s66, s57
  v_mfma_f32_16x16x32_bf16 v[188:191], a[236:239], a[48:51], v[188:191]
  s_add_u32 s3, s3, 1
  s_sub_u32 m0, s66, 0x20000
  v_mfma_f32_16x16x32_bf16 v[192:195], a[224:227], a[64:67], v[192:195]
  global_load_lds_dwordx4 v2, s[4:5] offset:0 nt
  v_mfma_f32_16x16x32_bf16 v[196:199], a[228:231], a[64:67], v[196:199]
  global_load_lds_dwordx4 v3, s[4:5] offset:1024 nt
  v_mfma_f32_16x16x32_bf16 v[200:203], a[232:235], a[64:67], v[200:203]
  v_mov_b32 v240, v16
  v_mov_b32 v241, v17
  v_mfma_f32_16x16x32_bf16 v[204:207], a[236:239], a[64:67], v[204:207]
  v_mov_b32 v242, v18
  v_mov_b32 v243, v19
  v_mfma_f32_16x16x32_bf16 v[208:211], a[224:227], a[80:83], v[208:211]
  v_mov_b32 v244, v20
  v_mov_b32 v245, v21
  v_mfma_f32_16x16x32_bf16 v[212:215], a[228:231], a[80:83], v[212:215]
  v_mov_b32 v246, v22
  v_mov_b32 v247, v23
  v_mfma_f32_16x16x32_bf16 v[216:219], a[232:235], a[80:83], v[216:219]
  v_mov_b32 v10, v24
  v_mov_b32 v11, v25
  v_mfma_f32_16x16x32_bf16 v[220:223], a[236:239], a[80:83], v[220:223]
  v_mov_b32 v2, v26
  v_mov_b32 v3, v27
  v_mfma_f32_16x16x32_bf16 v[224:227], a[224:227], a[96:99], v[224:227]
  s_mov_b32 s63, 32768
  s_mov_b32 s62, 40960
  v_mfma_f32_16x16x32_bf16 v[228:231], a[228:231], a[96:99], v[228:231]
  v_mfma_f32_16x16x32_bf16 v[232:235], a[232:235], a[96:99], v[232:235]
  s_waitcnt vmcnt(5) lgkmcnt(0)
  v_mfma_f32_16x16x32_bf16 v[236:239], a[236:239], a[96:99], v[236:239]
  s_barrier
L_tr:
  s_cmp_lg_u32 s64, 0
  s_cbranch_scc1 L_nofl
  global_load_dword v255, v29, s[18:19] sc1
  s_cmp_lg_u32 s48, 0
  s_cbranch_scc1 L_nofl
  global_load_dword v254, v28, s[18:19] sc1
L_nofl:
  v_mfma_f32_16x16x32_bf16 v[128:131], a[240:243], a[4:7], v[128:131]
  ds_read_b64_tr_b16 a[192:193], v251 offset:16384
  ds_read_b64_tr_b16 a[194:195], v251 offset:16896
  v_mfma_f32_16x16x32_bf16 v[132:135], a[244:247], a[4:7], v[132:135]
  ds_read_b64_tr_b16 a[196:197], v251 offset:16392
  ds_read_b64_tr_b16 a[198:199], v251 offset:16904
  v_mfma_f32_16x16x32_bf16 v[136:139], a[248:251], a[4:7], v[136:139]
  ds_read_b64_tr_b16 a[200:201], v252 offset:16384
  v_mfma_f32_16x16x32_bf16 v[140:143], a[252:255], a[4:7], v[140:143]
  ds_read_b64_tr_b16 a[202:203], v252 offset:16896
  ds_read_b64_tr_b16 a[204:205], v252 offset:16392
  v_mfma_f32_16x16x32_bf16 v[144:147], a[240:243], a[20:23], v[144:147]
  ds_read_b64_tr_b16 a[206:207], v252 offset:16904
  ds_read_b128 a[8:11], v249 offset:0
  v_mfma_f32_16x16x32_bf16 v[148:151], a[244:247], a[20:23], v[148:151]
  ds_read_b64_tr_b16 a[208:209], v251 offset:24576
  v_mfma_f32_16x16x32_bf16 v[152:155], a[248:251], a[20:23], v[152:155]
  ds_read_b64_tr_b16 a[210:211], v251 offset:25088
  ds_read_b64_tr_b16 a[212:213], v251 offset:24584
  v_mfma_f32_16x16x32_bf16 v[156:159], a[252:255], a[20:23], v[156:159]
  ds_read_b64_tr_b16 a[214:215], v251 offset:25096
  ds_read_b64_tr_b16 a[216:217], v252 offset:24576
  v_mfma_f32_16x16x32_bf16 v[160:163], a[240:243], a[36:39], v[160:163]
  ds_read_b64_tr_b16 a[218:219], v252 offset:25088
  v_mfma_f32_16x16x32_bf16 v[164:167], a[244:247], a[36:39], v[164:167]
  ds_read_b64_tr_b16 a[220:221], v252 offset:24584
  ds_read_b64_tr_b16 a[222:223], v252 offset:25096
  v_mfma_f32_16x16x32_bf16 v[168:171], a[248:251], a[36:39], v[168:171]
  ds_read_b128 a[12:15], v250 offset:0
  ds_read_b128 a[24:27], v249 offset:2048
  v_mfma_f32_16x16x32_bf16 v[172:175], a[252:255], a[36:39], v[172:175]
  ds_read_b128 a[28:31], v250 offset:2048
  v_mfma_f32_16x16x32_bf16 v[176:179], a[240:243], a[52:55], v[176:179]
  ds_read_b128 a[40:43], v249 offset:4096
  ds_read_b128 a[44:47], v250 offset:4096
  v_mfma_f32_16x16x32_bf16 v[180:183], a[244:247], a[52:55], v[180:183]
  ds_read_b128 a[56:59], v249 offset:6144
  ds_read_b128 a[60:63], v250 offset:6144
  v_mfma_f32_16x16x32_bf16 v[184:187], a[248:251], a[52:55], v[184:187]
  ds_read_b128 a[72:75], v249 offset:8192
  v_mfma_f32_16x16x32_bf16 v[188:191], a[252:255], a[52:55], v[188:191]
  ds_read_b128 a[76:79], v250 offset:8192
  ds_read_b128 a[88:91], v249 offset:10240
  v_mfma_f32_16x16x32_bf16 v[192:195], a[240:243], a[68:71], v[192:195]
  ds_read_b128 a[92:95], v250 offset:10240
  ds_read_b128 a[104:107], v249 offset:12288
  v_mfma_f32_16x16x32_bf16 v[196:199], a[244:247], a[68:71], v[196:199]
  ds_read_b128 a[108:111], v250 offset:12288
  v_mfma_f32_16x16x32_bf16 v[200:203], a[248:251], a[68:71], v[200:203]
  global_load_dword v253, v[32:33], off
  s_waitcnt lgkmcnt(0)
  v_mfma_f32_16x16x32_bf16 v[204:207], a[252:255], a[68:71], v[204:207]
  s_barrier
  v_mfma_f32_16x16x32_bf16 v[128:131], a[192:195], a[8:11], v[128:131]
  ds_read_b128 a[176:179], v243 offset:0
  v_mfma_f32_16x16x32_bf16 v[128:131], a[208:211], a[12:15], v[128:131]
  ds_read_b128 a[180:183], v243 offset:256
  v_mfma_f32_16x16x32_bf16 v[132:135], a[196:199], a[8:11], v[132:135]
  v_mfma_f32_16x16x32_bf16 v[132:135], a[212:215], a[12:15], v[132:135]
  ds_read_b128 a[184:187], v243 offset:512
  v_mfma_f32_16x16x32_bf16 v[136:139], a[200:203], a[8:11], v[136:139]
  v_mfma_f32_16x16x32_bf16 v[136:139], a[216:219], a[12:15], v[136:139]
  ds_read_b128 a[188:191], v243 offset:768
  v_mfma_f32_16x16x32_bf16 v[140:143], a[204:207], a[8:11], v[140:143]
  v_mfma_f32_16x16x32_bf16 v[140:143], a[220:223], a[12:15], v[140:143]
  s_add_u32 m0, s57, 4294852608
  v_mfma_f32_16x16x32_bf16 v[208:211], a[240:243], a[84:87], v[208:211]
  s_nop 0
  v_mfma_f32_16x16x32_bf16 v[212:215], a[244:247], a[84:87], v[212:215]
  v_mfma_f32_16x16x32_bf16 v[216:219], a[248:251], a[84:87], v[216:219]
  buffer_load_dwordx4 v6, s[28:31], s63 offen offset:0 nt lds
  v_mfma_f32_16x16x32_bf16 v[220:223], a[252:255], a[84:87], v[220:223]
  v_mfma_f32_32x32x16_bf16 v[16:31], v[12:15], v[12:15], 0
  buffer_load_dwordx4 v7, s[28:31], s63 offen offset:1024 nt lds
  v_mfma_f32_32x32x16_bf16 v[32:47], v[12:15], v[12:15], 0
  v_mfma_f32_16x16x32_bf16 v[144:147], a[192:195], a[24:27], v[144:147]
  v_mul_f32 v128, s72, v128
  v_mul_f32 v129, s72, v129
  v_cvt_pk_bf16_f32 v128, v128, v129
  v_mfma_f32_16x16x32_bf16 v[144:147], a[208:211], a[28:31], v[144:147]
  v_mul_f32 v130, s72, v130
  v_mul_f32 v131, s72, v131
  v_cvt_pk_bf16_f32 v129, v130, v131
  v_mfma_f32_16x16x32_bf16 v[148:151], a[196:199], a[24:27], v[148:151]
  v_mul_f32 v132, s72, v132
  v_mul_f32 v133, s72, v133
  v_mfma_f32_16x16x32_bf16 v[148:151], a[212:215], a[28:31], v[148:151]
  v_cvt_pk_bf16_f32 v130, v132, v133
  v_mul_f32 v134, s72, v134
  v_mul_f32 v135, s72, v135
  v_mfma_f32_16x16x32_bf16 v[152:155], a[200:203], a[24:27], v[152:155]
  v_cvt_pk_bf16_f32 v131, v134, v135
  s_waitcnt lgkmcnt(0)
  v_mfma_f32_16x16x32_bf16 v[152:155], a[216:219], a[28:31], v[152:155]
  ds_write_b128 v2, v[128:131] offset:0
  v_mul_f32 v136, s72, v136
  v_mul_f32 v137, s72, v137
  v_mfma_f32_16x16x32_bf16 v[156:159], a[204:207], a[24:27], v[156:159]
  v_cvt_pk_bf16_f32 v136, v136, v137
  v_mul_f32 v138, s72, v138
  v_mul_f32 v139, s72, v139
  v_mfma_f32_16x16x32_bf16 v[156:159], a[220:223], a[28:31], v[156:159]
  v_cvt_pk_bf16_f32 v137, v138, v139
  v_mul_f32 v140, s72, v140
  v_mfma_f32_16x16x32_bf16 v[224:227], a[240:243], a[100:103], v[224:227]
  v_mul_f32 v141, s72, v141
  v_cvt_pk_bf16_f32 v138, v140, v141
  v_mul_f32 v142, s72, v142
  v_mfma_f32_16x16x32_bf16 v[228:231], a[244:247], a[100:103], v[228:231]
  v_mul_f32 v143, s72, v143
  v_cvt_pk_bf16_f32 v139, v142, v143
  v_mfma_f32_16x16x32_bf16 v[232:235], a[248:251], a[100:103], v[232:235]
  ds_write_b128 v2, v[136:139] offset:1024
  s_add_u32 m0, s57, 4294918144
  s_nop 0
  v_mfma_f32_16x16x32_bf16 v[236:239], a[252:255], a[100:103], v[236:239]
  buffer_load_dwordx4 v6, s[28:31], s62 offen offset:0 nt lds
  buffer_load_dwordx4 v7, s[28:31], s62 offen offset:1024 nt lds
  v_mfma_f32_16x16x32_bf16 v[160:163], a[192:195], a[40:43], v[160:163]
  s_waitcnt lgkmcnt(0)
  s_barrier
  ds_read_b128 a[0:3], v3 offset:0
  ds_read_b128 a[4:7], v3 offset:1024
  v_mfma_f32_16x16x32_bf16 v[160:163], a[208:211], a[44:47], v[160:163]
  ds_read_b128 a[8:11], v3 offset:4096
  ds_read_b128 a[12:15], v3 offset:5120
  v_mul_f32 v144, s72, v144
  v_mfma_f32_16x16x32_bf16 v[164:167], a[196:199], a[40:43], v[164:167]
  v_mul_f32 v145, s72, v145
  v_cvt_pk_bf16_f32 v144, v144, v145
  v_mul_f32 v146, s72, v146
  v_mfma_f32_16x16x32_bf16 v[164:167], a[212:215], a[44:47], v[164:167]
  v_mul_f32 v147, s72, v147
  v_cvt_pk_bf16_f32 v145, v146, v147
  v_mul_f32 v148, s72, v148
  v_mfma_f32_16x16x32_bf16 v[168:171], a[200:203], a[40:43], v[168:171]
  v_mul_f32 v149, s72, v149
  v_cvt_pk_bf16_f32 v146, v148, v149
  v_mul_f32 v150, s72, v150
  v_mfma_f32_16x16x32_bf16 v[168:171], a[216:219], a[44:47], v[168:171]
  v_mul_f32 v151, s72, v151
  v_cvt_pk_bf16_f32 v147, v150, v151
  s_waitcnt lgkmcnt(0)
  v_mfma_f32_16x16x32_bf16 v[172:175], a[204:207], a[40:43], v[172:175]
  ds_write_b128 v2, v[144:147] offset:8192
  v_mul_f32 v152, s72, v152
  v_mul_f32 v153, s72, v153
  v_mfma_f32_16x16x32_bf16 v[172:175], a[220:223], a[44:47], v[172:175]
  v_cvt_pk_bf16_f32 v152, v152, v153
  v_mul_f32 v154, s72, v154
  v_mul_f32 v155, s72, v155
  v_mfma_f32_16x16x32_bf16 v[128:131], a[176:179], a[0:3], 0
  v_cvt_pk_bf16_f32 v153, v154, v155
  v_mul_f32 v156, s72, v156
  v_mul_f32 v157, s72, v157
  v_mfma_f32_16x16x32_bf16 v[128:131], a[180:183], a[4:7], v[128:131]
  v_cvt_pk_bf16_f32 v154, v156, v157
  v_mul_f32 v158, s72, v158
  v_mul_f32 v159, s72, v159
  v_mfma_f32_16x16x32_bf16 v[128:131], a[184:187], a[8:11], v[128:131]
  v_cvt_pk_bf16_f32 v155, v158, v159
  v_mfma_f32_16x16x32_bf16 v[128:131], a[188:191], a[12:15], v[128:131]
  ds_write_b128 v2, v[152:155] offset:9216
  s_add_u32 m0, s57, 4294885376
  s_nop 0
  buffer_load_dwordx4 v6, s[84:87], s63 offen offset:0 nt lds
  buffer_load_dwordx4 v7, s[84:87], s63 offen offset:1024 nt lds
  v_mfma_f32_16x16x32_bf16 v[176:179], a[192:195], a[56:59], v[176:179]
  s_waitcnt lgkmcnt(0)
  s_barrier
  ds_read_b128 a[16:19], v3 offset:8192
  ds_read_b128 a[20:23], v3 offset:9216
  ds_read_b128 a[24:27], v3 offset:12288
  v_mfma_f32_16x16x32_bf16 v[176:179], a[208:211], a[60:63], v[176:179]
  ds_read_b128 a[28:31], v3 offset:13312
  ds_read_b128 a[224:227], v240 offset:0
  ds_read_b128 a[228:231], v240 offset:256
  ds_read_b128 a[232:235], v240 offset:512
  v_mfma_f32_16x16x32_bf16 v[180:183], a[196:199], a[56:59], v[180:183]
  ds_read_b128 a[236:239], v240 offset:768
  v_mul_f32 v160, s72, v160
  v_mul_f32 v161, s72, v161
  v_cvt_pk_bf16_f32 v160, v160, v161
  v_mfma_f32_16x16x32_bf16 v[180:183], a[212:215], a[60:63], v[180:183]
  v_mul_f32 v162, s72, v162
  v_mul_f32 v163, s72, v163
  v_cvt_pk_bf16_f32 v161, v162, v163
  v_mul_f32 v164, s72, v164
  v_mfma_f32_16x16x32_bf16 v[184:187], a[200:203], a[56:59], v[184:187]
  v_mul_f32 v165, s72, v165
  v_cvt_pk_bf16_f32 v162, v164, v165
  v_mul_f32 v166, s72, v166
  v_mul_f32 v167, s72, v167
  v_mfma_f32_16x16x32_bf16 v[184:187], a[216:219], a[60:63], v[184:187]
  v_cvt_pk_bf16_f32 v163, v166, v167
  s_waitcnt lgkmcnt(0)
  v_mfma_f32_16x16x32_bf16 v[188:191], a[204:207], a[56:59], v[188:191]
  ds_write_b128 v2, v[160:163] offset:16384
  v_mul_f32 v168, s72, v168
  v_mul_f32 v169, s72, v169
  v_cvt_pk_bf16_f32 v168, v168, v169
  v_mul_f32 v170, s72, v170
  v_mul_f32 v171, s72, v171
  v_mfma_f32_16x16x32_bf16 v[188:191], a[220:223], a[60:63], v[188:191]
  v_cvt_pk_bf16_f32 v169, v170, v171
  v_mul_f32 v172, s72, v172
  v_mul_f32 v173, s72, v173
  v_cvt_pk_bf16_f32 v170, v172, v173
  v_mfma_f32_16x16x32_bf16 v[132:135], a[176:179], a[16:19], 0
  v_mul_f32 v174, s72, v174
  v_mul_f32 v175, s72, v175
  v_cvt_pk_bf16_f32 v171, v174, v175
  v_mfma_f32_16x16x32_bf16 v[132:135], a[180:183], a[20:23], v[132:135]
  ds_write_b128 v2, v[168:171] offset:17408
  v_max3_f32 v128, v128, v129, v130
  v_max_f32 v128, v128, v131
  v_sub_f32 v129, 0, v128
  v_sub_f32 v130, 0, v128
  v_mfma_f32_16x16x32_bf16 v[132:135], a[184:187], a[24:27], v[132:135]
  v_sub_f32 v131, 0, v128
  v_sub_f32 v128, 0, v128
  s_add_u32 m0, s57, 4294950912
  s_nop 0
  v_mfma_f32_16x16x32_bf16 v[132:135], a[188:191], a[28:31], v[132:135]
  buffer_load_dwordx4 v8, s[84:87], s62 offen offset:0 nt lds
  buffer_load_dwordx4 v9, s[84:87], s62 offen offset:1024 nt lds
  s_add_u32 s63, s63, 16384
  s_add_u32 s62, s62, 16384
  v_mfma_f32_16x16x32_bf16 v[192:195], a[192:195], a[72:75], v[192:195]
  s_waitcnt lgkmcnt(0)
  s_barrier
  ds_read_b128 a[32:35], v3 offset:16384
  ds_read_b128 a[36:39], v3 offset:17408
  v_mfma_f32_16x16x32_bf16 v[192:195], a[208:211], a[76:79], v[192:195]
  ds_read_b128 a[40:43], v3 offset:20480
  ds_read_b128 a[44:47], v3 offset:21504
  ds_read_b128 a[240:243], v240 offset:4096
  ds_read_b128 a[244:247], v240 offset:4352
  v_mfma_f32_16x16x32_bf16 v[196:199], a[196:199], a[72:75], v[196:199]
  ds_read_b128 a[248:251], v240 offset:4608
  ds_read_b128 a[252:255], v240 offset:4864
  v_mul_f32 v176, s72, v176
  v_mul_f32 v177, s72, v177
  v_mfma_f32_16x16x32_bf16 v[196:199], a[212:215], a[76:79], v[196:199]
  v_cvt_pk_bf16_f32 v176, v176, v177
  v_mul_f32 v178, s72, v178
  v_mul_f32 v179, s72, v179
  v_cvt_pk_bf16_f32 v177, v178, v179
  v_mfma_f32_16x16x32_bf16 v[200:203], a[200:203], a[72:75], v[200:203]
  v_mul_f32 v180, s72, v180
  v_mul_f32 v181, s72, v181
  v_cvt_pk_bf16_f32 v178, v180, v181
  v_mul_f32 v182, s72, v182
  v_mfma_f32_16x16x32_bf16 v[200:203], a[216:219], a[76:79], v[200:203]
  v_mul_f32 v183, s72, v183
  v_cvt_pk_bf16_f32 v179, v182, v183
  s_waitcnt lgkmcnt(0)
  v_mfma_f32_16x16x32_bf16 v[204:207], a[204:207], a[72:75], v[204:207]
  ds_write_b128 v2, v[176:179] offset:24576
  v_mul_f32 v184, s72, v184
  v_mul_f32 v185, s72, v185
  v_cvt_pk_bf16_f32 v184, v184, v185
  v_mul_f32 v186, s72, v186
  v_mfma_f32_16x16x32_bf16 v[204:207], a[220:223], a[76:79], v[204:207]
  v_mul_f32 v187, s72, v187
  v_cvt_pk_bf16_f32 v185, v186, v187
  v_mul_f32 v188, s72, v188
  v_mul_f32 v189, s72, v189
  v_mfma_f32_16x16x32_bf16 v[136:139], a[176:179], a[32:35], 0
  v_cvt_pk_bf16_f32 v186, v188, v189
  v_mul_f32 v190, s72, v190
  v_mul_f32 v191, s72, v191
  v_cvt_pk_bf16_f32 v187, v190, v191
  v_mfma_f32_16x16x32_bf16 v[136:139], a[180:183], a[36:39], v[136:139]
  ds_write_b128 v2, v[184:187] offset:25600
  v_max3_f32 v132, v132, v133, v134
  v_max_f32 v132, v132, v135
  v_sub_f32 v133, 0, v132
  v_mfma_f32_16x16x32_bf16 v[136:139], a[184:187], a[40:43], v[136:139]
  v_sub_f32 v134, 0, v132
  v_sub_f32 v135, 0, v132
  v_sub_f32 v132, 0, v132
  s_add_u32 m0, s57, 4294860800
  v_mfma_f32_16x16x32_bf16 v[136:139], a[188:191], a[44:47], v[136:139]
  s_nop 0
  buffer_load_dwordx4 v6, s[28:31], s63 offen offset:0 nt lds
  buffer_load_dwordx4 v7, s[28:31], s63 offen offset:1024 nt lds
  v_mfma_f32_16x16x32_bf16 v[208:211], a[192:195], a[88:91], v[208:211]
  s_waitcnt lgkmcnt(0)
  s_barrier
  ds_read_b128 a[48:51], v3 offset:24576
  ds_read_b128 a[52:55], v3 offset:25600
  v_mfma_f32_16x16x32_bf16 v[208:211], a[208:211], a[92:95], v[208:211]
  ds_read_b128 a[56:59], v3 offset:28672
  ds_read_b128 a[60:63], v3 offset:29696
  v_mul_f32 v192, s72, v192
  v_mul_f32 v193, s72, v193
  v_mfma_f32_16x16x32_bf16 v[212:215], a[196:199], a[88:91], v[212:215]
  v_cvt_pk_bf16_f32 v192, v192, v193
  v_mul_f32 v194, s72, v194
  v_mul_f32 v195, s72, v195
  v_mfma_f32_16x16x32_bf16 v[212:215], a[212:215], a[92:95], v[212:215]
  v_cvt_pk_bf16_f32 v193, v194, v195
  v_mul_f32 v196, s72, v196
  v_mul_f32 v197, s72, v197
  v_cvt_pk_bf16_f32 v194, v196, v197
  v_mfma_f32_16x16x32_bf16 v[216:219], a[200:203], a[88:91], v[216:219]
  v_mul_f32 v198, s72, v198
  v_mul_f32 v199, s72, v199
  v_cvt_pk_bf16_f32 v195, v198, v199
  v_mfma_f32_16x16x32_bf16 v[216:219], a[216:219], a[92:95], v[216:219]
  s_waitcnt lgkmcnt(0)
  ds_write_b128 v2, v[192:195] offset:0
  v_mul_f32 v200, s72, v200
  v_mul_f32 v201, s72, v201
  v_mfma_f32_16x16x32_bf16 v[220:223], a[204:207], a[88:91], v[220:223]
  v_cvt_pk_bf16_f32 v200, v200, v201
  v_mul_f32 v202, s72, v202
  v_mul_f32 v203, s72, v203
  v_cvt_pk_bf16_f32 v201, v202, v203
  v_mfma_f32_16x16x32_bf16 v[220:223], a[220:223], a[92:95], v[220:223]
  v_mul_f32 v204, s72, v204
  v_mul_f32 v205, s72, v205
  v_cvt_pk_bf16_f32 v202, v204, v205
  v_mfma_f32_16x16x32_bf16 v[140:143], a[176:179], a[48:51], 0
  v_mul_f32 v206, s72, v206
  v_mul_f32 v207, s72, v207
  v_cvt_pk_bf16_f32 v203, v206, v207
  v_mfma_f32_16x16x32_bf16 v[140:143], a[180:183], a[52:55], v[140:143]
  ds_write_b128 v2, v[200:203] offset:1024
  v_max3_f32 v136, v136, v137, v138
  v_max_f32 v136, v136, v139
  v_sub_f32 v137, 0, v136
  v_mfma_f32_16x16x32_bf16 v[140:143], a[184:187], a[56:59], v[140:143]
  v_sub_f32 v138, 0, v136
  v_sub_f32 v139, 0, v136
  v_sub_f32 v136, 0, v136
  s_add_u32 m0, s57, 4294926336
  v_mfma_f32_16x16x32_bf16 v[140:143], a[188:191], a[60:63], v[140:143]
  s_nop 0
  buffer_load_dwordx4 v6, s[28:31], s62 offen offset:0 nt lds
  buffer_load_dwordx4 v7, s[28:31], s62 offen offset:1024 nt lds
  v_mfma_f32_16x16x32_bf16 v[224:227], a[192:195], a[104:107], v[224:227]
  s_waitcnt lgkmcnt(0)
  s_barrier
  ds_read_b128 a[64:67], v3 offset:0
  ds_read_b128 a[68:71], v3 offset:1024
  v_mfma_f32_16x16x32_bf16 v[224:227], a[208:211], a[108:111], v[224:227]
  ds_read_b128 a[72:75], v3 offset:4096
  ds_read_b128 a[76:79], v3 offset:5120
  v_mul_f32 v208, s72, v208
  v_mul_f32 v209, s72, v209
  v_mfma_f32_16x16x32_bf16 v[228:231], a[196:199], a[104:107], v[228:231]
  v_cvt_pk_bf16_f32 v208, v208, v209
  v_mul_f32 v210, s72, v210
  v_mul_f32 v211, s72, v211
  v_mfma_f32_16x16x32_bf16 v[228:231], a[212:215], a[108:111], v[228:231]
  v_cvt_pk_bf16_f32 v209, v210, v211
  v_mul_f32 v212, s72, v212
  v_mul_f32 v213, s72, v213
  v_cvt_pk_bf16_f32 v210, v212, v213
  v_mfma_f32_16x16x32_bf16 v[232:235], a[200:203], a[104:107], v[232:235]
  v_mul_f32 v214, s72, v214
  v_mul_f32 v215, s72, v215
  v_cvt_pk_bf16_f32 v211, v214, v215
  v_mfma_f32_16x16x32_bf16 v[232:235], a[216:219], a[108:111], v[232:235]
  s_waitcnt lgkmcnt(0)
  ds_write_b128 v2, v[208:211] offset:8192
  v_mul_f32 v216, s72, v216
  v_mul_f32 v217, s72, v217
  v_mfma_f32_16x16x32_bf16 v[236:239], a[204:207], a[104:107], v[236:239]
  v_cvt_pk_bf16_f32 v216, v216, v217
  v_mul_f32 v218, s72, v218
  v_mul_f32 v219, s72, v219
  v_cvt_pk_bf16_f32 v217, v218, v219
  v_mfma_f32_16x16x32_bf16 v[236:239], a[220:223], a[108:111], v[236:239]
  v_mul_f32 v220, s72, v220
  v_mul_f32 v221, s72, v221
  v_cvt_pk_bf16_f32 v218, v220, v221
  v_mfma_f32_16x16x32_bf16 v[144:147], a[176:179], a[64:67], 0
  v_mul_f32 v222, s72, v222
  v_mul_f32 v223, s72, v223
  v_cvt_pk_bf16_f32 v219, v222, v223
  v_mfma_f32_16x16x32_bf16 v[144:147], a[180:183], a[68:71], v[144:147]
  ds_write_b128 v2, v[216:219] offset:9216
  v_max3_f32 v140, v140, v141, v142
  v_max_f32 v140, v140, v143
  v_sub_f32 v141, 0, v140
  v_mfma_f32_16x16x32_bf16 v[144:147], a[184:187], a[72:75], v[144:147]
  v_sub_f32 v142, 0, v140
  v_sub_f32 v143, 0, v140
  v_sub_f32 v140, 0, v140
  s_add_u32 m0, s57, 4294893568
  v_mfma_f32_16x16x32_bf16 v[144:147], a[188:191], a[76:79], v[144:147]
  s_nop 0
  buffer_load_dwordx4 v6, s[84:87], s63 offen offset:0 nt lds
  buffer_load_dwordx4 v7, s[84:87], s63 offen offset:1024 nt lds
  v_mfma_f32_16x16x32_bf16 v[156:159], a[224:227], a[0:3], v[128:131]
  s_waitcnt lgkmcnt(0)
  s_barrier
  ds_read_b128 a[80:83], v3 offset:8192
  ds_read_b128 a[84:87], v3 offset:9216
  ds_read_b128 a[88:91], v3 offset:12288
  v_mfma_f32_16x16x32_bf16 v[156:159], a[228:231], a[4:7], v[156:159]
  ds_read_b128 a[92:95], v3 offset:13312
  v_mul_f32 v224, s72, v224
  v_mul_f32 v225, s72, v225
  v_cvt_pk_bf16_f32 v224, v224, v225
  v_mfma_f32_16x16x32_bf16 v[156:159], a[232:235], a[8:11], v[156:159]
  v_mul_f32 v226, s72, v226
  v_mul_f32 v227, s72, v227
  v_cvt_pk_bf16_f32 v225, v226, v227
  v_mul_f32 v228, s72, v228
  v_mfma_f32_16x16x32_bf16 v[156:159], a[236:239], a[12:15], v[156:159]
  v_mul_f32 v229, s72, v229
  v_cvt_pk_bf16_f32 v226, v228, v229
  v_mul_f32 v230, s72, v230
  v_mul_f32 v231, s72, v231
  v_mfma_f32_16x16x32_bf16 v[160:163], a[240:243], a[0:3], v[128:131]
  v_cvt_pk_bf16_f32 v227, v230, v231
  s_waitcnt lgkmcnt(0)
  v_mfma_f32_16x16x32_bf16 v[160:163], a[244:247], a[4:7], v[160:163]
  ds_write_b128 v2, v[224:227] offset:16384
  v_mul_f32 v232, s72, v232
  v_mul_f32 v233, s72, v233
  v_cvt_pk_bf16_f32 v232, v232, v233
  v_mul_f32 v234, s72, v234
  v_mul_f32 v235, s72, v235
  v_mfma_f32_16x16x32_bf16 v[160:163], a[248:251], a[8:11], v[160:163]
  v_cvt_pk_bf16_f32 v233, v234, v235
  v_mul_f32 v236, s72, v236
  v_mul_f32 v237, s72, v237
  v_cvt_pk_bf16_f32 v234, v236, v237
  v_mul_f32 v238, s72, v238
  v_mfma_f32_16x16x32_bf16 v[160:163], a[252:255], a[12:15], v[160:163]
  v_mul_f32 v239, s72, v239
  v_cvt_pk_bf16_f32 v235, v238, v239
  v_mfma_f32_16x16x32_bf16 v[148:151], a[176:179], a[80:83], 0
  ds_write_b128 v2, v[232:235] offset:17408
  v_max3_f32 v144, v144, v145, v146
  v_max_f32 v144, v144, v147
  v_sub_f32 v145, 0, v144
  v_sub_f32 v146, 0, v144
  v_sub_f32 v147, 0, v144
  v_mfma_f32_16x16x32_bf16 v[148:151], a[180:183], a[84:87], v[148:151]
  v_sub_f32 v144, 0, v144
  v_mov_b32 v220, 0
  v_mov_b32 v221, 0
  v_mov_b32 v222, 0
  v_mfma_f32_16x16x32_bf16 v[148:151], a[184:187], a[88:91], v[148:151]
  v_mov_b32 v223, 0
  s_mov_b32 s55, 3
  s_add_u32 m0, s57, 4294959104
  s_nop 0
  v_mfma_f32_16x16x32_bf16 v[148:151], a[188:191], a[92:95], v[148:151]
  buffer_load_dwordx4 v8, s[84:87], s62 offen offset:0 nt lds
  buffer_load_dwordx4 v9, s[84:87], s62 offen offset:1024 nt lds
  s_add_u32 s63, s63, 16384
  s_add_u32 s62, s62, 16384
  s_cmp_lg_u32 s64, 0
  s_cbranch_scc1 L_maxpass
  v_mfma_f32_16x16x32_bf16 v[164:167], a[224:227], a[16:19], v[132:135]
  s_waitcnt lgkmcnt(0)
  s_barrier
  ds_read_b128 a[96:99], v3 offset:16384
  ds_read_b128 a[100:103], v3 offset:17408
  v_exp_f32 v172, v156
  v_mfma_f32_16x16x32_bf16 v[164:167], a[228:231], a[20:23], v[164:167]
  ds_read_b128 a[104:107], v3 offset:20480
  ds_read_b128 a[108:111], v3 offset:21504
  v_add_f32 v220, v220, v172
  v_mfma_f32_16x16x32_bf16 v[164:167], a[232:235], a[24:27], v[164:167]
  v_exp_f32 v173, v157
  v_mfma_f32_16x16x32_bf16 v[164:167], a[236:239], a[28:31], v[164:167]
  v_add_f32 v220, v220, v173
  v_cvt_pk_bf16_f32 v180, v172, v173
  v_max3_f32 v148, v148, v149, v150
  v_mfma_f32_16x16x32_bf16 v[168:171], a[240:243], a[16:19], v[132:135]
  v_exp_f32 v174, v158
  v_mfma_f32_16x16x32_bf16 v[168:171], a[244:247], a[20:23], v[168:171]
  v_add_f32 v220, v220, v174
  v_max_f32 v148, v148, v151
  v_mfma_f32_16x16x32_bf16 v[168:171], a[248:251], a[24:27], v[168:171]
  v_exp_f32 v175, v159
  v_mfma_f32_16x16x32_bf16 v[168:171], a[252:255], a[28:31], v[168:171]
  s_waitcnt lgkmcnt(0)
  v_add_f32 v220, v220, v175
  v_cvt_pk_bf16_f32 v181, v174, v175
  v_sub_f32 v149, 0, v148
  v_mfma_f32_16x16x32_bf16 v[152:155], a[176:179], a[96:99], 0
  ds_read_b64_tr_b16 v[188:189], v241 offset:0
  ds_read_b64_tr_b16 v[190:191], v241 offset:4096
  v_exp_f32 v176, v160
  v_mfma_f32_16x16x32_bf16 v[152:155], a[180:183], a[100:103], v[152:155]
  ds_read_b64_tr_b16 v[192:193], v242 offset:0
  ds_read_b64_tr_b16 v[194:195], v242 offset:4096
  v_add_f32 v220, v220, v176
  v_sub_f32 v150, 0, v148
  v_mfma_f32_16x16x32_bf16 v[152:155], a[184:187], a[104:107], v[152:155]
  ds_read_b64_tr_b16 v[196:197], v241 offset:256
  ds_read_b64_tr_b16 v[198:199], v241 offset:4352
  v_exp_f32 v177, v161
  v_mfma_f32_16x16x32_bf16 v[152:155], a[188:191], a[108:111], v[152:155]
  ds_read_b64_tr_b16 v[200:201], v242 offset:256
  ds_read_b64_tr_b16 v[202:203], v242 offset:4352
  v_add_f32 v220, v220, v177
  v_cvt_pk_bf16_f32 v182, v176, v177
  v_sub_f32 v151, 0, v148
  v_mfma_f32_32x32x16_bf16 a[192:207], v[12:15], v[12:15], 0
  ds_read_b64_tr_b16 v[204:205], v241 offset:512
  ds_read_b64_tr_b16 v[206:207], v241 offset:4608
  ds_read_b64_tr_b16 v[208:209], v242 offset:512
  ds_read_b64_tr_b16 v[210:211], v242 offset:4608
  v_exp_f32 v178, v162
  s_nop 0
  v_add_f32 v220, v220, v178
  v_sub_f32 v148, 0, v148
  v_mfma_f32_32x32x16_bf16 a[208:223], v[12:15], v[12:15], 0
  ds_read_b64_tr_b16 v[212:213], v241 offset:768
  ds_read_b64_tr_b16 v[214:215], v241 offset:4864
  ds_read_b64_tr_b16 v[216:217], v242 offset:768
  ds_read_b64_tr_b16 v[218:219], v242 offset:4864
  v_exp_f32 v179, v163
  s_nop 0
  v_add_f32 v220, v220, v179
  v_cvt_pk_bf16_f32 v183, v178, v179
  v_mfma_f32_16x16x32_bf16 v[156:159], a[224:227], a[32:35], v[136:139]
  v_exp_f32 v228, v164
  v_mfma_f32_16x16x32_bf16 v[156:159], a[228:231], a[36:39], v[156:159]
  v_max3_f32 v152, v152, v153, v154
  v_mov_b32 v226, 0
  v_mfma_f32_16x16x32_bf16 v[156:159], a[232:235], a[40:43], v[156:159]
  v_exp_f32 v229, v165
  v_mfma_f32_16x16x32_bf16 v[156:159], a[236:239], a[44:47], v[156:159]
  v_cvt_pk_bf16_f32 v184, v228, v229
  v_max_f32 v152, v152, v155
  v_mfma_f32_16x16x32_bf16 v[160:163], a[240:243], a[32:35], v[136:139]
  v_exp_f32 v230, v166
  v_mfma_f32_16x16x32_bf16 v[160:163], a[244:247], a[36:39], v[160:163]
  s_waitcnt lgkmcnt(0)
  v_sub_f32 v153, 0, v152
  v_mfma_f32_16x16x32_bf16 v[160:163], a[248:251], a[40:43], v[160:163]
  v_exp_f32 v231, v167
  v_mfma_f32_16x16x32_bf16 v[160:163], a[252:255], a[44:47], v[160:163]
  v_cvt_pk_bf16_f32 v185, v230, v231
  v_sub_f32 v154, 0, v152
  v_mfma_f32_16x16x32_bf16 v[16:19], v[188:191], v[180:183], v[16:19]
  v_exp_f32 v232, v168
  v_mfma_f32_16x16x32_bf16 v[20:23], v[192:195], v[180:183], v[20:23]
  v_sub_f32 v155, 0, v152
  v_mov_b32 v224, 0
  v_mfma_f32_16x16x32_bf16 v[24:27], v[196:199], v[180:183], v[24:27]
  v_exp_f32 v233, v169
  v_mfma_f32_16x16x32_bf16 v[28:31], v[200:203], v[180:183], v[28:31]
  v_cvt_pk_bf16_f32 v186, v232, v233
  v_sub_f32 v152, 0, v152
  v_mfma_f32_16x16x32_bf16 a[112:115], v[204:207], v[180:183], a[112:115]
  v_exp_f32 v234, v170
  v_mfma_f32_16x16x32_bf16 a[116:119], v[208:211], v[180:183], a[116:119]
  v_mov_b32 v225, 0
  v_add_f32 v221, v221, v228
  v_mfma_f32_16x16x32_bf16 a[120:123], v[212:215], v[180:183], a[120:123]
  v_exp_f32 v235, v171
  v_mfma_f32_16x16x32_bf16 a[124:127], v[216:219], v[180:183], a[124:127]
  v_cvt_pk_bf16_f32 v187, v234, v235
  v_add_f32 v221, v221, v229
  v_mfma_f32_16x16x32_bf16 v[164:167], a[224:227], a[48:51], v[140:143]
  v_exp_f32 v172, v156
  v_mfma_f32_16x16x32_bf16 v[164:167], a[228:231], a[52:55], v[164:167]
  v_add_f32 v221, v221, v230
  v_add_f32 v221, v221, v231
  v_mfma_f32_16x16x32_bf16 v[164:167], a[232:235], a[56:59], v[164:167]
  v_exp_f32 v173, v157
  v_mfma_f32_16x16x32_bf16 v[164:167], a[236:239], a[60:63], v[164:167]
  v_cvt_pk_bf16_f32 v180, v172, v173
  v_add_f32 v221, v221, v232
  v_mfma_f32_16x16x32_bf16 v[168:171], a[240:243], a[48:51], v[140:143]
  v_exp_f32 v174, v158
  v_mfma_f32_16x16x32_bf16 v[168:171], a[244:247], a[52:55], v[168:171]
  v_add_f32 v221, v221, v233
  v_add_f32 v221, v221, v234
  v_mfma_f32_16x16x32_bf16 v[168:171], a[248:251], a[56:59], v[168:171]
  v_exp_f32 v175, v159
  v_mfma_f32_16x16x32_bf16 v[168:171], a[252:255], a[60:63], v[168:171]
  v_cvt_pk_bf16_f32 v181, v174, v175
  v_add_f32 v221, v221, v235
  v_mfma_f32_16x16x32_bf16 v[32:35], v[188:191], v[184:187], v[32:35]
  v_exp_f32 v176, v160
  v_mfma_f32_16x16x32_bf16 v[36:39], v[192:195], v[184:187], v[36:39]
  v_mfma_f32_32x32x16_bf16 a[176:191], v[12:15], v[12:15], 0
  v_add_f32 v222, v222, v172
  v_mfma_f32_16x16x32_bf16 v[40:43], v[196:199], v[184:187], v[40:43]
  v_exp_f32 v177, v161
  v_mfma_f32_16x16x32_bf16 v[44:47], v[200:203], v[184:187], v[44:47]
  v_cvt_pk_bf16_f32 v182, v176, v177
  v_add_f32 v222, v222, v173
  v_mfma_f32_16x16x32_bf16 a[128:131], v[204:207], v[184:187], a[128:131]
  v_exp_f32 v178, v162
  v_mfma_f32_16x16x32_bf16 a[132:135], v[208:211], v[184:187], a[132:135]
  v_add_f32 v222, v222, v174
  v_add_f32 v222, v222, v175
  v_mfma_f32_16x16x32_bf16 a[136:139], v[212:215], v[184:187], a[136:139]
  v_exp_f32 v179, v163
  v_mfma_f32_16x16x32_bf16 a[140:143], v[216:219], v[184:187], a[140:143]
  v_cvt_pk_bf16_f32 v183, v178, v179
  v_add_f32 v222, v222, v176
  v_mfma_f32_16x16x32_bf16 v[156:159], a[224:227], a[64:67], v[144:147]
  v_exp_f32 v228, v164
  v_mfma_f32_16x16x32_bf16 v[156:159], a[228:231], a[68:71], v[156:159]
  s_sub_u32 s10, s57, 0x20000
  v_add_f32 v222, v222, v177
  v_mfma_f32_16x16x32_bf16 v[156:159], a[232:235], a[72:75], v[156:159]
  v_exp_f32 v229, v165
  v_mfma_f32_16x16x32_bf16 v[156:159], a[236:239], a[76:79], v[156:159]
  v_cvt_pk_bf16_f32 v184, v228, v229
  v_add_f32 v222, v222, v178
  v_mfma_f32_16x16x32_bf16 v[160:163], a[240:243], a[64:67], v[144:147]
  v_exp_f32 v230, v166
  v_mfma_f32_16x16x32_bf16 v[160:163], a[244:247], a[68:71], v[160:163]
  s_mov_b32 s11, 5
  v_add_f32 v222, v222, v179
  v_mfma_f32_16x16x32_bf16 v[160:163], a[248:251], a[72:75], v[160:163]
  v_exp_f32 v231, v167
  v_mfma_f32_16x16x32_bf16 v[160:163], a[252:255], a[76:79], v[160:163]
  v_cvt_pk_bf16_f32 v185, v230, v231
  v_add_f32 v223, v223, v228
  v_mfma_f32_16x16x32_bf16 v[48:51], v[188:191], v[180:183], v[48:51]
  v_exp_f32 v232, v168
  v_mfma_f32_16x16x32_bf16 v[52:55], v[192:195], v[180:183], v[52:55]
  v_add_f32 v223, v223, v229
  v_add_f32 v223, v223, v230
  v_mfma_f32_16x16x32_bf16 v[56:59], v[196:199], v[180:183], v[56:59]
  v_exp_f32 v233, v169
  v_mfma_f32_16x16x32_bf16 v[60:63], v[200:203], v[180:183], v[60:63]
  v_cvt_pk_bf16_f32 v186, v232, v233
  v_add_f32 v223, v223, v231
  v_mfma_f32_16x16x32_bf16 a[144:147], v[204:207], v[180:183], a[144:147]
  v_exp_f32 v234, v170
  v_mfma_f32_16x16x32_bf16 a[148:151], v[208:211], v[180:183], a[148:151]
  v_add_f32 v223, v223, v232
  v_add_f32 v223, v223, v233
  v_mfma_f32_16x16x32_bf16 a[152:155], v[212:215], v[180:183], a[152:155]
  v_exp_f32 v235, v171
  v_mfma_f32_16x16x32_bf16 a[156:159], v[216:219], v[180:183], a[156:159]
  v_cvt_pk_bf16_f32 v187, v234, v235
  v_add_f32 v223, v223, v234
  v_mfma_f32_16x16x32_bf16 v[164:167], a[224:227], a[80:83], v[148:151]
  v_exp_f32 v172, v156
  v_mfma_f32_16x16x32_bf16 v[164:167], a[228:231], a[84:87], v[164:167]
  v_add_f32 v223, v223, v235
  v_add_f32 v224, v224, v172
  v_mfma_f32_16x16x32_bf16 v[164:167], a[232:235], a[88:91], v[164:167]
  v_exp_f32 v173, v157
  v_mfma_f32_16x16x32_bf16 v[164:167], a[236:239], a[92:95], v[164:167]
  v_cvt_pk_bf16_f32 v180, v172, v173
  v_add_f32 v224, v224, v173
  v_mfma_f32_16x16x32_bf16 v[168:171], a[240:243], a[80:83], v[148:151]
  v_exp_f32 v174, v158
  v_mfma_f32_16x16x32_bf16 v[168:171], a[244:247], a[84:87], v[168:171]
  v_add_f32 v224, v224, v174
  v_mfma_f32_16x16x32_bf16 v[168:171], a[248:251], a[88:91], v[168:171]
  v_exp_f32 v175, v159
  v_mfma_f32_16x16x32_bf16 v[168:171], a[252:255], a[92:95], v[168:171]
  v_cvt_pk_bf16_f32 v181, v174, v175
  v_add_f32 v224, v224, v175
  v_mfma_f32_16x16x32_bf16 v[64:67], v[188:191], v[184:187], v[64:67]
  v_exp_f32 v176, v160
  v_mfma_f32_16x16x32_bf16 v[68:71], v[192:195], v[184:187], v[68:71]
  v_add_f32 v224, v224, v176
  v_mfma_f32_16x16x32_bf16 v[72:75], v[196:199], v[184:187], v[72:75]
  v_exp_f32 v177, v161
  v_mfma_f32_16x16x32_bf16 v[76:79], v[200:203], v[184:187], v[76:79]
  v_cvt_pk_bf16_f32 v182, v176, v177
  v_add_f32 v224, v224, v177
  v_mfma_f32_16x16x32_bf16 a[160:163], v[204:207], v[184:187], a[160:163]
  v_exp_f32 v178, v162
  v_mfma_f32_16x16x32_bf16 a[164:167], v[208:211], v[184:187], a[164:167]
  s_getreg_b32 s66, hwreg(HW_REG_IB_STS, 0, 4)
  v_add_f32 v224, v224, v178
  v_mfma_f32_16x16x32_bf16 a[168:171], v[212:215], v[184:187], a[168:171]
  v_exp_f32 v179, v163
  v_mfma_f32_16x16x32_bf16 a[172:175], v[216:219], v[184:187], a[172:175]
  s_waitcnt vmcnt(8)
  v_cvt_pk_bf16_f32 v183, v178, v179
  v_add_f32 v224, v224, v179
.p2align 5
L_loop:
  s_cmp_gt_u32 s66, s11
  s_cbranch_scc1 L_h0
L_u0:
  v_mfma_f32_16x16x32_bf16 v[156:159], a[224:227], a[96:99], v[152:155]
  s_barrier
  v_exp_f32 v228, v164
  v_mfma_f32_16x16x32_bf16 v[156:159], a[228:231], a[100:103], v[156:159]
  ds_read_b128 a[224:227], v240 offset:8192
  ds_read_b128 a[228:231], v240 offset:8448
  v_mfma_f32_16x16x32_bf16 v[156:159], a[232:235], a[104:107], v[156:159]
  v_exp_f32 v229, v165
  v_mfma_f32_16x16x32_bf16 v[156:159], a[236:239], a[108:111], v[156:159]
  ds_read_b128 a[232:235], v240 offset:8704
  v_cvt_pk_bf16_f32 v184, v228, v229
  v_mfma_f32_16x16x32_bf16 v[160:163], a[240:243], a[96:99], v[152:155]
  v_exp_f32 v230, v166
  v_mfma_f32_16x16x32_bf16 v[160:163], a[244:247], a[100:103], v[160:163]
  ds_read_b128 a[236:239], v240 offset:8960
  ds_read_b128 a[240:243], v240 offset:12288
  v_mfma_f32_16x16x32_bf16 v[160:163], a[248:251], a[104:107], v[160:163]
  v_exp_f32 v231, v167
  v_mfma_f32_16x16x32_bf16 v[160:163], a[252:255], a[108:111], v[160:163]
  ds_read_b128 a[244:247], v240 offset:12544
  v_cvt_pk_bf16_f32 v185, v230, v231
  v_mfma_f32_16x16x32_bf16 v[80:83], v[188:191], v[180:183], v[80:83]
  v_exp_f32 v232, v168
  v_mfma_f32_16x16x32_bf16 v[84:87], v[192:195], v[180:183], v[84:87]
  ds_read_b128 a[248:251], v240 offset:12800
  ds_read_b128 a[252:255], v240 offset:13056
  v_mfma_f32_16x16x32_bf16 v[88:91], v[196:199], v[180:183], v[88:91]
  v_exp_f32 v233, v169
  v_mfma_f32_16x16x32_bf16 v[92:95], v[200:203], v[180:183], v[92:95]
  s_add_u32 m0, s10, 0
  v_cvt_pk_bf16_f32 v186, v232, v233
  v_mfma_f32_16x16x32_bf16 a[176:179], v[204:207], v[180:183], a[176:179]
  v_exp_f32 v234, v170
  v_mfma_f32_16x16x32_bf16 a[180:183], v[208:211], v[180:183], a[180:183]
  buffer_load_dwordx4 v6, s[28:31], s63 offen offset:0 nt lds
  buffer_load_dwordx4 v7, s[28:31], s63 offen offset:1024 nt lds
  s_add_u32 m0, s10, 65536
  v_mfma_f32_16x16x32_bf16 a[184:187], v[212:215], v[180:183], a[184:187]
  v_exp_f32 v235, v171
  v_mfma_f32_16x16x32_bf16 a[188:191], v[216:219], v[180:183], a[188:191]
  s_waitcnt lgkmcnt(0)
  buffer_load_dwordx4 v6, s[28:31], s62 offen offset:0 nt lds
  buffer_load_dwordx4 v7, s[28:31], s62 offen offset:1024 nt lds
  v_cvt_pk_bf16_f32 v187, v234, v235
  v_mfma_f32_16x16x32_bf16 v[164:167], a[224:227], a[0:3], v[128:131]
  v_exp_f32 v172, v156
  v_mfma_f32_16x16x32_bf16 v[164:167], a[228:231], a[4:7], v[164:167]
  v_add_f32 v225, v225, v228
  v_add_f32 v225, v225, v229
  v_mfma_f32_16x16x32_bf16 v[164:167], a[232:235], a[8:11], v[164:167]
  v_exp_f32 v173, v157
  v_mfma_f32_16x16x32_bf16 v[164:167], a[236:239], a[12:15], v[164:167]
  v_cvt_pk_bf16_f32 v180, v172, v173
  v_add_f32 v225, v225, v230
  v_mfma_f32_16x16x32_bf16 v[168:171], a[240:243], a[0:3], v[128:131]
  v_exp_f32 v174, v158
  v_mfma_f32_16x16x32_bf16 v[168:171], a[244:247], a[4:7], v[168:171]
  v_add_f32 v225, v225, v231
  v_add_f32 v225, v225, v232
  v_mfma_f32_16x16x32_bf16 v[168:171], a[248:251], a[8:11], v[168:171]
  v_exp_f32 v175, v159
  v_mfma_f32_16x16x32_bf16 v[168:171], a[252:255], a[12:15], v[168:171]
  s_add_u32 m0, s10, 32768
  v_cvt_pk_bf16_f32 v181, v174, v175
  v_mfma_f32_16x16x32_bf16 v[96:99], v[188:191], v[184:187], v[96:99]
  v_exp_f32 v176, v160
  v_mfma_f32_16x16x32_bf16 v[100:103], v[192:195], v[184:187], v[100:103]
  buffer_load_dwordx4 v6, s[84:87], s63 offen offset:0 nt lds
  buffer_load_dwordx4 v7, s[84:87], s63 offen offset:1024 nt lds
  s_add_u32 m0, s10, 98304
  v_mfma_f32_16x16x32_bf16 v[104:107], v[196:199], v[184:187], v[104:107]
  v_exp_f32 v177, v161
  v_mfma_f32_16x16x32_bf16 v[108:111], v[200:203], v[184:187], v[108:111]
  buffer_load_dwordx4 v8, s[84:87], s62 offen offset:0 nt lds
  buffer_load_dwordx4 v9, s[84:87], s62 offen offset:1024 nt lds
  v_cvt_pk_bf16_f32 v182, v176, v177
  v_mfma_f32_16x16x32_bf16 a[192:195], v[204:207], v[184:187], a[192:195]
  v_exp_f32 v178, v162
  v_mfma_f32_16x16x32_bf16 a[196:199], v[208:211], v[184:187], a[196:199]
  s_add_u32 s63, s63, 16384
  s_add_u32 s62, s62, 16384
  v_mfma_f32_16x16x32_bf16 a[200:203], v[212:215], v[184:187], a[200:203]
  v_exp_f32 v179, v163
  v_mfma_f32_16x16x32_bf16 a[204:207], v[216:219], v[184:187], a[204:207]
  s_add_u32 s10, s10, 8192
  s_and_b32 s10, s10, 0x7fff
L_j0:
  v_cvt_pk_bf16_f32 v183, v178, v179
  v_add_f32 v225, v225, v233
  v_add_f32 v225, v225, v234
  v_add_f32 v225, v225, v235
  v_mfma_f32_16x16x32_bf16 v[156:159], a[224:227], a[16:19], v[132:135]
  v_exp_f32 v228, v164
  v_mfma_f32_16x16x32_bf16 v[156:159], a[228:231], a[20:23], v[156:159]
  v_add_f32 v226, v226, v172
  v_add_f32 v226, v226, v173
  v_mfma_f32_16x16x32_bf16 v[156:159], a[232:235], a[24:27], v[156:159]
  v_exp_f32 v229, v165
  v_mfma_f32_16x16x32_bf16 v[156:159], a[236:239], a[28:31], v[156:159]
  v_cvt_pk_bf16_f32 v184, v228, v229
  v_add_f32 v226, v226, v174
  v_mfma_f32_16x16x32_bf16 v[160:163], a[240:243], a[16:19], v[132:135]
  v_exp_f32 v230, v166
  v_mfma_f32_16x16x32_bf16 v[160:163], a[244:247], a[20:23], v[160:163]
  v_add_f32 v226, v226, v175
  v_add_f32 v226, v226, v176
  v_mfma_f32_16x16x32_bf16 v[160:163], a[248:251], a[24:27], v[160:163]
  v_exp_f32 v231, v167
  v_mfma_f32_16x16x32_bf16 v[160:163], a[252:255], a[28:31], v[160:163]
  v_cvt_pk_bf16_f32 v185, v230, v231
  v_add_f32 v226, v226, v177
  v_mfma_f32_16x16x32_bf16 v[112:115], v[188:191], v[180:183], v[112:115]
  v_exp_f32 v232, v168
  v_mfma_f32_16x16x32_bf16 v[116:119], v[192:195], v[180:183], v[116:119]
  ds_read_b64_tr_b16 v[188:189], v241 offset:8192
  ds_read_b64_tr_b16 v[190:191], v241 offset:12288
  ds_read_b64_tr_b16 v[192:193], v242 offset:8192
  v_mfma_f32_16x16x32_bf16 v[120:123], v[196:199], v[180:183], v[120:123]
  v_exp_f32 v233, v169
  v_mfma_f32_16x16x32_bf16 v[124:127], v[200:203], v[180:183], v[124:127]
  ds_read_b64_tr_b16 v[194:195], v242 offset:12288
  ds_read_b64_tr_b16 v[196:197], v241 offset:8448
  v_cvt_pk_bf16_f32 v186, v232, v233
  v_mfma_f32_16x16x32_bf16 a[208:211], v[204:207], v[180:183], a[208:211]
  v_exp_f32 v234, v170
  v_mfma_f32_16x16x32_bf16 a[212:215], v[208:211], v[180:183], a[212:215]
  ds_read_b64_tr_b16 v[198:199], v241 offset:12544
  ds_read_b64_tr_b16 v[200:201], v242 offset:8448
  ds_read_b64_tr_b16 v[202:203], v242 offset:12544
  v_mfma_f32_16x16x32_bf16 a[216:219], v[212:215], v[180:183], a[216:219]
  v_exp_f32 v235, v171
  v_mfma_f32_16x16x32_bf16 a[220:223], v[216:219], v[180:183], a[220:223]
  ds_read_b64_tr_b16 v[204:205], v241 offset:8704
  ds_read_b64_tr_b16 v[206:207], v241 offset:12800
  v_cvt_pk_bf16_f32 v187, v234, v235
  v_add_f32 v226, v226, v178
  v_add_f32 v226, v226, v179
  v_mfma_f32_16x16x32_bf16 v[164:167], a[224:227], a[32:35], v[136:139]
  v_exp_f32 v172, v156
  v_mfma_f32_16x16x32_bf16 v[164:167], a[228:231], a[36:39], v[164:167]
  ds_read_b64_tr_b16 v[208:209], v242 offset:8704
  ds_read_b64_tr_b16 v[210:211], v242 offset:12800
  v_mfma_f32_16x16x32_bf16 v[164:167], a[232:235], a[40:43], v[164:167]
  v_exp_f32 v173, v157
  v_mfma_f32_16x16x32_bf16 v[164:167], a[236:239], a[44:47], v[164:167]
  ds_read_b64_tr_b16 v[212:213], v241 offset:8960
  ds_read_b64_tr_b16 v[214:215], v241 offset:13056
  v_cvt_pk_bf16_f32 v180, v172, v173
  v_mfma_f32_16x16x32_bf16 v[168:171], a[240:243], a[32:35], v[136:139]
  v_exp_f32 v174, v158
  v_mfma_f32_16x16x32_bf16 v[168:171], a[244:247], a[36:39], v[168:171]
  ds_read_b64_tr_b16 v[216:217], v242 offset:8960
  ds_read_b64_tr_b16 v[218:219], v242 offset:13056
  v_mfma_f32_16x16x32_bf16 v[168:171], a[248:251], a[40:43], v[168:171]
  v_exp_f32 v175, v159
  v_mfma_f32_16x16x32_bf16 v[168:171], a[252:255], a[44:47], v[168:171]
  s_waitcnt lgkmcnt(4)
  v_cvt_pk_bf16_f32 v181, v174, v175
  v_mfma_f32_16x16x32_bf16 v[16:19], v[188:191], v[184:187], v[16:19]
  v_exp_f32 v176, v160
  v_mfma_f32_16x16x32_bf16 v[20:23], v[192:195], v[184:187], v[20:23]
  v_add_f32 v220, v220, v228
  v_add_f32 v220, v220, v229
  v_mfma_f32_16x16x32_bf16 v[24:27], v[196:199], v[184:187], v[24:27]
  v_exp_f32 v177, v161
  v_mfma_f32_16x16x32_bf16 v[28:31], v[200:203], v[184:187], v[28:31]
  v_cvt_pk_bf16_f32 v182, v176, v177
  v_add_f32 v220, v220, v230
  v_mfma_f32_16x16x32_bf16 a[112:115], v[204:207], v[184:187], a[112:115]
  v_exp_f32 v178, v162
  v_mfma_f32_16x16x32_bf16 a[116:119], v[208:211], v[184:187], a[116:119]
  s_waitcnt lgkmcnt(0)
  v_add_f32 v220, v220, v231
  v_mfma_f32_16x16x32_bf16 a[120:123], v[212:215], v[184:187], a[120:123]
  v_exp_f32 v179, v163
  v_mfma_f32_16x16x32_bf16 a[124:127], v[216:219], v[184:187], a[124:127]
  v_cvt_pk_bf16_f32 v183, v178, v179
  v_add_f32 v220, v220, v232
  v_add_f32 v220, v220, v233
  v_add_f32 v220, v220, v234
  v_add_f32 v220, v220, v235
  v_mfma_f32_16x16x32_bf16 v[156:159], a[224:227], a[48:51], v[140:143]
  v_exp_f32 v228, v164
  v_mfma_f32_16x16x32_bf16 v[156:159], a[228:231], a[52:55], v[156:159]
  v_add_f32 v221, v221, v172
  v_add_f32 v221, v221, v173
  v_mfma_f32_16x16x32_bf16 v[156:159], a[232:235], a[56:59], v[156:159]
  v_exp_f32 v229, v165
  v_mfma_f32_16x16x32_bf16 v[156:159], a[236:239], a[60:63], v[156:159]
  v_cvt_pk_bf16_f32 v184, v228, v229
  v_add_f32 v221, v221, v174
  v_mfma_f32_16x16x32_bf16 v[160:163], a[240:243], a[48:51], v[140:143]
  v_exp_f32 v230, v166
  v_mfma_f32_16x16x32_bf16 v[160:163], a[244:247], a[52:55], v[160:163]
  v_add_f32 v221, v221, v175
  v_add_f32 v221, v221, v176
  v_mfma_f32_16x16x32_bf16 v[160:163], a[248:251], a[56:59], v[160:163]
  v_exp_f32 v231, v167
  v_mfma_f32_16x16x32_bf16 v[160:163], a[252:255], a[60:63], v[160:163]
  v_cvt_pk_bf16_f32 v185, v230, v231
  v_add_f32 v221, v221, v177
  v_mfma_f32_16x16x32_bf16 v[32:35], v[188:191], v[180:183], v[32:35]
  v_exp_f32 v232, v168
  v_mfma_f32_16x16x32_bf16 v[36:39], v[192:195], v[180:183], v[36:39]
  v_add_f32 v221, v221, v178
  v_add_f32 v221, v221, v179
  v_mfma_f32_16x16x32_bf16 v[40:43], v[196:199], v[180:183], v[40:43]
  v_exp_f32 v233, v169
  v_mfma_f32_16x16x32_bf16 v[44:47], v[200:203], v[180:183], v[44:47]
  v_cvt_pk_bf16_f32 v186, v232, v233
  v_add_f32 v222, v222, v228
  v_mfma_f32_16x16x32_bf16 a[128:131], v[204:207], v[180:183], a[128:131]
  v_exp_f32 v234, v170
  v_mfma_f32_16x16x32_bf16 a[132:135], v[208:211], v[180:183], a[132:135]
  v_add_f32 v222, v222, v229
  v_add_f32 v222, v222, v230
  v_mfma_f32_16x16x32_bf16 a[136:139], v[212:215], v[180:183], a[136:139]
  v_exp_f32 v235, v171
  v_mfma_f32_16x16x32_bf16 a[140:143], v[216:219], v[180:183], a[140:143]
  v_cvt_pk_bf16_f32 v187, v234, v235
  v_add_f32 v222, v222, v231
  v_mfma_f32_16x16x32_bf16 v[164:167], a[224:227], a[64:67], v[144:147]
  v_exp_f32 v172, v156
  v_mfma_f32_16x16x32_bf16 v[164:167], a[228:231], a[68:71], v[164:167]
  v_add_f32 v222, v222, v232
  v_add_f32 v222, v222, v233
  v_mfma_f32_16x16x32_bf16 v[164:167], a[232:235], a[72:75], v[164:167]
  v_exp_f32 v173, v157
  v_mfma_f32_16x16x32_bf16 v[164:167], a[236:239], a[76:79], v[164:167]
  v_cvt_pk_bf16_f32 v180, v172, v173
  v_add_f32 v222, v222, v234
  v_mfma_f32_16x16x32_bf16 v[168:171], a[240:243], a[64:67], v[144:147]
  v_exp_f32 v174, v158
  v_mfma_f32_16x16x32_bf16 v[168:171], a[244:247], a[68:71], v[168:171]
  v_add_f32 v222, v222, v235
  v_add_f32 v223, v223, v172
  v_mfma_f32_16x16x32_bf16 v[168:171], a[248:251], a[72:75], v[168:171]
  v_exp_f32 v175, v159
  v_mfma_f32_16x16x32_bf16 v[168:171], a[252:255], a[76:79], v[168:171]
  v_cvt_pk_bf16_f32 v181, v174, v175
  v_add_f32 v223, v223, v173
  v_mfma_f32_16x16x32_bf16 v[48:51], v[188:191], v[184:187], v[48:51]
  v_exp_f32 v176, v160
  v_mfma_f32_16x16x32_bf16 v[52:55], v[192:195], v[184:187], v[52:55]
  v_add_f32 v223, v223, v174
  v_add_f32 v223, v223, v175
  v_mfma_f32_16x16x32_bf16 v[56:59], v[196:199], v[184:187], v[56:59]
  v_exp_f32 v177, v161
  v_mfma_f32_16x16x32_bf16 v[60:63], v[200:203], v[184:187], v[60:63]
  v_cvt_pk_bf16_f32 v182, v176, v177
  v_add_f32 v223, v223, v176
  v_mfma_f32_16x16x32_bf16 a[144:147], v[204:207], v[184:187], a[144:147]
  v_exp_f32 v178, v162
  v_mfma_f32_16x16x32_bf16 a[148:151], v[208:211], v[184:187], a[148:151]
  v_add_f32 v223, v223, v177
  v_add_f32 v223, v223, v178
  v_mfma_f32_16x16x32_bf16 a[152:155], v[212:215], v[184:187], a[152:155]
  v_exp_f32 v179, v163
  v_mfma_f32_16x16x32_bf16 a[156:159], v[216:219], v[184:187], a[156:159]
  v_cvt_pk_bf16_f32 v183, v178, v179
  v_add_f32 v223, v223, v179
  v_mfma_f32_16x16x32_bf16 v[156:159], a[224:227], a[80:83], v[148:151]
  v_exp_f32 v228, v164
  v_mfma_f32_16x16x32_bf16 v[156:159], a[228:231], a[84:87], v[156:159]
  v_add_f32 v224, v224, v228
  v_mfma_f32_16x16x32_bf16 v[156:159], a[232:235], a[88:91], v[156:159]
  v_exp_f32 v229, v165
  v_mfma_f32_16x16x32_bf16 v[156:159], a[236:239], a[92:95], v[156:159]
  v_cvt_pk_bf16_f32 v184, v228, v229
  v_add_f32 v224, v224, v229
  v_mfma_f32_16x16x32_bf16 v[160:163], a[240:243], a[80:83], v[148:151]
  v_exp_f32 v230, v166
  v_mfma_f32_16x16x32_bf16 v[160:163], a[244:247], a[84:87], v[160:163]
  v_add_f32 v224, v224, v230
  v_mfma_f32_16x16x32_bf16 v[160:163], a[248:251], a[88:91], v[160:163]
  v_exp_f32 v231, v167
  v_mfma_f32_16x16x32_bf16 v[160:163], a[252:255], a[92:95], v[160:163]
  v_cvt_pk_bf16_f32 v185, v230, v231
  v_add_f32 v224, v224, v231
  v_mfma_f32_16x16x32_bf16 v[64:67], v[188:191], v[180:183], v[64:67]
  v_exp_f32 v232, v168
  v_mfma_f32_16x16x32_bf16 v[68:71], v[192:195], v[180:183], v[68:71]
  v_add_f32 v224, v224, v232
  v_mfma_f32_16x16x32_bf16 v[72:75], v[196:199], v[180:183], v[72:75]
  v_exp_f32 v233, v169
  v_mfma_f32_16x16x32_bf16 v[76:79], v[200:203], v[180:183], v[76:79]
  v_cvt_pk_bf16_f32 v186, v232, v233
  v_add_f32 v224, v224, v233
  v_mfma_f32_16x16x32_bf16 a[160:163], v[204:207], v[180:183], a[160:163]
  v_exp_f32 v234, v170
  v_mfma_f32_16x16x32_bf16 a[164:167], v[208:211], v[180:183], a[164:167]
  s_getreg_b32 s66, hwreg(HW_REG_IB_STS, 0, 4)
  v_add_f32 v224, v224, v234
  v_mfma_f32_16x16x32_bf16 a[168:171], v[212:215], v[180:183], a[168:171]
  v_exp_f32 v235, v171
  v_mfma_f32_16x16x32_bf16 a[172:175], v[216:219], v[180:183], a[172:175]
  s_waitcnt vmcnt(8)
  v_cvt_pk_bf16_f32 v187, v234, v235
  v_add_f32 v224, v224, v235
  s_cmp_gt_u32 s66, s11
  s_cbranch_scc1 L_h1
L_u1:
  v_mfma_f32_16x16x32_bf16 v[164:167], a[224:227], a[96:99], v[152:155]
  s_barrier
  v_exp_f32 v172, v156
  v_mfma_f32_16x16x32_bf16 v[164:167], a[228:231], a[100:103], v[164:167]
  ds_read_b128 a[224:227], v240 offset:16384
  ds_read_b128 a[228:231], v240 offset:16640
  v_mfma_f32_16x16x32_bf16 v[164:167], a[232:235], a[104:107], v[164:167]
  v_exp_f32 v173, v157
  v_mfma_f32_16x16x32_bf16 v[164:167], a[236:239], a[108:111], v[164:167]
  ds_read_b128 a[232:235], v240 offset:16896
  v_cvt_pk_bf16_f32 v180, v172, v173
  v_mfma_f32_16x16x32_bf16 v[168:171], a[240:243], a[96:99], v[152:155]
  v_exp_f32 v174, v158
  v_mfma_f32_16x16x32_bf16 v[168:171], a[244:247], a[100:103], v[168:171]
  ds_read_b128 a[236:239], v240 offset:17152
  ds_read_b128 a[240:243], v240 offset:20480
  v_mfma_f32_16x16x32_bf16 v[168:171], a[248:251], a[104:107], v[168:171]
  v_exp_f32 v175, v159
  v_mfma_f32_16x16x32_bf16 v[168:171], a[252:255], a[108:111], v[168:171]
  ds_read_b128 a[244:247], v240 offset:20736
  v_cvt_pk_bf16_f32 v181, v174, v175
  v_mfma_f32_16x16x32_bf16 v[80:83], v[188:191], v[184:187], v[80:83]
  v_exp_f32 v176, v160
  v_mfma_f32_16x16x32_bf16 v[84:87], v[192:195], v[184:187], v[84:87]
  ds_read_b128 a[248:251], v240 offset:20992
  ds_read_b128 a[252:255], v240 offset:21248
  v_mfma_f32_16x16x32_bf16 v[88:91], v[196:199], v[184:187], v[88:91]
  v_exp_f32 v177, v161
  v_mfma_f32_16x16x32_bf16 v[92:95], v[200:203], v[184:187], v[92:95]
  s_add_u32 m0, s10, 0
  v_cvt_pk_bf16_f32 v182, v176, v177
  v_mfma_f32_16x16x32_bf16 a[176:179], v[204:207], v[184:187], a[176:179]
  v_exp_f32 v178, v162
  v_mfma_f32_16x16x32_bf16 a[180:183], v[208:211], v[184:187], a[180:183]
  buffer_load_dwordx4 v6, s[28:31], s63 offen offset:0 nt lds
  buffer_load_dwordx4 v7, s[28:31], s63 offen offset:1024 nt lds
  s_add_u32 m0, s10, 65536
  v_mfma_f32_16x16x32_bf16 a[184:187], v[212:215], v[184:187], a[184:187]
  v_exp_f32 v179, v163
  v_mfma_f32_16x16x32_bf16 a[188:191], v[216:219], v[184:187], a[188:191]
  s_waitcnt lgkmcnt(0)
  buffer_load_dwordx4 v6, s[28:31], s62 offen offset:0 nt lds
  buffer_load_dwordx4 v7, s[28:31], s62 offen offset:1024 nt lds
  v_cvt_pk_bf16_f32 v183, v178, v179
  v_mfma_f32_16x16x32_bf16 v[156:159], a[224:227], a[0:3], v[128:131]
  v_exp_f32 v228, v164
  v_mfma_f32_16x16x32_bf16 v[156:159], a[228:231], a[4:7], v[156:159]
  v_add_f32 v225, v225, v172
  v_add_f32 v225, v225, v173
  v_mfma_f32_16x16x32_bf16 v[156:159], a[232:235], a[8:11], v[156:159]
  v_exp_f32 v229, v165
  v_mfma_f32_16x16x32_bf16 v[156:159], a[236:239], a[12:15], v[156:159]
  v_cvt_pk_bf16_f32 v184, v228, v229
  v_add_f32 v225, v225, v174
  v_mfma_f32_16x16x32_bf16 v[160:163], a[240:243], a[0:3], v[128:131]
  v_exp_f32 v230, v166
  v_mfma_f32_16x16x32_bf16 v[160:163], a[244:247], a[4:7], v[160:163]
  v_add_f32 v225, v225, v175
  v_add_f32 v225, v225, v176
  v_mfma_f32_16x16x32_bf16 v[160:163], a[248:251], a[8:11], v[160:163]
  v_exp_f32 v231, v167
  v_mfma_f32_16x16x32_bf16 v[160:163], a[252:255], a[12:15], v[160:163]
  s_add_u32 m0, s10, 32768
  v_cvt_pk_bf16_f32 v185, v230, v231
  v_mfma_f32_16x16x32_bf16 v[96:99], v[188:191], v[180:183], v[96:99]
  v_exp_f32 v232, v168
  v_mfma_f32_16x16x32_bf16 v[100:103], v[192:195], v[180:183], v[100:103]
  buffer_load_dwordx4 v6, s[84:87], s63 offen offset:0 nt lds
  buffer_load_dwordx4 v7, s[84:87], s63 offen offset:1024 nt lds
  s_add_u32 m0, s10, 98304
  v_mfma_f32_16x16x32_bf16 v[104:107], v[196:199], v[180:183], v[104:107]
  v_exp_f32 v233, v169
  v_mfma_f32_16x16x32_bf16 v[108:111], v[200:203], v[180:183], v[108:111]
  buffer_load_dwordx4 v8, s[84:87], s62 offen offset:0 nt lds
  buffer_load_dwordx4 v9, s[84:87], s62 offen offset:1024 nt lds
  v_cvt_pk_bf16_f32 v186, v232, v233
  v_mfma_f32_16x16x32_bf16 a[192:195], v[204:207], v[180:183], a[192:195]
  v_exp_f32 v234, v170
  v_mfma_f32_16x16x32_bf16 a[196:199], v[208:211], v[180:183], a[196:199]
  s_add_u32 s63, s63, 16384
  s_add_u32 s62, s62, 16384
  v_mfma_f32_16x16x32_bf16 a[200:203], v[212:215], v[180:183], a[200:203]
  v_exp_f32 v235, v171
  v_mfma_f32_16x16x32_bf16 a[204:207], v[216:219], v[180:183], a[204:207]
  s_add_u32 s10, s10, 8192
  s_and_b32 s10, s10, 0x7fff
L_j1:
  v_cvt_pk_bf16_f32 v187, v234, v235
  v_add_f32 v225, v225, v177
  v_add_f32 v225, v225, v178
  v_add_f32 v225, v225, v179
  v_mfma_f32_16x16x32_bf16 v[164:167], a[224:227], a[16:19], v[132:135]
  v_exp_f32 v172, v156
  v_mfma_f32_16x16x32_bf16 v[164:167], a[228:231], a[20:23], v[164:167]
  v_add_f32 v226, v226, v228
  v_add_f32 v226, v226, v229
  v_mfma_f32_16x16x32_bf16 v[164:167], a[232:235], a[24:27], v[164:167]
  v_exp_f32 v173, v157
  v_mfma_f32_16x16x32_bf16 v[164:167], a[236:239], a[28:31], v[164:167]
  v_cvt_pk_bf16_f32 v180, v172, v173
  v_add_f32 v226, v226, v230
  v_mfma_f32_16x16x32_bf16 v[168:171], a[240:243], a[16:19], v[132:135]
  v_exp_f32 v174, v158
  v_mfma_f32_16x16x32_bf16 v[168:171], a[244:247], a[20:23], v[168:171]
  v_add_f32 v226, v226, v231
  v_add_f32 v226, v226, v232
  v_mfma_f32_16x16x32_bf16 v[168:171], a[248:251], a[24:27], v[168:171]
  v_exp_f32 v175, v159
  v_mfma_f32_16x16x32_bf16 v[168:171], a[252:255], a[28:31], v[168:171]
  v_cvt_pk_bf16_f32 v181, v174, v175
  v_add_f32 v226, v226, v233
  v_mfma_f32_16x16x32_bf16 v[112:115], v[188:191], v[184:187], v[112:115]
  v_exp_f32 v176, v160
  v_mfma_f32_16x16x32_bf16 v[116:119], v[192:195], v[184:187], v[116:119]
  ds_read_b64_tr_b16 v[188:189], v241 offset:16384
  ds_read_b64_tr_b16 v[190:191], v241 offset:20480
  ds_read_b64_tr_b16 v[192:193], v242 offset:16384
  v_mfma_f32_16x16x32_bf16 v[120:123], v[196:199], v[184:187], v[120:123]
  v_exp_f32 v177, v161
  v_mfma_f32_16x16x32_bf16 v[124:127], v[200:203], v[184:187], v[124:127]
  ds_read_b64_tr_b16 v[194:195], v242 offset:20480
  ds_read_b64_tr_b16 v[196:197], v241 offset:16640
  v_cvt_pk_bf16_f32 v182, v176, v177
  v_mfma_f32_16x16x32_bf16 a[208:211], v[204:207], v[184:187], a[208:211]
  v_exp_f32 v178, v162
  v_mfma_f32_16x16x32_bf16 a[212:215], v[208:211], v[184:187], a[212:215]
  ds_read_b64_tr_b16 v[198:199], v241 offset:20736
  ds_read_b64_tr_b16 v[200:201], v242 offset:16640
  ds_read_b64_tr_b16 v[202:203], v242 offset:20736
  v_mfma_f32_16x16x32_bf16 a[216:219], v[212:215], v[184:187], a[216:219]
  v_exp_f32 v179, v163
  v_mfma_f32_16x16x32_bf16 a[220:223], v[216:219], v[184:187], a[220:223]
  ds_read_b64_tr_b16 v[204:205], v241 offset:16896
  ds_read_b64_tr_b16 v[206:207], v241 offset:20992
  v_cvt_pk_bf16_f32 v183, v178, v179
  v_add_f32 v226, v226, v234
  v_add_f32 v226, v226, v235
  v_mfma_f32_16x16x32_bf16 v[156:159], a[224:227], a[32:35], v[136:139]
  v_exp_f32 v228, v164
  v_mfma_f32_16x16x32_bf16 v[156:159], a[228:231], a[36:39], v[156:159]
  ds_read_b64_tr_b16 v[208:209], v242 offset:16896
  ds_read_b64_tr_b16 v[210:211], v242 offset:20992
  v_mfma_f32_16x16x32_bf16 v[156:159], a[232:235], a[40:43], v[156:159]
  v_exp_f32 v229, v165
  v_mfma_f32_16x16x32_bf16 v[156:159], a[236:239], a[44:47], v[156:159]
  ds_read_b64_tr_b16 v[212:213], v241 offset:17152
  ds_read_b64_tr_b16 v[214:215], v241 offset:21248
  v_cvt_pk_bf16_f32 v184, v228, v229
  v_mfma_f32_16x16x32_bf16 v[160:163], a[240:243], a[32:35], v[136:139]
  v_exp_f32 v230, v166
  v_mfma_f32_16x16x32_bf16 v[160:163], a[244:247], a[36:39], v[160:163]
  ds_read_b64_tr_b16 v[216:217], v242 offset:17152
  ds_read_b64_tr_b16 v[218:219], v242 offset:21248
  v_mfma_f32_16x16x32_bf16 v[160:163], a[248:251], a[40:43], v[160:163]
  v_exp_f32 v231, v167
  v_mfma_f32_16x16x32_bf16 v[160:163], a[252:255], a[44:47], v[160:163]
  s_waitcnt lgkmcnt(4)
  v_cvt_pk_bf16_f32 v185, v230, v231
  v_mfma_f32_16x16x32_bf16 v[16:19], v[188:191], v[180:183], v[16:19]
  v_exp_f32 v232, v168
  v_mfma_f32_16x16x32_bf16 v[20:23], v[192:195], v[180:183], v[20:23]
  v_add_f32 v220, v220, v172
  v_add_f32 v220, v220, v173
  v_mfma_f32_16x16x32_bf16 v[24:27], v[196:199], v[180:183], v[24:27]
  v_exp_f32 v233, v169
  v_mfma_f32_16x16x32_bf16 v[28:31], v[200:203], v[180:183], v[28:31]
  v_cvt_pk_bf16_f32 v186, v232, v233
  v_add_f32 v220, v220, v174
  v_mfma_f32_16x16x32_bf16 a[112:115], v[204:207], v[180:183], a[112:115]
  v_exp_f32 v234, v170
  v_mfma_f32_16x16x32_bf16 a[116:119], v[208:211], v[180:183], a[116:119]
  s_waitcnt lgkmcnt(0)
  v_add_f32 v220, v220, v175
  v_mfma_f32_16x16x32_bf16 a[120:123], v[212:215], v[180:183], a[120:123]
  v_exp_f32 v235, v171
  v_mfma_f32_16x16x32_bf16 a[124:127], v[216:219], v[180:183], a[124:127]
  v_cvt_pk_bf16_f32 v187, v234, v235
  v_add_f32 v220, v220, v176
  v_add_f32 v220, v220, v177
  v_add_f32 v220, v220, v178
  v_add_f32 v220, v220, v179
  v_mfma_f32_16x16x32_bf16 v[164:167], a[224:227], a[48:51], v[140:143]
  v_exp_f32 v172, v156
  v_mfma_f32_16x16x32_bf16 v[164:167], a[228:231], a[52:55], v[164:167]
  v_add_f32 v221, v221, v228
  v_add_f32 v221, v221, v229
  v_mfma_f32_16x16x32_bf16 v[164:167], a[232:235], a[56:59], v[164:167]
  v_exp_f32 v173, v157
  v_mfma_f32_16x16x32_bf16 v[164:167], a[236:239], a[60:63], v[164:167]
  v_cvt_pk_bf16_f32 v180, v172, v173
  v_add_f32 v221, v221, v230
  v_mfma_f32_16x16x32_bf16 v[168:171], a[240:243], a[48:51], v[140:143]
  v_exp_f32 v174, v158
  v_mfma_f32_16x16x32_bf16 v[168:171], a[244:247], a[52:55], v[168:171]
  v_add_f32 v221, v221, v231
  v_add_f32 v221, v221, v232
  v_mfma_f32_16x16x32_bf16 v[168:171], a[248:251], a[56:59], v[168:171]
  v_exp_f32 v175, v159
  v_mfma_f32_16x16x32_bf16 v[168:171], a[252:255], a[60:63], v[168:171]
  v_cvt_pk_bf16_f32 v181, v174, v175
  v_add_f32 v221, v221, v233
  v_mfma_f32_16x16x32_bf16 v[32:35], v[188:191], v[184:187], v[32:35]
  v_exp_f32 v176, v160
  v_mfma_f32_16x16x32_bf16 v[36:39], v[192:195], v[184:187], v[36:39]
  v_add_f32 v221, v221, v234
  v_add_f32 v221, v221, v235
  v_mfma_f32_16x16x32_bf16 v[40:43], v[196:199], v[184:187], v[40:43]
  v_exp_f32 v177, v161
  v_mfma_f32_16x16x32_bf16 v[44:47], v[200:203], v[184:187], v[44:47]
  v_cvt_pk_bf16_f32 v182, v176, v177
  v_add_f32 v222, v222, v172
  v_mfma_f32_16x16x32_bf16 a[128:131], v[204:207], v[184:187], a[128:131]
  v_exp_f32 v178, v162
  v_mfma_f32_16x16x32_bf16 a[132:135], v[208:211], v[184:187], a[132:135]
  v_add_f32 v222, v222, v173
  v_add_f32 v222, v222, v174
  v_mfma_f32_16x16x32_bf16 a[136:139], v[212:215], v[184:187], a[136:139]
  v_exp_f32 v179, v163
  v_mfma_f32_16x16x32_bf16 a[140:143], v[216:219], v[184:187], a[140:143]
  v_cvt_pk_bf16_f32 v183, v178, v179
  v_add_f32 v222, v222, v175
  v_mfma_f32_16x16x32_bf16 v[156:159], a[224:227], a[64:67], v[144:147]
  v_exp_f32 v228, v164
  v_mfma_f32_16x16x32_bf16 v[156:159], a[228:231], a[68:71], v[156:159]
  v_add_f32 v222, v222, v176
  v_add_f32 v222, v222, v177
  v_mfma_f32_16x16x32_bf16 v[156:159], a[232:235], a[72:75], v[156:159]
  v_exp_f32 v229, v165
  v_mfma_f32_16x16x32_bf16 v[156:159], a[236:239], a[76:79], v[156:159]
  v_cvt_pk_bf16_f32 v184, v228, v229
  v_add_f32 v222, v222, v178
  v_mfma_f32_16x16x32_bf16 v[160:163], a[240:243], a[64:67], v[144:147]
  v_exp_f32 v230, v166
  v_mfma_f32_16x16x32_bf16 v[160:163], a[244:247], a[68:71], v[160:163]
  v_add_f32 v222, v222, v179
  v_add_f32 v223, v223, v228
  v_mfma_f32_16x16x32_bf16 v[160:163], a[248:251], a[72:75], v[160:163]
  v_exp_f32 v231, v167
  v_mfma_f32_16x16x32_bf16 v[160:163], a[252:255], a[76:79], v[160:163]
  v_cvt_pk_bf16_f32 v185, v230, v231
  v_add_f32 v223, v223, v229
  v_mfma_f32_16x16x32_bf16 v[48:51], v[188:191], v[180:183], v[48:51]
  v_exp_f32 v232, v168
  v_mfma_f32_16x16x32_bf16 v[52:55], v[192:195], v[180:183], v[52:55]
  v_add_f32 v223, v223, v230
  v_add_f32 v223, v223, v231
  v_mfma_f32_16x16x32_bf16 v[56:59], v[196:199], v[180:183], v[56:59]
  v_exp_f32 v233, v169
  v_mfma_f32_16x16x32_bf16 v[60:63], v[200:203], v[180:183], v[60:63]
  v_cvt_pk_bf16_f32 v186, v232, v233
  v_add_f32 v223, v223, v232
  v_mfma_f32_16x16x32_bf16 a[144:147], v[204:207], v[180:183], a[144:147]
  v_exp_f32 v234, v170
  v_mfma_f32_16x16x32_bf16 a[148:151], v[208:211], v[180:183], a[148:151]
  v_add_f32 v223, v223, v233
  v_add_f32 v223, v223, v234
  v_mfma_f32_16x16x32_bf16 a[152:155], v[212:215], v[180:183], a[152:155]
  v_exp_f32 v235, v171
  v_mfma_f32_16x16x32_bf16 a[156:159], v[216:219], v[180:183], a[156:159]
  v_cvt_pk_bf16_f32 v187, v234, v235
  v_add_f32 v223, v223, v235
  v_mfma_f32_16x16x32_bf16 v[164:167], a[224:227], a[80:83], v[148:151]
  v_exp_f32 v172, v156
  v_mfma_f32_16x16x32_bf16 v[164:167], a[228:231], a[84:87], v[164:167]
  v_add_f32 v224, v224, v172
  v_mfma_f32_16x16x32_bf16 v[164:167], a[232:235], a[88:91], v[164:167]
  v_exp_f32 v173, v157
  v_mfma_f32_16x16x32_bf16 v[164:167], a[236:239], a[92:95], v[164:167]
  v_cvt_pk_bf16_f32 v180, v172, v173
  v_add_f32 v224, v224, v173
  v_mfma_f32_16x16x32_bf16 v[168:171], a[240:243], a[80:83], v[148:151]
  v_exp_f32 v174, v158
  v_mfma_f32_16x16x32_bf16 v[168:171], a[244:247], a[84:87], v[168:171]
  v_add_f32 v224, v224, v174
  v_mfma_f32_16x16x32_bf16 v[168:171], a[248:251], a[88:91], v[168:171]
  v_exp_f32 v175, v159
  v_mfma_f32_16x16x32_bf16 v[168:171], a[252:255], a[92:95], v[168:171]
  v_cvt_pk_bf16_f32 v181, v174, v175
  v_add_f32 v224, v224, v175
  v_mfma_f32_16x16x32_bf16 v[64:67], v[188:191], v[184:187], v[64:67]
  v_exp_f32 v176, v160
  v_mfma_f32_16x16x32_bf16 v[68:71], v[192:195], v[184:187], v[68:71]
  v_add_f32 v224, v224, v176
  v_mfma_f32_16x16x32_bf16 v[72:75], v[196:199], v[184:187], v[72:75]
  v_exp_f32 v177, v161
  v_mfma_f32_16x16x32_bf16 v[76:79], v[200:203], v[184:187], v[76:79]
  v_cvt_pk_bf16_f32 v182, v176, v177
  v_add_f32 v224, v224, v177
  v_mfma_f32_16x16x32_bf16 a[160:163], v[204:207], v[184:187], a[160:163]
  v_exp_f32 v178, v162
  v_mfma_f32_16x16x32_bf16 a[164:167], v[208:211], v[184:187], a[164:167]
  s_getreg_b32 s66, hwreg(HW_REG_IB_STS, 0, 4)
  v_add_f32 v224, v224, v178
  v_mfma_f32_16x16x32_bf16 a[168:171], v[212:215], v[184:187], a[168:171]
  v_exp_f32 v179, v163
  v_mfma_f32_16x16x32_bf16 a[172:175], v[216:219], v[184:187], a[172:175]
  s_waitcnt vmcnt(8)
  v_cvt_pk_bf16_f32 v183, v178, v179
  v_add_f32 v224, v224, v179
  s_cmp_gt_u32 s66, s11
  s_cbranch_scc1 L_h2
L_u2:
  v_mfma_f32_16x16x32_bf16 v[156:159], a[224:227], a[96:99], v[152:155]
  s_barrier
  v_exp_f32 v228, v164
  v_mfma_f32_16x16x32_bf16 v[156:159], a[228:231], a[100:103], v[156:159]
  ds_read_b128 a[224:227], v240 offset:24576
  ds_read_b128 a[228:231], v240 offset:24832
  v_mfma_f32_16x16x32_bf16 v[156:159], a[232:235], a[104:107], v[156:159]
  v_exp_f32 v229, v165
  v_mfma_f32_16x16x32_bf16 v[156:159], a[236:239], a[108:111], v[156:159]
  ds_read_b128 a[232:235], v240 offset:25088
  v_cvt_pk_bf16_f32 v184, v228, v229
  v_mfma_f32_16x16x32_bf16 v[160:163], a[240:243], a[96:99], v[152:155]
  v_exp_f32 v230, v166
  v_mfma_f32_16x16x32_bf16 v[160:163], a[244:247], a[100:103], v[160:163]
  ds_read_b128 a[236:239], v240 offset:25344
  ds_read_b128 a[240:243], v240 offset:28672
  v_mfma_f32_16x16x32_bf16 v[160:163], a[248:251], a[104:107], v[160:163]
  v_exp_f32 v231, v167
  v_mfma_f32_16x16x32_bf16 v[160:163], a[252:255], a[108:111], v[160:163]
  ds_read_b128 a[244:247], v240 offset:28928
  v_cvt_pk_bf16_f32 v185, v230, v231
  v_mfma_f32_16x16x32_bf16 v[80:83], v[188:191], v[180:183], v[80:83]
  v_exp_f32 v232, v168
  v_mfma_f32_16x16x32_bf16 v[84:87], v[192:195], v[180:183], v[84:87]
  ds_read_b128 a[248:251], v240 offset:29184
  ds_read_b128 a[252:255], v240 offset:29440
  v_mfma_f32_16x16x32_bf16 v[88:91], v[196:199], v[180:183], v[88:91]
  v_exp_f32 v233, v169
  v_mfma_f32_16x16x32_bf16 v[92:95], v[200:203], v[180:183], v[92:95]
  s_add_u32 m0, s10, 0
  v_cvt_pk_bf16_f32 v186, v232, v233
  v_mfma_f32_16x16x32_bf16 a[176:179], v[204:207], v[180:183], a[176:179]
  v_exp_f32 v234, v170
  v_mfma_f32_16x16x32_bf16 a[180:183], v[208:211], v[180:183], a[180:183]
  buffer_load_dwordx4 v6, s[28:31], s63 offen offset:0 nt lds
  buffer_load_dwordx4 v7, s[28:31], s63 offen offset:1024 nt lds
  s_add_u32 m0, s10, 65536
  v_mfma_f32_16x16x32_bf16 a[184:187], v[212:215], v[180:183], a[184:187]
  v_exp_f32 v235, v171
  v_mfma_f32_16x16x32_bf16 a[188:191], v[216:219], v[180:183], a[188:191]
  s_waitcnt lgkmcnt(0)
  buffer_load_dwordx4 v6, s[28:31], s62 offen offset:0 nt lds
  buffer_load_dwordx4 v7, s[28:31], s62 offen offset:1024 nt lds
  v_cvt_pk_bf16_f32 v187, v234, v235
  v_mfma_f32_16x16x32_bf16 v[164:167], a[224:227], a[0:3], v[128:131]
  v_exp_f32 v172, v156
  v_mfma_f32_16x16x32_bf16 v[164:167], a[228:231], a[4:7], v[164:167]
  v_add_f32 v225, v225, v228
  v_add_f32 v225, v225, v229
  v_mfma_f32_16x16x32_bf16 v[164:167], a[232:235], a[8:11], v[164:167]
  v_exp_f32 v173, v157
  v_mfma_f32_16x16x32_bf16 v[164:167], a[236:239], a[12:15], v[164:167]
  v_cvt_pk_bf16_f32 v180, v172, v173
  v_add_f32 v225, v225, v230
  v_mfma_f32_16x16x32_bf16 v[168:171], a[240:243], a[0:3], v[128:131]
  v_exp_f32 v174, v158
  v_mfma_f32_16x16x32_bf16 v[168:171], a[244:247], a[4:7], v[168:171]
  v_add_f32 v225, v225, v231
  v_add_f32 v225, v225, v232
  v_mfma_f32_16x16x32_bf16 v[168:171], a[248:251], a[8:11], v[168:171]
  v_exp_f32 v175, v159
  v_mfma_f32_16x16x32_bf16 v[168:171], a[252:255], a[12:15], v[168:171]
  s_add_u32 m0, s10, 32768
  v_cvt_pk_bf16_f32 v181, v174, v175
  v_mfma_f32_16x16x32_bf16 v[96:99], v[188:191], v[184:187], v[96:99]
  v_exp_f32 v176, v160
  v_mfma_f32_16x16x32_bf16 v[100:103], v[192:195], v[184:187], v[100:103]
  buffer_load_dwordx4 v6, s[84:87], s63 offen offset:0 nt lds
  buffer_load_dwordx4 v7, s[84:87], s63 offen offset:1024 nt lds
  s_add_u32 m0, s10, 98304
  v_mfma_f32_16x16x32_bf16 v[104:107], v[196:199], v[184:187], v[104:107]
  v_exp_f32 v177, v161
  v_mfma_f32_16x16x32_bf16 v[108:111], v[200:203], v[184:187], v[108:111]
  buffer_load_dwordx4 v8, s[84:87], s62 offen offset:0 nt lds
  buffer_load_dwordx4 v9, s[84:87], s62 offen offset:1024 nt lds
  v_cvt_pk_bf16_f32 v182, v176, v177
  v_mfma_f32_16x16x32_bf16 a[192:195], v[204:207], v[184:187], a[192:195]
  v_exp_f32 v178, v162
  v_mfma_f32_16x16x32_bf16 a[196:199], v[208:211], v[184:187], a[196:199]
  s_add_u32 s63, s63, 16384
  s_add_u32 s62, s62, 16384
  v_mfma_f32_16x16x32_bf16 a[200:203], v[212:215], v[184:187], a[200:203]
  v_exp_f32 v179, v163
  v_mfma_f32_16x16x32_bf16 a[204:207], v[216:219], v[184:187], a[204:207]
  s_add_u32 s10, s10, 8192
  s_and_b32 s10, s10, 0x7fff
L_j2:
  v_cvt_pk_bf16_f32 v183, v178, v179
  v_add_f32 v225, v225, v233
  v_add_f32 v225, v225, v234
  v_add_f32 v225, v225, v235
  v_mfma_f32_16x16x32_bf16 v[156:159], a[224:227], a[16:19], v[132:135]
  v_exp_f32 v228, v164
  v_mfma_f32_16x16x32_bf16 v[156:159], a[228:231], a[20:23], v[156:159]
  v_add_f32 v226, v226, v172
  v_add_f32 v226, v226, v173
  v_mfma_f32_16x16x32_bf16 v[156:159], a[232:235], a[24:27], v[156:159]
  v_exp_f32 v229, v165
  v_mfma_f32_16x16x32_bf16 v[156:159], a[236:239], a[28:31], v[156:159]
  v_cvt_pk_bf16_f32 v184, v228, v229
  v_add_f32 v226, v226, v174
  v_mfma_f32_16x16x32_bf16 v[160:163], a[240:243], a[16:19], v[132:135]
  v_exp_f32 v230, v166
  v_mfma_f32_16x16x32_bf16 v[160:163], a[244:247], a[20:23], v[160:163]
  v_add_f32 v226, v226, v175
  v_add_f32 v226, v226, v176
  v_mfma_f32_16x16x32_bf16 v[160:163], a[248:251], a[24:27], v[160:163]
  v_exp_f32 v231, v167
  v_mfma_f32_16x16x32_bf16 v[160:163], a[252:255], a[28:31], v[160:163]
  v_cvt_pk_bf16_f32 v185, v230, v231
  v_add_f32 v226, v226, v177
  v_mfma_f32_16x16x32_bf16 v[112:115], v[188:191], v[180:183], v[112:115]
  v_exp_f32 v232, v168
  v_mfma_f32_16x16x32_bf16 v[116:119], v[192:195], v[180:183], v[116:119]
  ds_read_b64_tr_b16 v[188:189], v241 offset:24576
  ds_read_b64_tr_b16 v[190:191], v241 offset:28672
  ds_read_b64_tr_b16 v[192:193], v242 offset:24576
  v_mfma_f32_16x16x32_bf16 v[120:123], v[196:199], v[180:183], v[120:123]
  v_exp_f32 v233, v169
  v_mfma_f32_16x16x32_bf16 v[124:127], v[200:203], v[180:183], v[124:127]
  ds_read_b64_tr_b16 v[194:195], v242 offset:28672
  ds_read_b64_tr_b16 v[196:197], v241 offset:24832
  v_cvt_pk_bf16_f32 v186, v232, v233
  v_mfma_f32_16x16x32_bf16 a[208:211], v[204:207], v[180:183], a[208:211]
  v_exp_f32 v234, v170
  v_mfma_f32_16x16x32_bf16 a[212:215], v[208:211], v[180:183], a[212:215]
  ds_read_b64_tr_b16 v[198:199], v241 offset:28928
  ds_read_b64_tr_b16 v[200:201], v242 offset:24832
  ds_read_b64_tr_b16 v[202:203], v242 offset:28928
  v_mfma_f32_16x16x32_bf16 a[216:219], v[212:215], v[180:183], a[216:219]
  v_exp_f32 v235, v171
  v_mfma_f32_16x16x32_bf16 a[220:223], v[216:219], v[180:183], a[220:223]
  ds_read_b64_tr_b16 v[204:205], v241 offset:25088
  ds_read_b64_tr_b16 v[206:207], v241 offset:29184
  v_cvt_pk_bf16_f32 v187, v234, v235
  v_add_f32 v226, v226, v178
  v_add_f32 v226, v226, v179
  v_mfma_f32_16x16x32_bf16 v[164:167], a[224:227], a[32:35], v[136:139]
  v_exp_f32 v172, v156
  v_mfma_f32_16x16x32_bf16 v[164:167], a[228:231], a[36:39], v[164:167]
  ds_read_b64_tr_b16 v[208:209], v242 offset:25088
  ds_read_b64_tr_b16 v[210:211], v242 offset:29184
  v_mfma_f32_16x16x32_bf16 v[164:167], a[232:235], a[40:43], v[164:167]
  v_exp_f32 v173, v157
  v_mfma_f32_16x16x32_bf16 v[164:167], a[236:239], a[44:47], v[164:167]
  ds_read_b64_tr_b16 v[212:213], v241 offset:25344
  ds_read_b64_tr_b16 v[214:215], v241 offset:29440
  v_cvt_pk_bf16_f32 v180, v172, v173
  v_mfma_f32_16x16x32_bf16 v[168:171], a[240:243], a[32:35], v[136:139]
  v_exp_f32 v174, v158
  v_mfma_f32_16x16x32_bf16 v[168:171], a[244:247], a[36:39], v[168:171]
  ds_read_b64_tr_b16 v[216:217], v242 offset:25344
  ds_read_b64_tr_b16 v[218:219], v242 offset:29440
  v_mfma_f32_16x16x32_bf16 v[168:171], a[248:251], a[40:43], v[168:171]
  v_exp_f32 v175, v159
  v_mfma_f32_16x16x32_bf16 v[168:171], a[252:255], a[44:47], v[168:171]
  s_waitcnt lgkmcnt(4)
  v_cvt_pk_bf16_f32 v181, v174, v175
  v_mfma_f32_16x16x32_bf16 v[16:19], v[188:191], v[184:187], v[16:19]
  v_exp_f32 v176, v160
  v_mfma_f32_16x16x32_bf16 v[20:23], v[192:195], v[184:187], v[20:23]
  v_add_f32 v220, v220, v228
  v_add_f32 v220, v220, v229
  v_mfma_f32_16x16x32_bf16 v[24:27], v[196:199], v[184:187], v[24:27]
  v_exp_f32 v177, v161
  v_mfma_f32_16x16x32_bf16 v[28:31], v[200:203], v[184:187], v[28:31]
  v_cvt_pk_bf16_f32 v182, v176, v177
  v_add_f32 v220, v220, v230
  v_mfma_f32_16x16x32_bf16 a[112:115], v[204:207], v[184:187], a[112:115]
  v_exp_f32 v178, v162
  v_mfma_f32_16x16x32_bf16 a[116:119], v[208:211], v[184:187], a[116:119]
  s_waitcnt lgkmcnt(0)
  v_add_f32 v220, v220, v231
  v_mfma_f32_16x16x32_bf16 a[120:123], v[212:215], v[184:187], a[120:123]
  v_exp_f32 v179, v163
  v_mfma_f32_16x16x32_bf16 a[124:127], v[216:219], v[184:187], a[124:127]
  v_cvt_pk_bf16_f32 v183, v178, v179
  v_add_f32 v220, v220, v232
  v_add_f32 v220, v220, v233
  v_add_f32 v220, v220, v234
  v_add_f32 v220, v220, v235
  v_mfma_f32_16x16x32_bf16 v[156:159], a[224:227], a[48:51], v[140:143]
  v_exp_f32 v228, v164
  v_mfma_f32_16x16x32_bf16 v[156:159], a[228:231], a[52:55], v[156:159]
  v_add_f32 v221, v221, v172
  v_add_f32 v221, v221, v173
  v_mfma_f32_16x16x32_bf16 v[156:159], a[232:235], a[56:59], v[156:159]
  v_exp_f32 v229, v165
  v_mfma_f32_16x16x32_bf16 v[156:159], a[236:239], a[60:63], v[156:159]
  v_cvt_pk_bf16_f32 v184, v228, v229
  v_add_f32 v221, v221, v174
  v_mfma_f32_16x16x32_bf16 v[160:163], a[240:243], a[48:51], v[140:143]
  v_exp_f32 v230, v166
  v_mfma_f32_16x16x32_bf16 v[160:163], a[244:247], a[52:55], v[160:163]
  v_add_f32 v221, v221, v175
  v_add_f32 v221, v221, v176
  v_mfma_f32_16x16x32_bf16 v[160:163], a[248:251], a[56:59], v[160:163]
  v_exp_f32 v231, v167
  v_mfma_f32_16x16x32_bf16 v[160:163], a[252:255], a[60:63], v[160:163]
  v_cvt_pk_bf16_f32 v185, v230, v231
  v_add_f32 v221, v221, v177
  v_mfma_f32_16x16x32_bf16 v[32:35], v[188:191], v[180:183], v[32:35]
  v_exp_f32 v232, v168
  v_mfma_f32_16x16x32_bf16 v[36:39], v[192:195], v[180:183], v[36:39]
  v_add_f32 v221, v221, v178
  v_add_f32 v221, v221, v179
  v_mfma_f32_16x16x32_bf16 v[40:43], v[196:199], v[180:183], v[40:43]
  v_exp_f32 v233, v169
  v_mfma_f32_16x16x32_bf16 v[44:47], v[200:203], v[180:183], v[44:47]
  v_cvt_pk_bf16_f32 v186, v232, v233
  v_add_f32 v222, v222, v228
  v_mfma_f32_16x16x32_bf16 a[128:131], v[204:207], v[180:183], a[128:131]
  v_exp_f32 v234, v170
  v_mfma_f32_16x16x32_bf16 a[132:135], v[208:211], v[180:183], a[132:135]
  v_add_f32 v222, v222, v229
  v_add_f32 v222, v222, v230
  v_mfma_f32_16x16x32_bf16 a[136:139], v[212:215], v[180:183], a[136:139]
  v_exp_f32 v235, v171
  v_mfma_f32_16x16x32_bf16 a[140:143], v[216:219], v[180:183], a[140:143]
  v_cvt_pk_bf16_f32 v187, v234, v235
  v_add_f32 v222, v222, v231
  v_mfma_f32_16x16x32_bf16 v[164:167], a[224:227], a[64:67], v[144:147]
  v_exp_f32 v172, v156
  v_mfma_f32_16x16x32_bf16 v[164:167], a[228:231], a[68:71], v[164:167]
  v_add_f32 v222, v222, v232
  v_add_f32 v222, v222, v233
  v_mfma_f32_16x16x32_bf16 v[164:167], a[232:235], a[72:75], v[164:167]
  v_exp_f32 v173, v157
  v_mfma_f32_16x16x32_bf16 v[164:167], a[236:239], a[76:79], v[164:167]
  v_cvt_pk_bf16_f32 v180, v172, v173
  v_add_f32 v222, v222, v234
  v_mfma_f32_16x16x32_bf16 v[168:171], a[240:243], a[64:67], v[144:147]
  v_exp_f32 v174, v158
  v_mfma_f32_16x16x32_bf16 v[168:171], a[244:247], a[68:71], v[168:171]
  v_add_f32 v222, v222, v235
  v_add_f32 v223, v223, v172
  v_mfma_f32_16x16x32_bf16 v[168:171], a[248:251], a[72:75], v[168:171]
  v_exp_f32 v175, v159
  v_mfma_f32_16x16x32_bf16 v[168:171], a[252:255], a[76:79], v[168:171]
  v_cvt_pk_bf16_f32 v181, v174, v175
  v_add_f32 v223, v223, v173
  v_mfma_f32_16x16x32_bf16 v[48:51], v[188:191], v[184:187], v[48:51]
  v_exp_f32 v176, v160
  v_mfma_f32_16x16x32_bf16 v[52:55], v[192:195], v[184:187], v[52:55]
  v_add_f32 v223, v223, v174
  v_add_f32 v223, v223, v175
  v_mfma_f32_16x16x32_bf16 v[56:59], v[196:199], v[184:187], v[56:59]
  v_exp_f32 v177, v161
  v_mfma_f32_16x16x32_bf16 v[60:63], v[200:203], v[184:187], v[60:63]
  v_cvt_pk_bf16_f32 v182, v176, v177
  v_add_f32 v223, v223, v176
  v_mfma_f32_16x16x32_bf16 a[144:147], v[204:207], v[184:187], a[144:147]
  v_exp_f32 v178, v162
  v_mfma_f32_16x16x32_bf16 a[148:151], v[208:211], v[184:187], a[148:151]
  v_add_f32 v223, v223, v177
  v_add_f32 v223, v223, v178
  v_mfma_f32_16x16x32_bf16 a[152:155], v[212:215], v[184:187], a[152:155]
  v_exp_f32 v179, v163
  v_mfma_f32_16x16x32_bf16 a[156:159], v[216:219], v[184:187], a[156:159]
  v_cvt_pk_bf16_f32 v183, v178, v179
  v_add_f32 v223, v223, v179
  v_mfma_f32_16x16x32_bf16 v[156:159], a[224:227], a[80:83], v[148:151]
  v_exp_f32 v228, v164
  v_mfma_f32_16x16x32_bf16 v[156:159], a[228:231], a[84:87], v[156:159]
  v_add_f32 v224, v224, v228
  v_mfma_f32_16x16x32_bf16 v[156:159], a[232:235], a[88:91], v[156:159]
  v_exp_f32 v229, v165
  v_mfma_f32_16x16x32_bf16 v[156:159], a[236:239], a[92:95], v[156:159]
  v_cvt_pk_bf16_f32 v184, v228, v229
  v_add_f32 v224, v224, v229
  v_mfma_f32_16x16x32_bf16 v[160:163], a[240:243], a[80:83], v[148:151]
  v_exp_f32 v230, v166
  v_mfma_f32_16x16x32_bf16 v[160:163], a[244:247], a[84:87], v[160:163]
  v_add_f32 v224, v224, v230
  v_mfma_f32_16x16x32_bf16 v[160:163], a[248:251], a[88:91], v[160:163]
  v_exp_f32 v231, v167
  v_mfma_f32_16x16x32_bf16 v[160:163], a[252:255], a[92:95], v[160:163]
  v_cvt_pk_bf16_f32 v185, v230, v231
  v_add_f32 v224, v224, v231
  v_mfma_f32_16x16x32_bf16 v[64:67], v[188:191], v[180:183], v[64:67]
  v_exp_f32 v232, v168
  v_mfma_f32_16x16x32_bf16 v[68:71], v[192:195], v[180:183], v[68:71]
  v_add_f32 v224, v224, v232
  v_mfma_f32_16x16x32_bf16 v[72:75], v[196:199], v[180:183], v[72:75]
  v_exp_f32 v233, v169
  v_mfma_f32_16x16x32_bf16 v[76:79], v[200:203], v[180:183], v[76:79]
  v_cvt_pk_bf16_f32 v186, v232, v233
  v_add_f32 v224, v224, v233
  v_mfma_f32_16x16x32_bf16 a[160:163], v[204:207], v[180:183], a[160:163]
  v_exp_f32 v234, v170
  v_mfma_f32_16x16x32_bf16 a[164:167], v[208:211], v[180:183], a[164:167]
  s_getreg_b32 s66, hwreg(HW_REG_IB_STS, 0, 4)
  v_add_f32 v224, v224, v234
  v_mfma_f32_16x16x32_bf16 a[168:171], v[212:215], v[180:183], a[168:171]
  v_exp_f32 v235, v171
  v_mfma_f32_16x16x32_bf16 a[172:175], v[216:219], v[180:183], a[172:175]
  s_waitcnt vmcnt(8)
  v_cvt_pk_bf16_f32 v187, v234, v235
  v_add_f32 v224, v224, v235
  s_cmp_gt_u32 s66, s11
  s_cbranch_scc1 L_h3
L_u3:
  v_mfma_f32_16x16x32_bf16 v[164:167], a[224:227], a[96:99], v[152:155]
  s_barrier
  v_exp_f32 v172, v156
  v_mfma_f32_16x16x32_bf16 v[164:167], a[228:231], a[100:103], v[164:167]
  ds_read_b128 a[224:227], v240 offset:0
  ds_read_b128 a[228:231], v240 offset:256
  v_mfma_f32_16x16x32_bf16 v[164:167], a[232:235], a[104:107], v[164:167]
  v_exp_f32 v173, v157
  v_mfma_f32_16x16x32_bf16 v[164:167], a[236:239], a[108:111], v[164:167]
  ds_read_b128 a[232:235], v240 offset:512
  v_cvt_pk_bf16_f32 v180, v172, v173
  v_mfma_f32_16x16x32_bf16 v[168:171], a[240:243], a[96:99], v[152:155]
  v_exp_f32 v174, v158
  v_mfma_f32_16x16x32_bf16 v[168:171], a[244:247], a[100:103], v[168:171]
  ds_read_b128 a[236:239], v240 offset:768
  ds_read_b128 a[240:243], v240 offset:4096
  v_mfma_f32_16x16x32_bf16 v[168:171], a[248:251], a[104:107], v[168:171]
  v_exp_f32 v175, v159
  v_mfma_f32_16x16x32_bf16 v[168:171], a[252:255], a[108:111], v[168:171]
  ds_read_b128 a[244:247], v240 offset:4352
  v_cvt_pk_bf16_f32 v181, v174, v175
  v_mfma_f32_16x16x32_bf16 v[80:83], v[188:191], v[184:187], v[80:83]
  v_exp_f32 v176, v160
  v_mfma_f32_16x16x32_bf16 v[84:87], v[192:195], v[184:187], v[84:87]
  ds_read_b128 a[248:251], v240 offset:4608
  ds_read_b128 a[252:255], v240 offset:4864
  v_mfma_f32_16x16x32_bf16 v[88:91], v[196:199], v[184:187], v[88:91]
  v_exp_f32 v177, v161
  v_mfma_f32_16x16x32_bf16 v[92:95], v[200:203], v[184:187], v[92:95]
  s_add_u32 m0, s10, 0
  v_cvt_pk_bf16_f32 v182, v176, v177
  v_mfma_f32_16x16x32_bf16 a[176:179], v[204:207], v[184:187], a[176:179]
  v_exp_f32 v178, v162
  v_mfma_f32_16x16x32_bf16 a[180:183], v[208:211], v[184:187], a[180:183]
  buffer_load_dwordx4 v6, s[28:31], s63 offen offset:0 nt lds
  buffer_load_dwordx4 v7, s[28:31], s63 offen offset:1024 nt lds
  s_add_u32 m0, s10, 65536
  v_mfma_f32_16x16x32_bf16 a[184:187], v[212:215], v[184:187], a[184:187]
  v_exp_f32 v179, v163
  v_mfma_f32_16x16x32_bf16 a[188:191], v[216:219], v[184:187], a[188:191]
  s_waitcnt lgkmcnt(0)
  buffer_load_dwordx4 v6, s[28:31], s62 offen offset:0 nt lds
  buffer_load_dwordx4 v7, s[28:31], s62 offen offset:1024 nt lds
  v_cvt_pk_bf16_f32 v183, v178, v179
  v_mfma_f32_16x16x32_bf16 v[156:159], a[224:227], a[0:3], v[128:131]
  v_exp_f32 v228, v164
  v_mfma_f32_16x16x32_bf16 v[156:159], a[228:231], a[4:7], v[156:159]
  v_add_f32 v225, v225, v172
  v_add_f32 v225, v225, v173
  v_mfma_f32_16x16x32_bf16 v[156:159], a[232:235], a[8:11], v[156:159]
  v_exp_f32 v229, v165
  v_mfma_f32_16x16x32_bf16 v[156:159], a[236:239], a[12:15], v[156:159]
  v_cvt_pk_bf16_f32 v184, v228, v229
  v_add_f32 v225, v225, v174
  v_mfma_f32_16x16x32_bf16 v[160:163], a[240:243], a[0:3], v[128:131]
  v_exp_f32 v230, v166
  v_mfma_f32_16x16x32_bf16 v[160:163], a[244:247], a[4:7], v[160:163]
  v_add_f32 v225, v225, v175
  v_add_f32 v225, v225, v176
  v_mfma_f32_16x16x32_bf16 v[160:163], a[248:251], a[8:11], v[160:163]
  v_exp_f32 v231, v167
  v_mfma_f32_16x16x32_bf16 v[160:163], a[252:255], a[12:15], v[160:163]
  s_add_u32 m0, s10, 32768
  v_cvt_pk_bf16_f32 v185, v230, v231
  v_mfma_f32_16x16x32_bf16 v[96:99], v[188:191], v[180:183], v[96:99]
  v_exp_f32 v232, v168
  v_mfma_f32_16x16x32_bf16 v[100:103], v[192:195], v[180:183], v[100:103]
  buffer_load_dwordx4 v6, s[84:87], s63 offen offset:0 nt lds
  buffer_load_dwordx4 v7, s[84:87], s63 offen offset:1024 nt lds
  s_add_u32 m0, s10, 98304
  v_mfma_f32_16x16x32_bf16 v[104:107], v[196:199], v[180:183], v[104:107]
  v_exp_f32 v233, v169
  v_mfma_f32_16x16x32_bf16 v[108:111], v[200:203], v[180:183], v[108:111]
  buffer_load_dwordx4 v8, s[84:87], s62 offen offset:0 nt lds
  buffer_load_dwordx4 v9, s[84:87], s62 offen offset:1024 nt lds
  v_cvt_pk_bf16_f32 v186, v232, v233
  v_mfma_f32_16x16x32_bf16 a[192:195], v[204:207], v[180:183], a[192:195]
  v_exp_f32 v234, v170
  v_mfma_f32_16x16x32_bf16 a[196:199], v[208:211], v[180:183], a[196:199]
  s_add_u32 s63, s63, 16384
  s_add_u32 s62, s62, 16384
  v_mfma_f32_16x16x32_bf16 a[200:203], v[212:215], v[180:183], a[200:203]
  v_exp_f32 v235, v171
  v_mfma_f32_16x16x32_bf16 a[204:207], v[216:219], v[180:183], a[204:207]
  s_add_u32 s10, s10, 8192
  s_and_b32 s10, s10, 0x7fff
L_j3:
  v_cvt_pk_bf16_f32 v187, v234, v235
  v_add_f32 v225, v225, v177
  v_add_f32 v225, v225, v178
  v_add_f32 v225, v225, v179
  v_mfma_f32_16x16x32_bf16 v[164:167], a[224:227], a[16:19], v[132:135]
  v_exp_f32 v172, v156
  v_mfma_f32_16x16x32_bf16 v[164:167], a[228:231], a[20:23], v[164:167]
  v_add_f32 v226, v226, v228
  v_add_f32 v226, v226, v229
  v_mfma_f32_16x16x32_bf16 v[164:167], a[232:235], a[24:27], v[164:167]
  v_exp_f32 v173, v157
  v_mfma_f32_16x16x32_bf16 v[164:167], a[236:239], a[28:31], v[164:167]
  v_cvt_pk_bf16_f32 v180, v172, v173
  v_add_f32 v226, v226, v230
  v_mfma_f32_16x16x32_bf16 v[168:171], a[240:243], a[16:19], v[132:135]
  v_exp_f32 v174, v158
  v_mfma_f32_16x16x32_bf16 v[168:171], a[244:247], a[20:23], v[168:171]
  v_add_f32 v226, v226, v231
  v_add_f32 v226, v226, v232
  v_mfma_f32_16x16x32_bf16 v[168:171], a[248:251], a[24:27], v[168:171]
  v_exp_f32 v175, v159
  v_mfma_f32_16x16x32_bf16 v[168:171], a[252:255], a[28:31], v[168:171]
  v_cvt_pk_bf16_f32 v181, v174, v175
  v_add_f32 v226, v226, v233
  v_mfma_f32_16x16x32_bf16 v[112:115], v[188:191], v[184:187], v[112:115]
  v_exp_f32 v176, v160
  v_mfma_f32_16x16x32_bf16 v[116:119], v[192:195], v[184:187], v[116:119]
  ds_read_b64_tr_b16 v[188:189], v241 offset:0
  ds_read_b64_tr_b16 v[190:191], v241 offset:4096
  ds_read_b64_tr_b16 v[192:193], v242 offset:0
  v_mfma_f32_16x16x32_bf16 v[120:123], v[196:199], v[184:187], v[120:123]
  v_exp_f32 v177, v161
  v_mfma_f32_16x16x32_bf16 v[124:127], v[200:203], v[184:187], v[124:127]
  ds_read_b64_tr_b16 v[194:195], v242 offset:4096
  ds_read_b64_tr_b16 v[196:197], v241 offset:256
  v_cvt_pk_bf16_f32 v182, v176, v177
  v_mfma_f32_16x16x32_bf16 a[208:211], v[204:207], v[184:187], a[208:211]
  v_exp_f32 v178, v162
  v_mfma_f32_16x16x32_bf16 a[212:215], v[208:211], v[184:187], a[212:215]
  ds_read_b64_tr_b16 v[198:199], v241 offset:4352
  ds_read_b64_tr_b16 v[200:201], v242 offset:256
  ds_read_b64_tr_b16 v[202:203], v242 offset:4352
  v_mfma_f32_16x16x32_bf16 a[216:219], v[212:215], v[184:187], a[216:219]
  v_exp_f32 v179, v163
  v_mfma_f32_16x16x32_bf16 a[220:223], v[216:219], v[184:187], a[220:223]
  ds_read_b64_tr_b16 v[204:205], v241 offset:512
  ds_read_b64_tr_b16 v[206:207], v241 offset:4608
  v_cvt_pk_bf16_f32 v183, v178, v179
  v_add_f32 v226, v226, v234
  v_add_f32 v226, v226, v235
  v_mfma_f32_16x16x32_bf16 v[156:159], a[224:227], a[32:35], v[136:139]
  v_exp_f32 v228, v164
  v_mfma_f32_16x16x32_bf16 v[156:159], a[228:231], a[36:39], v[156:159]
  ds_read_b64_tr_b16 v[208:209], v242 offset:512
  ds_read_b64_tr_b16 v[210:211], v242 offset:4608
  v_mfma_f32_16x16x32_bf16 v[156:159], a[232:235], a[40:43], v[156:159]
  v_exp_f32 v229, v165
  v_mfma_f32_16x16x32_bf16 v[156:159], a[236:239], a[44:47], v[156:159]
  ds_read_b64_tr_b16 v[212:213], v241 offset:768
  ds_read_b64_tr_b16 v[214:215], v241 offset:4864
  v_cvt_pk_bf16_f32 v184, v228, v229
  v_mfma_f32_16x16x32_bf16 v[160:163], a[240:243], a[32:35], v[136:139]
  v_exp_f32 v230, v166
  v_mfma_f32_16x16x32_bf16 v[160:163], a[244:247], a[36:39], v[160:163]
  ds_read_b64_tr_b16 v[216:217], v242 offset:768
  ds_read_b64_tr_b16 v[218:219], v242 offset:4864
  v_mfma_f32_16x16x32_bf16 v[160:163], a[248:251], a[40:43], v[160:163]
  v_exp_f32 v231, v167
  v_mfma_f32_16x16x32_bf16 v[160:163], a[252:255], a[44:47], v[160:163]
  s_waitcnt lgkmcnt(4)
  v_cvt_pk_bf16_f32 v185, v230, v231
  v_mfma_f32_16x16x32_bf16 v[16:19], v[188:191], v[180:183], v[16:19]
  v_exp_f32 v232, v168
  v_mfma_f32_16x16x32_bf16 v[20:23], v[192:195], v[180:183], v[20:23]
  v_add_f32 v220, v220, v172
  v_add_f32 v220, v220, v173
  v_mfma_f32_16x16x32_bf16 v[24:27], v[196:199], v[180:183], v[24:27]
  v_exp_f32 v233, v169
  v_mfma_f32_16x16x32_bf16 v[28:31], v[200:203], v[180:183], v[28:31]
  v_cvt_pk_bf16_f32 v186, v232, v233
  v_add_f32 v220, v220, v174
  v_mfma_f32_16x16x32_bf16 a[112:115], v[204:207], v[180:183], a[112:115]
  v_exp_f32 v234, v170
  v_mfma_f32_16x16x32_bf16 a[116:119], v[208:211], v[180:183], a[116:119]
  s_waitcnt lgkmcnt(0)
  v_add_f32 v220, v220, v175
  v_mfma_f32_16x16x32_bf16 a[120:123], v[212:215], v[180:183], a[120:123]
  v_exp_f32 v235, v171
  v_mfma_f32_16x16x32_bf16 a[124:127], v[216:219], v[180:183], a[124:127]
  v_cvt_pk_bf16_f32 v187, v234, v235
  v_add_f32 v220, v220, v176
  v_add_f32 v220, v220, v177
  v_add_f32 v220, v220, v178
  v_add_f32 v220, v220, v179
  v_mfma_f32_16x16x32_bf16 v[164:167], a[224:227], a[48:51], v[140:143]
  v_exp_f32 v172, v156
  v_mfma_f32_16x16x32_bf16 v[164:167], a[228:231], a[52:55], v[164:167]
  v_add_f32 v221, v221, v228
  v_add_f32 v221, v221, v229
  v_mfma_f32_16x16x32_bf16 v[164:167], a[232:235], a[56:59], v[164:167]
  v_exp_f32 v173, v157
  v_mfma_f32_16x16x32_bf16 v[164:167], a[236:239], a[60:63], v[164:167]
  v_cvt_pk_bf16_f32 v180, v172, v173
  v_add_f32 v221, v221, v230
  v_mfma_f32_16x16x32_bf16 v[168:171], a[240:243], a[48:51], v[140:143]
  v_exp_f32 v174, v158
  v_mfma_f32_16x16x32_bf16 v[168:171], a[244:247], a[52:55], v[168:171]
  v_add_f32 v221, v221, v231
  v_add_f32 v221, v221, v232
  v_mfma_f32_16x16x32_bf16 v[168:171], a[248:251], a[56:59], v[168:171]
  v_exp_f32 v175, v159
  v_mfma_f32_16x16x32_bf16 v[168:171], a[252:255], a[60:63], v[168:171]
  v_cvt_pk_bf16_f32 v181, v174, v175
  v_add_f32 v221, v221, v233
  v_mfma_f32_16x16x32_bf16 v[32:35], v[188:191], v[184:187], v[32:35]
  v_exp_f32 v176, v160
  v_mfma_f32_16x16x32_bf16 v[36:39], v[192:195], v[184:187], v[36:39]
  v_add_f32 v221, v221, v234
  v_add_f32 v221, v221, v235
  v_mfma_f32_16x16x32_bf16 v[40:43], v[196:199], v[184:187], v[40:43]
  v_exp_f32 v177, v161
  v_mfma_f32_16x16x32_bf16 v[44:47], v[200:203], v[184:187], v[44:47]
  v_cvt_pk_bf16_f32 v182, v176, v177
  v_add_f32 v222, v222, v172
  v_mfma_f32_16x16x32_bf16 a[128:131], v[204:207], v[184:187], a[128:131]
  v_exp_f32 v178, v162
  v_mfma_f32_16x16x32_bf16 a[132:135], v[208:211], v[184:187], a[132:135]
  v_add_f32 v222, v222, v173
  v_add_f32 v222, v222, v174
  v_mfma_f32_16x16x32_bf16 a[136:139], v[212:215], v[184:187], a[136:139]
  v_exp_f32 v179, v163
  v_mfma_f32_16x16x32_bf16 a[140:143], v[216:219], v[184:187], a[140:143]
  v_cvt_pk_bf16_f32 v183, v178, v179
  v_add_f32 v222, v222, v175
  v_mfma_f32_16x16x32_bf16 v[156:159], a[224:227], a[64:67], v[144:147]
  v_exp_f32 v228, v164
  v_mfma_f32_16x16x32_bf16 v[156:159], a[228:231], a[68:71], v[156:159]
  v_add_f32 v222, v222, v176
  v_add_f32 v222, v222, v177
  v_mfma_f32_16x16x32_bf16 v[156:159], a[232:235], a[72:75], v[156:159]
  v_exp_f32 v229, v165
  v_mfma_f32_16x16x32_bf16 v[156:159], a[236:239], a[76:79], v[156:159]
  v_cvt_pk_bf16_f32 v184, v228, v229
  v_add_f32 v222, v222, v178
  v_mfma_f32_16x16x32_bf16 v[160:163], a[240:243], a[64:67], v[144:147]
  v_exp_f32 v230, v166
  v_mfma_f32_16x16x32_bf16 v[160:163], a[244:247], a[68:71], v[160:163]
  v_add_f32 v222, v222, v179
  v_add_f32 v223, v223, v228
  v_mfma_f32_16x16x32_bf16 v[160:163], a[248:251], a[72:75], v[160:163]
  v_exp_f32 v231, v167
  v_mfma_f32_16x16x32_bf16 v[160:163], a[252:255], a[76:79], v[160:163]
  v_cvt_pk_bf16_f32 v185, v230, v231
  v_add_f32 v223, v223, v229
  v_mfma_f32_16x16x32_bf16 v[48:51], v[188:191], v[180:183], v[48:51]
  v_exp_f32 v232, v168
  v_mfma_f32_16x16x32_bf16 v[52:55], v[192:195], v[180:183], v[52:55]
  v_add_f32 v223, v223, v230
  v_add_f32 v223, v223, v231
  v_mfma_f32_16x16x32_bf16 v[56:59], v[196:199], v[180:183], v[56:59]
  v_exp_f32 v233, v169
  v_mfma_f32_16x16x32_bf16 v[60:63], v[200:203], v[180:183], v[60:63]
  v_cvt_pk_bf16_f32 v186, v232, v233
  v_add_f32 v223, v223, v232
  v_mfma_f32_16x16x32_bf16 a[144:147], v[204:207], v[180:183], a[144:147]
  v_exp_f32 v234, v170
  v_mfma_f32_16x16x32_bf16 a[148:151], v[208:211], v[180:183], a[148:151]
  v_add_f32 v223, v223, v233
  v_add_f32 v223, v223, v234
  v_mfma_f32_16x16x32_bf16 a[152:155], v[212:215], v[180:183], a[152:155]
  v_exp_f32 v235, v171
  v_mfma_f32_16x16x32_bf16 a[156:159], v[216:219], v[180:183], a[156:159]
  v_cvt_pk_bf16_f32 v187, v234, v235
  v_add_f32 v223, v223, v235
  v_mfma_f32_16x16x32_bf16 v[164:167], a[224:227], a[80:83], v[148:151]
  v_exp_f32 v172, v156
  v_mfma_f32_16x16x32_bf16 v[164:167], a[228:231], a[84:87], v[164:167]
  v_add_f32 v224, v224, v172
  v_mfma_f32_16x16x32_bf16 v[164:167], a[232:235], a[88:91], v[164:167]
  v_exp_f32 v173, v157
  v_mfma_f32_16x16x32_bf16 v[164:167], a[236:239], a[92:95], v[164:167]
  v_cvt_pk_bf16_f32 v180, v172, v173
  v_add_f32 v224, v224, v173
  v_mfma_f32_16x16x32_bf16 v[168:171], a[240:243], a[80:83], v[148:151]
  v_exp_f32 v174, v158
  v_mfma_f32_16x16x32_bf16 v[168:171], a[244:247], a[84:87], v[168:171]
  v_add_f32 v224, v224, v174
  v_mfma_f32_16x16x32_bf16 v[168:171], a[248:251], a[88:91], v[168:171]
  v_exp_f32 v175, v159
  v_mfma_f32_16x16x32_bf16 v[168:171], a[252:255], a[92:95], v[168:171]
  v_cvt_pk_bf16_f32 v181, v174, v175
  v_add_f32 v224, v224, v175
  v_mfma_f32_16x16x32_bf16 v[64:67], v[188:191], v[184:187], v[64:67]
  v_exp_f32 v176, v160
  v_mfma_f32_16x16x32_bf16 v[68:71], v[192:195], v[184:187], v[68:71]
  s_sub_u32 s55, s55, 1
  v_add_f32 v224, v224, v176
  v_mfma_f32_16x16x32_bf16 v[72:75], v[196:199], v[184:187], v[72:75]
  v_exp_f32 v177, v161
  v_mfma_f32_16x16x32_bf16 v[76:79], v[200:203], v[184:187], v[76:79]
  s_cmp_lg_u32 s55, 0
  v_cvt_pk_bf16_f32 v182, v176, v177
  v_mfma_f32_16x16x32_bf16 a[160:163], v[204:207], v[184:187], a[160:163]
  v_exp_f32 v178, v162
  v_mfma_f32_16x16x32_bf16 a[164:167], v[208:211], v[184:187], a[164:167]
  s_getreg_b32 s66, hwreg(HW_REG_IB_STS, 0, 4)
  v_add_f32 v224, v224, v177
  v_mfma_f32_16x16x32_bf16 a[168:171], v[212:215], v[184:187], a[168:171]
  v_exp_f32 v179, v163
  v_mfma_f32_16x16x32_bf16 a[172:175], v[216:219], v[184:187], a[172:175]
  s_waitcnt vmcnt(8)
  v_cvt_pk_bf16_f32 v183, v178, v179
  v_add_f32 v224, v224, v178
  v_add_f32 v224, v224, v179
  s_cbranch_scc1 L_loop
  s_branch L_last
L_h0:
  s_mov_b32 s11, 99
  v_mfma_f32_16x16x32_bf16 v[156:159], a[224:227], a[96:99], v[152:155]
  s_barrier
  v_exp_f32 v228, v164
  v_mfma_f32_16x16x32_bf16 v[156:159], a[228:231], a[100:103], v[156:159]
  ds_read_b128 a[224:227], v240 offset:8192
  ds_read_b128 a[228:231], v240 offset:8448
  v_mfma_f32_16x16x32_bf16 v[156:159], a[232:235], a[104:107], v[156:159]
  v_exp_f32 v229, v165
  v_mfma_f32_16x16x32_bf16 v[156:159], a[236:239], a[108:111], v[156:159]
  ds_read_b128 a[232:235], v240 offset:8704
  v_cvt_pk_bf16_f32 v184, v228, v229
  v_mfma_f32_16x16x32_bf16 v[160:163], a[240:243], a[96:99], v[152:155]
  v_exp_f32 v230, v166
  v_mfma_f32_16x16x32_bf16 v[160:163], a[244:247], a[100:103], v[160:163]
  ds_read_b128 a[236:239], v240 offset:8960
  ds_read_b128 a[240:243], v240 offset:12288
  v_mfma_f32_16x16x32_bf16 v[160:163], a[248:251], a[104:107], v[160:163]
  v_exp_f32 v231, v167
  v_mfma_f32_16x16x32_bf16 v[160:163], a[252:255], a[108:111], v[160:163]
  ds_read_b128 a[244:247], v240 offset:12544
  v_cvt_pk_bf16_f32 v185, v230, v231
  v_mfma_f32_16x16x32_bf16 v[80:83], v[188:191], v[180:183], v[80:83]
  v_exp_f32 v232, v168
  v_mfma_f32_16x16x32_bf16 v[84:87], v[192:195], v[180:183], v[84:87]
  ds_read_b128 a[248:251], v240 offset:12800
  ds_read_b128 a[252:255], v240 offset:13056
  v_mfma_f32_16x16x32_bf16 v[88:91], v[196:199], v[180:183], v[88:91]
  v_exp_f32 v233, v169
  v_mfma_f32_16x16x32_bf16 v[92:95], v[200:203], v[180:183], v[92:95]
  v_cvt_pk_bf16_f32 v186, v232, v233
  v_mfma_f32_16x16x32_bf16 a[176:179], v[204:207], v[180:183], a[176:179]
  v_exp_f32 v234, v170
  v_mfma_f32_16x16x32_bf16 a[180:183], v[208:211], v[180:183], a[180:183]
  v_mfma_f32_16x16x32_bf16 a[184:187], v[212:215], v[180:183], a[184:187]
  v_exp_f32 v235, v171
  v_mfma_f32_16x16x32_bf16 a[188:191], v[216:219], v[180:183], a[188:191]
  s_waitcnt lgkmcnt(0)
  v_cvt_pk_bf16_f32 v187, v234, v235
  v_mfma_f32_16x16x32_bf16 v[164:167], a[224:227], a[0:3], v[128:131]
  v_exp_f32 v172, v156
  v_mfma_f32_16x16x32_bf16 v[164:167], a[228:231], a[4:7], v[164:167]
  v_add_f32 v225, v225, v228
  v_add_f32 v225, v225, v229
  v_mfma_f32_16x16x32_bf16 v[164:167], a[232:235], a[8:11], v[164:167]
  v_exp_f32 v173, v157
  v_mfma_f32_16x16x32_bf16 v[164:167], a[236:239], a[12:15], v[164:167]
  v_cvt_pk_bf16_f32 v180, v172, v173
  v_add_f32 v225, v225, v230
  v_mfma_f32_16x16x32_bf16 v[168:171], a[240:243], a[0:3], v[128:131]
  v_exp_f32 v174, v158
  v_mfma_f32_16x16x32_bf16 v[168:171], a[244:247], a[4:7], v[168:171]
  v_add_f32 v225, v225, v231
  v_add_f32 v225, v225, v232
  v_mfma_f32_16x16x32_bf16 v[168:171], a[248:251], a[8:11], v[168:171]
  v_exp_f32 v175, v159
  v_mfma_f32_16x16x32_bf16 v[168:171], a[252:255], a[12:15], v[168:171]
  v_cvt_pk_bf16_f32 v181, v174, v175
  v_mfma_f32_16x16x32_bf16 v[96:99], v[188:191], v[184:187], v[96:99]
  v_exp_f32 v176, v160
  v_mfma_f32_16x16x32_bf16 v[100:103], v[192:195], v[184:187], v[100:103]
  v_mfma_f32_16x16x32_bf16 v[104:107], v[196:199], v[184:187], v[104:107]
  v_exp_f32 v177, v161
  v_mfma_f32_16x16x32_bf16 v[108:111], v[200:203], v[184:187], v[108:111]
  v_cvt_pk_bf16_f32 v182, v176, v177
  v_mfma_f32_16x16x32_bf16 a[192:195], v[204:207], v[184:187], a[192:195]
  v_exp_f32 v178, v162
  v_mfma_f32_16x16x32_bf16 a[196:199], v[208:211], v[184:187], a[196:199]
  v_mfma_f32_16x16x32_bf16 a[200:203], v[212:215], v[184:187], a[200:203]
  v_exp_f32 v179, v163
  v_mfma_f32_16x16x32_bf16 a[204:207], v[216:219], v[184:187], a[204:207]
  s_branch L_j0
L_h1:
  s_mov_b32 s11, 99
  v_mfma_f32_16x16x32_bf16 v[164:167], a[224:227], a[96:99], v[152:155]
  s_barrier
  v_exp_f32 v172, v156
  v_mfma_f32_16x16x32_bf16 v[164:167], a[228:231], a[100:103], v[164:167]
  ds_read_b128 a[224:227], v240 offset:16384
  ds_read_b128 a[228:231], v240 offset:16640
  v_mfma_f32_16x16x32_bf16 v[164:167], a[232:235], a[104:107], v[164:167]
  v_exp_f32 v173, v157
  v_mfma_f32_16x16x32_bf16 v[164:167], a[236:239], a[108:111], v[164:167]
  ds_read_b128 a[232:235], v240 offset:16896
  v_cvt_pk_bf16_f32 v180, v172, v173
  v_mfma_f32_16x16x32_bf16 v[168:171], a[240:243], a[96:99], v[152:155]
  v_exp_f32 v174, v158
  v_mfma_f32_16x16x32_bf16 v[168:171], a[244:247], a[100:103], v[168:171]
  ds_read_b128 a[236:239], v240 offset:17152
  ds_read_b128 a[240:243], v240 offset:20480
  v_mfma_f32_16x16x32_bf16 v[168:171], a[248:251], a[104:107], v[168:171]
  v_exp_f32 v175, v159
  v_mfma_f32_16x16x32_bf16 v[168:171], a[252:255], a[108:111], v[168:171]
  ds_read_b128 a[244:247], v240 offset:20736
  v_cvt_pk_bf16_f32 v181, v174, v175
  v_mfma_f32_16x16x32_bf16 v[80:83], v[188:191], v[184:187], v[80:83]
  v_exp_f32 v176, v160
  v_mfma_f32_16x16x32_bf16 v[84:87], v[192:195], v[184:187], v[84:87]
  ds_read_b128 a[248:251], v240 offset:20992
  ds_read_b128 a[252:255], v240 offset:21248
  v_mfma_f32_16x16x32_bf16 v[88:91], v[196:199], v[184:187], v[88:91]
  v_exp_f32 v177, v161
  v_mfma_f32_16x16x32_bf16 v[92:95], v[200:203], v[184:187], v[92:95]
  v_cvt_pk_bf16_f32 v182, v176, v177
  v_mfma_f32_16x16x32_bf16 a[176:179], v[204:207], v[184:187], a[176:179]
  v_exp_f32 v178, v162
  v_mfma_f32_16x16x32_bf16 a[180:183], v[208:211], v[184:187], a[180:183]
  v_mfma_f32_16x16x32_bf16 a[184:187], v[212:215], v[184:187], a[184:187]
  v_exp_f32 v179, v163
  v_mfma_f32_16x16x32_bf16 a[188:191], v[216:219], v[184:187], a[188:191]
  s_waitcnt lgkmcnt(0)
  v_cvt_pk_bf16_f32 v183, v178, v179
  v_mfma_f32_16x16x32_bf16 v[156:159], a[224:227], a[0:3], v[128:131]
  v_exp_f32 v228, v164
  v_mfma_f32_16x16x32_bf16 v[156:159], a[228:231], a[4:7], v[156:159]
  v_add_f32 v225, v225, v172
  v_add_f32 v225, v225, v173
  v_mfma_f32_16x16x32_bf16 v[156:159], a[232:235], a[8:11], v[156:159]
  v_exp_f32 v229, v165
  v_mfma_f32_16x16x32_bf16 v[156:159], a[236:239], a[12:15], v[156:159]
  v_cvt_pk_bf16_f32 v184, v228, v229
  v_add_f32 v225, v225, v174
  v_mfma_f32_16x16x32_bf16 v[160:163], a[240:243], a[0:3], v[128:131]
  v_exp_f32 v230, v166
  v_mfma_f32_16x16x32_bf16 v[160:163], a[244:247], a[4:7], v[160:163]
  v_add_f32 v225, v225, v175
  v_add_f32 v225, v225, v176
  v_mfma_f32_16x16x32_bf16 v[160:163], a[248:251], a[8:11], v[160:163]
  v_exp_f32 v231, v167
  v_mfma_f32_16x16x32_bf16 v[160:163], a[252:255], a[12:15], v[160:163]
  v_cvt_pk_bf16_f32 v185, v230, v231
  v_mfma_f32_16x16x32_bf16 v[96:99], v[188:191], v[180:183], v[96:99]
  v_exp_f32 v232, v168
  v_mfma_f32_16x16x32_bf16 v[100:103], v[192:195], v[180:183], v[100:103]
  v_mfma_f32_16x16x32_bf16 v[104:107], v[196:199], v[180:183], v[104:107]
  v_exp_f32 v233, v169
  v_mfma_f32_16x16x32_bf16 v[108:111], v[200:203], v[180:183], v[108:111]
  v_cvt_pk_bf16_f32 v186, v232, v233
  v_mfma_f32_16x16x32_bf16 a[192:195], v[204:207], v[180:183], a[192:195]
  v_exp_f32 v234, v170
  v_mfma_f32_16x16x32_bf16 a[196:199], v[208:211], v[180:183], a[196:199]
  v_mfma_f32_16x16x32_bf16 a[200:203], v[212:215], v[180:183], a[200:203]
  v_exp_f32 v235, v171
  v_mfma_f32_16x16x32_bf16 a[204:207], v[216:219], v[180:183], a[204:207]
  s_branch L_j1
L_h2:
  s_mov_b32 s11, 99
  v_mfma_f32_16x16x32_bf16 v[156:159], a[224:227], a[96:99], v[152:155]
  s_barrier
  v_exp_f32 v228, v164
  v_mfma_f32_16x16x32_bf16 v[156:159], a[228:231], a[100:103], v[156:159]
  ds_read_b128 a[224:227], v240 offset:24576
  ds_read_b128 a[228:231], v240 offset:24832
  v_mfma_f32_16x16x32_bf16 v[156:159], a[232:235], a[104:107], v[156:159]
  v_exp_f32 v229, v165
  v_mfma_f32_16x16x32_bf16 v[156:159], a[236:239], a[108:111], v[156:159]
  ds_read_b128 a[232:235], v240 offset:25088
  v_cvt_pk_bf16_f32 v184, v228, v229
  v_mfma_f32_16x16x32_bf16 v[160:163], a[240:243], a[96:99], v[152:155]
  v_exp_f32 v230, v166
  v_mfma_f32_16x16x32_bf16 v[160:163], a[244:247], a[100:103], v[160:163]
  ds_read_b128 a[236:239], v240 offset:25344
  ds_read_b128 a[240:243], v240 offset:28672
  v_mfma_f32_16x16x32_bf16 v[160:163], a[248:251], a[104:107], v[160:163]
  v_exp_f32 v231, v167
  v_mfma_f32_16x16x32_bf16 v[160:163], a[252:255], a[108:111], v[160:163]
  ds_read_b128 a[244:247], v240 offset:28928
  v_cvt_pk_bf16_f32 v185, v230, v231
  v_mfma_f32_16x16x32_bf16 v[80:83], v[188:191], v[180:183], v[80:83]
  v_exp_f32 v232, v168
  v_mfma_f32_16x16x32_bf16 v[84:87], v[192:195], v[180:183], v[84:87]
  ds_read_b128 a[248:251], v240 offset:29184
  ds_read_b128 a[252:255], v240 offset:29440
  v_mfma_f32_16x16x32_bf16 v[88:91], v[196:199], v[180:183], v[88:91]
  v_exp_f32 v233, v169
  v_mfma_f32_16x16x32_bf16 v[92:95], v[200:203], v[180:183], v[92:95]
  v_cvt_pk_bf16_f32 v186, v232, v233
  v_mfma_f32_16x16x32_bf16 a[176:179], v[204:207], v[180:183], a[176:179]
  v_exp_f32 v234, v170
  v_mfma_f32_16x16x32_bf16 a[180:183], v[208:211], v[180:183], a[180:183]
  v_mfma_f32_16x16x32_bf16 a[184:187], v[212:215], v[180:183], a[184:187]
  v_exp_f32 v235, v171
  v_mfma_f32_16x16x32_bf16 a[188:191], v[216:219], v[180:183], a[188:191]
  s_waitcnt lgkmcnt(0)
  v_cvt_pk_bf16_f32 v187, v234, v235
  v_mfma_f32_16x16x32_bf16 v[164:167], a[224:227], a[0:3], v[128:131]
  v_exp_f32 v172, v156
  v_mfma_f32_16x16x32_bf16 v[164:167], a[228:231], a[4:7], v[164:167]
  v_add_f32 v225, v225, v228
  v_add_f32 v225, v225, v229
  v_mfma_f32_16x16x32_bf16 v[164:167], a[232:235], a[8:11], v[164:167]
  v_exp_f32 v173, v157
  v_mfma_f32_16x16x32_bf16 v[164:167], a[236:239], a[12:15], v[164:167]
  v_cvt_pk_bf16_f32 v180, v172, v173
  v_add_f32 v225, v225, v230
  v_mfma_f32_16x16x32_bf16 v[168:171], a[240:243], a[0:3], v[128:131]
  v_exp_f32 v174, v158
  v_mfma_f32_16x16x32_bf16 v[168:171], a[244:247], a[4:7], v[168:171]
  v_add_f32 v225, v225, v231
  v_add_f32 v225, v225, v232
  v_mfma_f32_16x16x32_bf16 v[168:171], a[248:251], a[8:11], v[168:171]
  v_exp_f32 v175, v159
  v_mfma_f32_16x16x32_bf16 v[168:171], a[252:255], a[12:15], v[168:171]
  v_cvt_pk_bf16_f32 v181, v174, v175
  v_mfma_f32_16x16x32_bf16 v[96:99], v[188:191], v[184:187], v[96:99]
  v_exp_f32 v176, v160
  v_mfma_f32_16x16x32_bf16 v[100:103], v[192:195], v[184:187], v[100:103]
  v_mfma_f32_16x16x32_bf16 v[104:107], v[196:199], v[184:187], v[104:107]
  v_exp_f32 v177, v161
  v_mfma_f32_16x16x32_bf16 v[108:111], v[200:203], v[184:187], v[108:111]
  v_cvt_pk_bf16_f32 v182, v176, v177
  v_mfma_f32_16x16x32_bf16 a[192:195], v[204:207], v[184:187], a[192:195]
  v_exp_f32 v178, v162
  v_mfma_f32_16x16x32_bf16 a[196:199], v[208:211], v[184:187], a[196:199]
  v_mfma_f32_16x16x32_bf16 a[200:203], v[212:215], v[184:187], a[200:203]
  v_exp_f32 v179, v163
  v_mfma_f32_16x16x32_bf16 a[204:207], v[216:219], v[184:187], a[204:207]
  s_branch L_j2
L_h3:
  s_mov_b32 s11, 99
  v_mfma_f32_16x16x32_bf16 v[164:167], a[224:227], a[96:99], v[152:155]
  s_barrier
  v_exp_f32 v172, v156
  v_mfma_f32_16x16x32_bf16 v[164:167], a[228:231], a[100:103], v[164:167]
  ds_read_b128 a[224:227], v240 offset:0
  ds_read_b128 a[228:231], v240 offset:256
  v_mfma_f32_16x16x32_bf16 v[164:167], a[232:235], a[104:107], v[164:167]
  v_exp_f32 v173, v157
  v_mfma_f32_16x16x32_bf16 v[164:167], a[236:239], a[108:111], v[164:167]
  ds_read_b128 a[232:235], v240 offset:512
  v_cvt_pk_bf16_f32 v180, v172, v173
  v_mfma_f32_16x16x32_bf16 v[168:171], a[240:243], a[96:99], v[152:155]
  v_exp_f32 v174, v158
  v_mfma_f32_16x16x32_bf16 v[168:171], a[244:247], a[100:103], v[168:171]
  ds_read_b128 a[236:239], v240 offset:768
  ds_read_b128 a[240:243], v240 offset:4096
  v_mfma_f32_16x16x32_bf16 v[168:171], a[248:251], a[104:107], v[168:171]
  v_exp_f32 v175, v159
  v_mfma_f32_16x16x32_bf16 v[168:171], a[252:255], a[108:111], v[168:171]
  ds_read_b128 a[244:247], v240 offset:4352
  v_cvt_pk_bf16_f32 v181, v174, v175
  v_mfma_f32_16x16x32_bf16 v[80:83], v[188:191], v[184:187], v[80:83]
  v_exp_f32 v176, v160
  v_mfma_f32_16x16x32_bf16 v[84:87], v[192:195], v[184:187], v[84:87]
  ds_read_b128 a[248:251], v240 offset:4608
  ds_read_b128 a[252:255], v240 offset:4864
  v_mfma_f32_16x16x32_bf16 v[88:91], v[196:199], v[184:187], v[88:91]
  v_exp_f32 v177, v161
  v_mfma_f32_16x16x32_bf16 v[92:95], v[200:203], v[184:187], v[92:95]
  v_cvt_pk_bf16_f32 v182, v176, v177
  v_mfma_f32_16x16x32_bf16 a[176:179], v[204:207], v[184:187], a[176:179]
  v_exp_f32 v178, v162
  v_mfma_f32_16x16x32_bf16 a[180:183], v[208:211], v[184:187], a[180:183]
  v_mfma_f32_16x16x32_bf16 a[184:187], v[212:215], v[184:187], a[184:187]
  v_exp_f32 v179, v163
  v_mfma_f32_16x16x32_bf16 a[188:191], v[216:219], v[184:187], a[188:191]
  s_waitcnt lgkmcnt(0)
  v_cvt_pk_bf16_f32 v183, v178, v179
  v_mfma_f32_16x16x32_bf16 v[156:159], a[224:227], a[0:3], v[128:131]
  v_exp_f32 v228, v164
  v_mfma_f32_16x16x32_bf16 v[156:159], a[228:231], a[4:7], v[156:159]
  v_add_f32 v225, v225, v172
  v_add_f32 v225, v225, v173
  v_mfma_f32_16x16x32_bf16 v[156:159], a[232:235], a[8:11], v[156:159]
  v_exp_f32 v229, v165
  v_mfma_f32_16x16x32_bf16 v[156:159], a[236:239], a[12:15], v[156:159]
  v_cvt_pk_bf16_f32 v184, v228, v229
  v_add_f32 v225, v225, v174
  v_mfma_f32_16x16x32_bf16 v[160:163], a[240:243], a[0:3], v[128:131]
  v_exp_f32 v230, v166
  v_mfma_f32_16x16x32_bf16 v[160:163], a[244:247], a[4:7], v[160:163]
  v_add_f32 v225, v225, v175
  v_add_f32 v225, v225, v176
  v_mfma_f32_16x16x32_bf16 v[160:163], a[248:251], a[8:11], v[160:163]
  v_exp_f32 v231, v167
  v_mfma_f32_16x16x32_bf16 v[160:163], a[252:255], a[12:15], v[160:163]
  v_cvt_pk_bf16_f32 v185, v230, v231
  v_mfma_f32_16x16x32_bf16 v[96:99], v[188:191], v[180:183], v[96:99]
  v_exp_f32 v232, v168
  v_mfma_f32_16x16x32_bf16 v[100:103], v[192:195], v[180:183], v[100:103]
  v_mfma_f32_16x16x32_bf16 v[104:107], v[196:199], v[180:183], v[104:107]
  v_exp_f32 v233, v169
  v_mfma_f32_16x16x32_bf16 v[108:111], v[200:203], v[180:183], v[108:111]
  v_cvt_pk_bf16_f32 v186, v232, v233
  v_mfma_f32_16x16x32_bf16 a[192:195], v[204:207], v[180:183], a[192:195]
  v_exp_f32 v234, v170
  v_mfma_f32_16x16x32_bf16 a[196:199], v[208:211], v[180:183], a[196:199]
  v_mfma_f32_16x16x32_bf16 a[200:203], v[212:215], v[180:183], a[200:203]
  v_exp_f32 v235, v171
  v_mfma_f32_16x16x32_bf16 a[204:207], v[216:219], v[180:183], a[204:207]
  s_branch L_j3
L_last:
  v_mfma_f32_16x16x32_bf16 v[156:159], a[224:227], a[96:99], v[152:155]
  s_barrier
  v_exp_f32 v228, v164
  v_mfma_f32_16x16x32_bf16 v[156:159], a[228:231], a[100:103], v[156:159]
  ds_read_b128 a[224:227], v240 offset:8192
  ds_read_b128 a[228:231], v240 offset:8448
  v_mfma_f32_16x16x32_bf16 v[156:159], a[232:235], a[104:107], v[156:159]
  v_exp_f32 v229, v165
  v_mfma_f32_16x16x32_bf16 v[156:159], a[236:239], a[108:111], v[156:159]
  ds_read_b128 a[232:235], v240 offset:8704
  v_cvt_pk_bf16_f32 v184, v228, v229
  v_mfma_f32_16x16x32_bf16 v[160:163], a[240:243], a[96:99], v[152:155]
  v_exp_f32 v230, v166
  v_mfma_f32_16x16x32_bf16 v[160:163], a[244:247], a[100:103], v[160:163]
  ds_read_b128 a[236:239], v240 offset:8960
  ds_read_b128 a[240:243], v240 offset:12288
  v_mfma_f32_16x16x32_bf16 v[160:163], a[248:251], a[104:107], v[160:163]
  v_exp_f32 v231, v167
  v_mfma_f32_16x16x32_bf16 v[160:163], a[252:255], a[108:111], v[160:163]
  ds_read_b128 a[244:247], v240 offset:12544
  v_cvt_pk_bf16_f32 v185, v230, v231
  v_mfma_f32_16x16x32_bf16 v[80:83], v[188:191], v[180:183], v[80:83]
  v_exp_f32 v232, v168
  v_mfma_f32_16x16x32_bf16 v[84:87], v[192:195], v[180:183], v[84:87]
  ds_read_b128 a[248:251], v240 offset:12800
  ds_read_b128 a[252:255], v240 offset:13056
  v_mfma_f32_16x16x32_bf16 v[88:91], v[196:199], v[180:183], v[88:91]
  v_exp_f32 v233, v169
  v_mfma_f32_16x16x32_bf16 v[92:95], v[200:203], v[180:183], v[92:95]
  s_cmp_ge_u32 s63, 262144
  v_cvt_pk_bf16_f32 v186, v232, v233
  v_mfma_f32_16x16x32_bf16 a[176:179], v[204:207], v[180:183], a[176:179]
  v_exp_f32 v234, v170
  v_mfma_f32_16x16x32_bf16 a[180:183], v[208:211], v[180:183], a[180:183]
  s_cbranch_scc1 L_ok0
  s_add_u32 m0, s10, 0
  s_nop 0
  buffer_load_dwordx4 v6, s[28:31], s63 offen offset:0 nt lds
  buffer_load_dwordx4 v7, s[28:31], s63 offen offset:1024 nt lds
  s_add_u32 m0, s10, 65536
  s_nop 0
  buffer_load_dwordx4 v6, s[28:31], s62 offen offset:0 nt lds
  buffer_load_dwordx4 v7, s[28:31], s62 offen offset:1024 nt lds
  s_add_u32 m0, s10, 32768
  s_nop 0
  buffer_load_dwordx4 v6, s[84:87], s63 offen offset:0 nt lds
  buffer_load_dwordx4 v7, s[84:87], s63 offen offset:1024 nt lds
  s_add_u32 m0, s10, 98304
  s_nop 0
  buffer_load_dwordx4 v8, s[84:87], s62 offen offset:0 nt lds
  buffer_load_dwordx4 v9, s[84:87], s62 offen offset:1024 nt lds
  s_add_u32 s63, s63, 16384
  s_add_u32 s62, s62, 16384
  s_add_u32 s10, s10, 8192
  s_and_b32 s10, s10, 0x7fff
  L_ok0:
  v_add_f32 v225, v225, v228
  v_mfma_f32_16x16x32_bf16 a[184:187], v[212:215], v[180:183], a[184:187]
  v_exp_f32 v235, v171
  v_mfma_f32_16x16x32_bf16 a[188:191], v[216:219], v[180:183], a[188:191]
  s_waitcnt lgkmcnt(0)
  v_cvt_pk_bf16_f32 v187, v234, v235
  v_mfma_f32_16x16x32_bf16 v[164:167], a[224:227], a[0:3], v[128:131]
  s_add_u32 m0, s58, 0
  s_xor_b32 s69, s1, 0x0
  v_exp_f32 v172, v156
  v_mfma_f32_16x16x32_bf16 v[164:167], a[228:231], a[4:7], v[164:167]
  buffer_load_dwordx4 v244, s[40:43], s69 offen offset:0  lds
  v_add_f32 v225, v225, v229
  v_mfma_f32_16x16x32_bf16 v[164:167], a[232:235], a[8:11], v[164:167]
  v_exp_f32 v173, v157
  v_mfma_f32_16x16x32_bf16 v[164:167], a[236:239], a[12:15], v[164:167]
  v_cvt_pk_bf16_f32 v180, v172, v173
  v_add_f32 v225, v225, v230
  v_mfma_f32_16x16x32_bf16 v[168:171], a[240:243], a[0:3], v[128:131]
  v_exp_f32 v174, v158
  v_mfma_f32_16x16x32_bf16 v[168:171], a[244:247], a[4:7], v[168:171]
  buffer_load_dwordx4 v245, s[40:43], s69 offen offset:1024  lds
  v_add_f32 v225, v225, v231
  v_mfma_f32_16x16x32_bf16 v[168:171], a[248:251], a[8:11], v[168:171]
  v_exp_f32 v175, v159
  v_mfma_f32_16x16x32_bf16 v[168:171], a[252:255], a[12:15], v[168:171]
  v_cvt_pk_bf16_f32 v181, v174, v175
  v_add_f32 v225, v225, v232
  v_mfma_f32_16x16x32_bf16 v[96:99], v[188:191], v[184:187], v[96:99]
  v_exp_f32 v176, v160
  v_mfma_f32_16x16x32_bf16 v[100:103], v[192:195], v[184:187], v[100:103]
  buffer_load_dwordx4 v246, s[40:43], s69 offen offset:2048  lds
  v_add_f32 v225, v225, v233
  v_mfma_f32_16x16x32_bf16 v[104:107], v[196:199], v[184:187], v[104:107]
  v_exp_f32 v177, v161
  v_mfma_f32_16x16x32_bf16 v[108:111], v[200:203], v[184:187], v[108:111]
  v_cvt_pk_bf16_f32 v182, v176, v177
  v_add_f32 v225, v225, v234
  v_mfma_f32_16x16x32_bf16 a[192:195], v[204:207], v[184:187], a[192:195]
  v_exp_f32 v178, v162
  v_mfma_f32_16x16x32_bf16 a[196:199], v[208:211], v[184:187], a[196:199]
  buffer_load_dwordx4 v247, s[40:43], s69 offen offset:3072  lds
  v_add_f32 v225, v225, v235
  v_mfma_f32_16x16x32_bf16 a[200:203], v[212:215], v[184:187], a[200:203]
  v_exp_f32 v179, v163
  v_mfma_f32_16x16x32_bf16 a[204:207], v[216:219], v[184:187], a[204:207]
  v_cvt_pk_bf16_f32 v183, v178, v179
  v_add_f32 v226, v226, v172
  v_mfma_f32_16x16x32_bf16 v[156:159], a[224:227], a[16:19], v[132:135]
  v_exp_f32 v228, v164
  v_mfma_f32_16x16x32_bf16 v[156:159], a[228:231], a[20:23], v[156:159]
  v_add_f32 v226, v226, v173
  v_add_f32 v226, v226, v174
  v_mfma_f32_16x16x32_bf16 v[156:159], a[232:235], a[24:27], v[156:159]
  v_exp_f32 v229, v165
  v_mfma_f32_16x16x32_bf16 v[156:159], a[236:239], a[28:31], v[156:159]
  v_cvt_pk_bf16_f32 v184, v228, v229
  v_add_f32 v226, v226, v175
  v_mfma_f32_16x16x32_bf16 v[160:163], a[240:243], a[16:19], v[132:135]
  v_exp_f32 v230, v166
  v_mfma_f32_16x16x32_bf16 v[160:163], a[244:247], a[20:23], v[160:163]
  v_add_f32 v226, v226, v176
  v_add_f32 v226, v226, v177
  v_mfma_f32_16x16x32_bf16 v[160:163], a[248:251], a[24:27], v[160:163]
  v_exp_f32 v231, v167
  v_mfma_f32_16x16x32_bf16 v[160:163], a[252:255], a[28:31], v[160:163]
  v_cvt_pk_bf16_f32 v185, v230, v231
  v_add_f32 v226, v226, v178
  v_mfma_f32_16x16x32_bf16 v[112:115], v[188:191], v[180:183], v[112:115]
  v_exp_f32 v232, v168
  v_mfma_f32_16x16x32_bf16 v[116:119], v[192:195], v[180:183], v[116:119]
  ds_read_b64_tr_b16 v[188:189], v241 offset:8192
  ds_read_b64_tr_b16 v[190:191], v241 offset:12288
  ds_read_b64_tr_b16 v[192:193], v242 offset:8192
  v_mfma_f32_16x16x32_bf16 v[120:123], v[196:199], v[180:183], v[120:123]
  v_exp_f32 v233, v169
  v_mfma_f32_16x16x32_bf16 v[124:127], v[200:203], v[180:183], v[124:127]
  ds_read_b64_tr_b16 v[194:195], v242 offset:12288
  ds_read_b64_tr_b16 v[196:197], v241 offset:8448
  v_cvt_pk_bf16_f32 v186, v232, v233
  v_mfma_f32_16x16x32_bf16 a[208:211], v[204:207], v[180:183], a[208:211]
  v_exp_f32 v234, v170
  v_mfma_f32_16x16x32_bf16 a[212:215], v[208:211], v[180:183], a[212:215]
  ds_read_b64_tr_b16 v[198:199], v241 offset:12544
  ds_read_b64_tr_b16 v[200:201], v242 offset:8448
  ds_read_b64_tr_b16 v[202:203], v242 offset:12544
  v_mfma_f32_16x16x32_bf16 a[216:219], v[212:215], v[180:183], a[216:219]
  v_exp_f32 v235, v171
  v_mfma_f32_16x16x32_bf16 a[220:223], v[216:219], v[180:183], a[220:223]
  ds_read_b64_tr_b16 v[204:205], v241 offset:8704
  ds_read_b64_tr_b16 v[206:207], v241 offset:12800
  v_cvt_pk_bf16_f32 v187, v234, v235
  v_add_f32 v226, v226, v179
  v_mfma_f32_16x16x32_bf16 v[164:167], a[224:227], a[32:35], v[136:139]
  s_add_u32 m0, s60, 0
  s_xor_b32 s69, s1, 0x30000
  v_exp_f32 v172, v156
  v_mfma_f32_16x16x32_bf16 v[164:167], a[228:231], a[36:39], v[164:167]
  ds_read_b64_tr_b16 v[208:209], v242 offset:8704
  ds_read_b64_tr_b16 v[210:211], v242 offset:12800
  buffer_load_dwordx4 v244, s[40:43], s69 offen offset:0  lds
  v_mfma_f32_16x16x32_bf16 v[164:167], a[232:235], a[40:43], v[164:167]
  v_exp_f32 v173, v157
  v_mfma_f32_16x16x32_bf16 v[164:167], a[236:239], a[44:47], v[164:167]
  ds_read_b64_tr_b16 v[212:213], v241 offset:8960
  ds_read_b64_tr_b16 v[214:215], v241 offset:13056
  v_cvt_pk_bf16_f32 v180, v172, v173
  v_mfma_f32_16x16x32_bf16 v[168:171], a[240:243], a[32:35], v[136:139]
  v_exp_f32 v174, v158
  v_mfma_f32_16x16x32_bf16 v[168:171], a[244:247], a[36:39], v[168:171]
  ds_read_b64_tr_b16 v[216:217], v242 offset:8960
  ds_read_b64_tr_b16 v[218:219], v242 offset:13056
  buffer_load_dwordx4 v245, s[40:43], s69 offen offset:1024  lds
  v_mfma_f32_16x16x32_bf16 v[168:171], a[248:251], a[40:43], v[168:171]
  v_exp_f32 v175, v159
  v_mfma_f32_16x16x32_bf16 v[168:171], a[252:255], a[44:47], v[168:171]
  s_waitcnt lgkmcnt(4)
  v_cvt_pk_bf16_f32 v181, v174, v175
  v_mfma_f32_16x16x32_bf16 v[16:19], v[188:191], v[184:187], v[16:19]
  v_exp_f32 v176, v160
  v_mfma_f32_16x16x32_bf16 v[20:23], v[192:195], v[184:187], v[20:23]
  buffer_load_dwordx4 v246, s[40:43], s69 offen offset:2048  lds
  v_add_f32 v220, v220, v228
  v_mfma_f32_16x16x32_bf16 v[24:27], v[196:199], v[184:187], v[24:27]
  v_exp_f32 v177, v161
  v_mfma_f32_16x16x32_bf16 v[28:31], v[200:203], v[184:187], v[28:31]
  v_cvt_pk_bf16_f32 v182, v176, v177
  v_add_f32 v220, v220, v229
  v_mfma_f32_16x16x32_bf16 a[112:115], v[204:207], v[184:187], a[112:115]
  v_exp_f32 v178, v162
  v_mfma_f32_16x16x32_bf16 a[116:119], v[208:211], v[184:187], a[116:119]
  s_waitcnt lgkmcnt(0)
  buffer_load_dwordx4 v247, s[40:43], s69 offen offset:3072  lds
  v_mfma_f32_16x16x32_bf16 a[120:123], v[212:215], v[184:187], a[120:123]
  v_exp_f32 v179, v163
  v_mfma_f32_16x16x32_bf16 a[124:127], v[216:219], v[184:187], a[124:127]
  v_cvt_pk_bf16_f32 v183, v178, v179
  v_add_f32 v220, v220, v230
  v_add_f32 v220, v220, v231
  v_add_f32 v220, v220, v232
  v_add_f32 v220, v220, v233
  v_add_f32 v220, v220, v234
  v_add_f32 v220, v220, v235
  v_mfma_f32_16x16x32_bf16 v[156:159], a[224:227], a[48:51], v[140:143]
  v_exp_f32 v228, v164
  v_mfma_f32_16x16x32_bf16 v[156:159], a[228:231], a[52:55], v[156:159]
  v_add_u32 v237, s58, v5
  v_add_f32 v221, v221, v172
  v_mfma_f32_16x16x32_bf16 v[156:159], a[232:235], a[56:59], v[156:159]
  v_exp_f32 v229, v165
  v_mfma_f32_16x16x32_bf16 v[156:159], a[236:239], a[60:63], v[156:159]
  v_cvt_pk_bf16_f32 v184, v228, v229
  v_add_f32 v221, v221, v173
  v_mfma_f32_16x16x32_bf16 v[160:163], a[240:243], a[48:51], v[140:143]
  v_exp_f32 v230, v166
  v_mfma_f32_16x16x32_bf16 v[160:163], a[244:247], a[52:55], v[160:163]
  v_add_u32 v238, s59, v5
  v_add_f32 v221, v221, v174
  v_mfma_f32_16x16x32_bf16 v[160:163], a[248:251], a[56:59], v[160:163]
  v_exp_f32 v231, v167
  v_mfma_f32_16x16x32_bf16 v[160:163], a[252:255], a[60:63], v[160:163]
  v_cvt_pk_bf16_f32 v185, v230, v231
  v_add_f32 v221, v221, v175
  v_mfma_f32_16x16x32_bf16 v[32:35], v[188:191], v[180:183], v[32:35]
  v_exp_f32 v232, v168
  v_mfma_f32_16x16x32_bf16 v[36:39], v[192:195], v[180:183], v[36:39]
  v_add_f32 v221, v221, v176
  v_add_f32 v221, v221, v177
  v_mfma_f32_16x16x32_bf16 v[40:43], v[196:199], v[180:183], v[40:43]
  v_exp_f32 v233, v169
  v_mfma_f32_16x16x32_bf16 v[44:47], v[200:203], v[180:183], v[44:47]
  v_cvt_pk_bf16_f32 v186, v232, v233
  v_add_f32 v221, v221, v178
  v_mfma_f32_16x16x32_bf16 a[128:131], v[204:207], v[180:183], a[128:131]
  v_exp_f32 v234, v170
  v_mfma_f32_16x16x32_bf16 a[132:135], v[208:211], v[180:183], a[132:135]
  v_add_f32 v221, v221, v179
  v_add_f32 v222, v222, v228
  v_mfma_f32_16x16x32_bf16 a[136:139], v[212:215], v[180:183], a[136:139]
  v_exp_f32 v235, v171
  v_mfma_f32_16x16x32_bf16 a[140:143], v[216:219], v[180:183], a[140:143]
  v_cvt_pk_bf16_f32 v187, v234, v235
  v_add_f32 v222, v222, v229
  v_mfma_f32_16x16x32_bf16 v[164:167], a[224:227], a[64:67], v[144:147]
  s_add_u32 m0, s58, 4096
  s_xor_b32 s69, s1, 0x8000
  v_exp_f32 v172, v156
  v_mfma_f32_16x16x32_bf16 v[164:167], a[228:231], a[68:71], v[164:167]
  buffer_load_dwordx4 v244, s[40:43], s69 offen offset:0  lds
  v_add_f32 v222, v222, v230
  v_mfma_f32_16x16x32_bf16 v[164:167], a[232:235], a[72:75], v[164:167]
  v_exp_f32 v173, v157
  v_mfma_f32_16x16x32_bf16 v[164:167], a[236:239], a[76:79], v[164:167]
  v_cvt_pk_bf16_f32 v180, v172, v173
  v_add_f32 v222, v222, v231
  v_mfma_f32_16x16x32_bf16 v[168:171], a[240:243], a[64:67], v[144:147]
  v_exp_f32 v174, v158
  v_mfma_f32_16x16x32_bf16 v[168:171], a[244:247], a[68:71], v[168:171]
  buffer_load_dwordx4 v245, s[40:43], s69 offen offset:1024  lds
  v_add_f32 v222, v222, v232
  v_mfma_f32_16x16x32_bf16 v[168:171], a[248:251], a[72:75], v[168:171]
  v_exp_f32 v175, v159
  v_mfma_f32_16x16x32_bf16 v[168:171], a[252:255], a[76:79], v[168:171]
  v_cvt_pk_bf16_f32 v181, v174, v175
  v_add_f32 v222, v222, v233
  v_mfma_f32_16x16x32_bf16 v[48:51], v[188:191], v[184:187], v[48:51]
  v_exp_f32 v176, v160
  v_mfma_f32_16x16x32_bf16 v[52:55], v[192:195], v[184:187], v[52:55]
  buffer_load_dwordx4 v246, s[40:43], s69 offen offset:2048  lds
  v_add_f32 v222, v222, v234
  v_mfma_f32_16x16x32_bf16 v[56:59], v[196:199], v[184:187], v[56:59]
  v_exp_f32 v177, v161
  v_mfma_f32_16x16x32_bf16 v[60:63], v[200:203], v[184:187], v[60:63]
  v_cvt_pk_bf16_f32 v182, v176, v177
  v_add_f32 v222, v222, v235
  v_mfma_f32_16x16x32_bf16 a[144:147], v[204:207], v[184:187], a[144:147]
  v_exp_f32 v178, v162
  v_mfma_f32_16x16x32_bf16 a[148:151], v[208:211], v[184:187], a[148:151]
  buffer_load_dwordx4 v247, s[40:43], s69 offen offset:3072  lds
  v_add_f32 v223, v223, v172
  v_mfma_f32_16x16x32_bf16 a[152:155], v[212:215], v[184:187], a[152:155]
  v_exp_f32 v179, v163
  v_mfma_f32_16x16x32_bf16 a[156:159], v[216:219], v[184:187], a[156:159]
  v_cvt_pk_bf16_f32 v183, v178, v179
  v_add_f32 v223, v223, v173
  v_mfma_f32_16x16x32_bf16 v[156:159], a[224:227], a[80:83], v[148:151]
  v_exp_f32 v228, v164
  v_mfma_f32_16x16x32_bf16 v[156:159], a[228:231], a[84:87], v[156:159]
  s_and_b32 s65, s49, 1
  s_lshl_b32 s65, s65, 6
  s_lshr_b32 s61, s49, 1
  s_lshl_b32 s61, s61, 3
  v_mfma_f32_16x16x32_bf16 v[156:159], a[232:235], a[88:91], v[156:159]
  v_exp_f32 v229, v165
  v_mfma_f32_16x16x32_bf16 v[156:159], a[236:239], a[92:95], v[156:159]
  v_cvt_pk_bf16_f32 v184, v228, v229
  s_add_u32 s65, s65, s61
  s_lshr_b32 s61, s50, 2
  s_add_u32 s65, s65, s61
  s_lshl_b32 s65, s65, 7
  v_mfma_f32_16x16x32_bf16 v[160:163], a[240:243], a[80:83], v[148:151]
  v_exp_f32 v230, v166
  v_mfma_f32_16x16x32_bf16 v[160:163], a[244:247], a[84:87], v[160:163]
  s_and_b32 s61, s50, 3
  s_lshl_b32 s61, s61, 2
  s_add_u32 s65, s65, s61
  s_add_u32 s65, s65, 0x1000000
  v_mfma_f32_16x16x32_bf16 v[160:163], a[248:251], a[88:91], v[160:163]
  v_exp_f32 v231, v167
  v_mfma_f32_16x16x32_bf16 v[160:163], a[252:255], a[92:95], v[160:163]
  v_cvt_pk_bf16_f32 v185, v230, v231
  v_lshrrev_b32 v239, 1, v1
  v_lshlrev_b32 v239, 14, v239
  v_and_b32 v3, 1, v1
  v_lshl_add_u32 v239, v3, 12, v239
  v_mfma_f32_16x16x32_bf16 v[64:67], v[188:191], v[180:183], v[64:67]
  v_exp_f32 v232, v168
  v_mfma_f32_16x16x32_bf16 v[68:71], v[192:195], v[180:183], v[68:71]
  v_add_u32 v239, s65, v239
  s_xor_b32 s65, s2, 1
  s_lshl_b32 s65, s65, 9
  s_add_u32 s65, s65, 0x1000010
  v_mfma_f32_16x16x32_bf16 v[72:75], v[196:199], v[180:183], v[72:75]
  v_exp_f32 v233, v169
  v_mfma_f32_16x16x32_bf16 v[76:79], v[200:203], v[180:183], v[76:79]
  v_cvt_pk_bf16_f32 v186, v232, v233
  v_and_b32 v3, 3, v1
  v_lshlrev_b32 v3, 7, v3
  v_cmp_gt_u32 vcc, 16, v1
  v_add_u32 v3, s65, v3
  v_mfma_f32_16x16x32_bf16 a[160:163], v[204:207], v[180:183], a[160:163]
  v_exp_f32 v234, v170
  v_mfma_f32_16x16x32_bf16 a[164:167], v[208:211], v[180:183], a[164:167]
  s_waitcnt vmcnt(20)
  s_nop 0
  v_cndmask_b32 v239, v3, v239, vcc
  v_mfma_f32_16x16x32_bf16 a[168:171], v[212:215], v[180:183], a[168:171]
  v_exp_f32 v235, v171
  v_mfma_f32_16x16x32_bf16 a[172:175], v[216:219], v[180:183], a[172:175]
  v_cvt_pk_bf16_f32 v187, v234, v235
  v_add_f32 v223, v223, v174
  v_add_f32 v223, v223, v175
  v_add_f32 v223, v223, v176
  v_add_f32 v223, v223, v177
  v_add_f32 v223, v223, v178
  v_add_f32 v223, v223, v179
  v_add_f32 v224, v224, v228
  v_add_f32 v224, v224, v229
  v_add_f32 v224, v224, v230
  v_add_f32 v224, v224, v231
  v_add_f32 v224, v224, v232
  v_add_f32 v224, v224, v233
  v_add_f32 v224, v224, v234
  v_add_f32 v224, v224, v235
  v_mfma_f32_16x16x32_bf16 v[164:167], a[224:227], a[96:99], v[152:155]
  s_barrier
  v_exp_f32 v172, v156
  v_mfma_f32_16x16x32_bf16 v[164:167], a[228:231], a[100:103], v[164:167]
  ds_read_b128 a[224:227], v240 offset:16384
  ds_read_b128 a[228:231], v240 offset:16640
  v_mfma_f32_16x16x32_bf16 v[164:167], a[232:235], a[104:107], v[164:167]
  v_exp_f32 v173, v157
  v_mfma_f32_16x16x32_bf16 v[164:167], a[236:239], a[108:111], v[164:167]
  ds_read_b128 a[232:235], v240 offset:16896
  v_cvt_pk_bf16_f32 v180, v172, v173
  v_mfma_f32_16x16x32_bf16 v[168:171], a[240:243], a[96:99], v[152:155]
  v_exp_f32 v174, v158
  v_mfma_f32_16x16x32_bf16 v[168:171], a[244:247], a[100:103], v[168:171]
  ds_read_b128 a[236:239], v240 offset:17152
  ds_read_b128 a[240:243], v240 offset:20480
  v_mfma_f32_16x16x32_bf16 v[168:171], a[248:251], a[104:107], v[168:171]
  v_exp_f32 v175, v159
  v_mfma_f32_16x16x32_bf16 v[168:171], a[252:255], a[108:111], v[168:171]
  ds_read_b128 a[244:247], v240 offset:20736
  v_cvt_pk_bf16_f32 v181, v174, v175
  v_mfma_f32_16x16x32_bf16 v[80:83], v[188:191], v[184:187], v[80:83]
  v_exp_f32 v176, v160
  v_mfma_f32_16x16x32_bf16 v[84:87], v[192:195], v[184:187], v[84:87]
  ds_read_b128 a[248:251], v240 offset:20992
  ds_read_b128 a[252:255], v240 offset:21248
  v_mfma_f32_16x16x32_bf16 v[88:91], v[196:199], v[184:187], v[88:91]
  v_exp_f32 v177, v161
  v_mfma_f32_16x16x32_bf16 v[92:95], v[200:203], v[184:187], v[92:95]
  v_cvt_pk_bf16_f32 v182, v176, v177
  v_add_f32 v225, v225, v172
  v_mfma_f32_16x16x32_bf16 a[176:179], v[204:207], v[184:187], a[176:179]
  v_exp_f32 v178, v162
  v_mfma_f32_16x16x32_bf16 a[180:183], v[208:211], v[184:187], a[180:183]
  v_add_f32 v225, v225, v173
  v_add_f32 v225, v225, v174
  v_mfma_f32_16x16x32_bf16 a[184:187], v[212:215], v[184:187], a[184:187]
  v_exp_f32 v179, v163
  v_mfma_f32_16x16x32_bf16 a[188:191], v[216:219], v[184:187], a[188:191]
  s_waitcnt lgkmcnt(0)
  v_cvt_pk_bf16_f32 v183, v178, v179
  v_mfma_f32_16x16x32_bf16 v[156:159], a[224:227], a[0:3], v[128:131]
  s_add_u32 m0, s60, 4096
  s_xor_b32 s69, s1, 0x38000
  v_exp_f32 v228, v164
  v_mfma_f32_16x16x32_bf16 v[156:159], a[228:231], a[4:7], v[156:159]
  buffer_load_dwordx4 v244, s[40:43], s69 offen offset:0  lds
  v_add_f32 v225, v225, v175
  v_mfma_f32_16x16x32_bf16 v[156:159], a[232:235], a[8:11], v[156:159]
  v_exp_f32 v229, v165
  v_mfma_f32_16x16x32_bf16 v[156:159], a[236:239], a[12:15], v[156:159]
  v_cvt_pk_bf16_f32 v184, v228, v229
  v_add_f32 v225, v225, v176
  v_mfma_f32_16x16x32_bf16 v[160:163], a[240:243], a[0:3], v[128:131]
  v_exp_f32 v230, v166
  v_mfma_f32_16x16x32_bf16 v[160:163], a[244:247], a[4:7], v[160:163]
  buffer_load_dwordx4 v245, s[40:43], s69 offen offset:1024  lds
  v_add_f32 v225, v225, v177
  v_mfma_f32_16x16x32_bf16 v[160:163], a[248:251], a[8:11], v[160:163]
  v_exp_f32 v231, v167
  v_mfma_f32_16x16x32_bf16 v[160:163], a[252:255], a[12:15], v[160:163]
  v_cvt_pk_bf16_f32 v185, v230, v231
  v_add_f32 v225, v225, v178
  v_mfma_f32_16x16x32_bf16 v[96:99], v[188:191], v[180:183], v[96:99]
  v_exp_f32 v232, v168
  v_mfma_f32_16x16x32_bf16 v[100:103], v[192:195], v[180:183], v[100:103]
  buffer_load_dwordx4 v246, s[40:43], s69 offen offset:2048  lds
  v_add_f32 v225, v225, v179
  v_mfma_f32_16x16x32_bf16 v[104:107], v[196:199], v[180:183], v[104:107]
  v_exp_f32 v233, v169
  v_mfma_f32_16x16x32_bf16 v[108:111], v[200:203], v[180:183], v[108:111]
  v_cvt_pk_bf16_f32 v186, v232, v233
  v_add_f32 v226, v226, v228
  v_mfma_f32_16x16x32_bf16 a[192:195], v[204:207], v[180:183], a[192:195]
  v_exp_f32 v234, v170
  v_mfma_f32_16x16x32_bf16 a[196:199], v[208:211], v[180:183], a[196:199]
  buffer_load_dwordx4 v247, s[40:43], s69 offen offset:3072  lds
  v_add_f32 v226, v226, v229
  v_mfma_f32_16x16x32_bf16 a[200:203], v[212:215], v[180:183], a[200:203]
  v_exp_f32 v235, v171
  v_mfma_f32_16x16x32_bf16 a[204:207], v[216:219], v[180:183], a[204:207]
  v_cvt_pk_bf16_f32 v187, v234, v235
  v_add_f32 v226, v226, v230
  v_mfma_f32_16x16x32_bf16 v[164:167], a[224:227], a[16:19], v[132:135]
  s_add_u32 m0, s58, 8192
  s_xor_b32 s69, s1, 0x10000
  v_exp_f32 v172, v156
  v_mfma_f32_16x16x32_bf16 v[164:167], a[228:231], a[20:23], v[164:167]
  buffer_load_dwordx4 v244, s[40:43], s69 offen offset:0  lds
  v_add_f32 v226, v226, v231
  v_mfma_f32_16x16x32_bf16 v[164:167], a[232:235], a[24:27], v[164:167]
  v_exp_f32 v173, v157
  v_mfma_f32_16x16x32_bf16 v[164:167], a[236:239], a[28:31], v[164:167]
  buffer_load_dwordx4 v245, s[40:43], s69 offen offset:1024  lds
  v_cvt_pk_bf16_f32 v180, v172, v173
  v_mfma_f32_16x16x32_bf16 v[168:171], a[240:243], a[16:19], v[132:135]
  v_exp_f32 v174, v158
  v_mfma_f32_16x16x32_bf16 v[168:171], a[244:247], a[20:23], v[168:171]
  buffer_load_dwordx4 v246, s[40:43], s69 offen offset:2048  lds
  v_add_f32 v226, v226, v232
  v_mfma_f32_16x16x32_bf16 v[168:171], a[248:251], a[24:27], v[168:171]
  v_exp_f32 v175, v159
  v_mfma_f32_16x16x32_bf16 v[168:171], a[252:255], a[28:31], v[168:171]
  buffer_load_dwordx4 v247, s[40:43], s69 offen offset:3072  lds
  v_cvt_pk_bf16_f32 v181, v174, v175
  v_mfma_f32_16x16x32_bf16 v[112:115], v[188:191], v[184:187], v[112:115]
  v_exp_f32 v176, v160
  v_mfma_f32_16x16x32_bf16 v[116:119], v[192:195], v[184:187], v[116:119]
  ds_read_b64_tr_b16 v[188:189], v241 offset:16384
  ds_read_b64_tr_b16 v[190:191], v241 offset:20480
  ds_read_b64_tr_b16 v[192:193], v242 offset:16384
  v_mfma_f32_16x16x32_bf16 v[120:123], v[196:199], v[184:187], v[120:123]
  v_exp_f32 v177, v161
  v_mfma_f32_16x16x32_bf16 v[124:127], v[200:203], v[184:187], v[124:127]
  ds_read_b64_tr_b16 v[194:195], v242 offset:20480
  ds_read_b64_tr_b16 v[196:197], v241 offset:16640
  v_cvt_pk_bf16_f32 v182, v176, v177
  v_mfma_f32_16x16x32_bf16 a[208:211], v[204:207], v[184:187], a[208:211]
  v_exp_f32 v178, v162
  v_mfma_f32_16x16x32_bf16 a[212:215], v[208:211], v[184:187], a[212:215]
  ds_read_b64_tr_b16 v[198:199], v241 offset:20736
  ds_read_b64_tr_b16 v[200:201], v242 offset:16640
  ds_read_b64_tr_b16 v[202:203], v242 offset:20736
  v_mfma_f32_16x16x32_bf16 a[216:219], v[212:215], v[184:187], a[216:219]
  v_exp_f32 v179, v163
  v_mfma_f32_16x16x32_bf16 a[220:223], v[216:219], v[184:187], a[220:223]
  ds_read_b64_tr_b16 v[204:205], v241 offset:16896
  ds_read_b64_tr_b16 v[206:207], v241 offset:20992
  v_cvt_pk_bf16_f32 v183, v178, v179
  v_add_f32 v226, v226, v233
  v_add_f32 v226, v226, v234
  v_add_f32 v226, v226, v235
  v_mfma_f32_16x16x32_bf16 v[156:159], a[224:227], a[32:35], v[136:139]
  v_exp_f32 v228, v164
  v_mfma_f32_16x16x32_bf16 v[156:159], a[228:231], a[36:39], v[156:159]
  ds_read_b64_tr_b16 v[208:209], v242 offset:16896
  ds_read_b64_tr_b16 v[210:211], v242 offset:20992
  v_mfma_f32_16x16x32_bf16 v[156:159], a[232:235], a[40:43], v[156:159]
  v_exp_f32 v229, v165
  v_mfma_f32_16x16x32_bf16 v[156:159], a[236:239], a[44:47], v[156:159]
  ds_read_b64_tr_b16 v[212:213], v241 offset:17152
  ds_read_b64_tr_b16 v[214:215], v241 offset:21248
  v_cvt_pk_bf16_f32 v184, v228, v229
  v_mfma_f32_16x16x32_bf16 v[160:163], a[240:243], a[32:35], v[136:139]
  v_exp_f32 v230, v166
  v_mfma_f32_16x16x32_bf16 v[160:163], a[244:247], a[36:39], v[160:163]
  ds_read_b64_tr_b16 v[216:217], v242 offset:17152
  ds_read_b64_tr_b16 v[218:219], v242 offset:21248
  v_mfma_f32_16x16x32_bf16 v[160:163], a[248:251], a[40:43], v[160:163]
  v_exp_f32 v231, v167
  v_mfma_f32_16x16x32_bf16 v[160:163], a[252:255], a[44:47], v[160:163]
  s_waitcnt lgkmcnt(4)
  v_cvt_pk_bf16_f32 v185, v230, v231
  v_mfma_f32_16x16x32_bf16 v[16:19], v[188:191], v[180:183], v[16:19]
  v_exp_f32 v232, v168
  v_mfma_f32_16x16x32_bf16 v[20:23], v[192:195], v[180:183], v[20:23]
  s_lshr_b32 s65, s1, 6
  v_add_f32 v220, v220, v172
  v_mfma_f32_16x16x32_bf16 v[24:27], v[196:199], v[180:183], v[24:27]
  v_exp_f32 v233, v169
  v_mfma_f32_16x16x32_bf16 v[28:31], v[200:203], v[180:183], v[28:31]
  v_cvt_pk_bf16_f32 v186, v232, v233
  v_add_u32 v248, s65, v5
  v_mfma_f32_16x16x32_bf16 a[112:115], v[204:207], v[180:183], a[112:115]
  v_exp_f32 v234, v170
  v_mfma_f32_16x16x32_bf16 a[116:119], v[208:211], v[180:183], a[116:119]
  s_waitcnt lgkmcnt(0)
  v_add_u32 v254, 1, v254
  v_mfma_f32_16x16x32_bf16 a[120:123], v[212:215], v[180:183], a[120:123]
  v_exp_f32 v235, v171
  v_mfma_f32_16x16x32_bf16 a[124:127], v[216:219], v[180:183], a[124:127]
  v_cvt_pk_bf16_f32 v187, v234, v235
  v_add_f32 v220, v220, v173
  v_add_f32 v220, v220, v174
  v_add_f32 v220, v220, v175
  v_add_f32 v220, v220, v176
  v_add_f32 v220, v220, v177
  v_add_f32 v220, v220, v178
  v_add_f32 v220, v220, v179
  v_mfma_f32_16x16x32_bf16 v[164:167], a[224:227], a[48:51], v[140:143]
  s_add_u32 m0, s58, 12288
  s_xor_b32 s69, s1, 0x18000
  v_exp_f32 v172, v156
  v_mfma_f32_16x16x32_bf16 v[164:167], a[228:231], a[52:55], v[164:167]
  buffer_load_dwordx4 v244, s[40:43], s69 offen offset:0  lds
  v_add_f32 v221, v221, v228
  v_mfma_f32_16x16x32_bf16 v[164:167], a[232:235], a[56:59], v[164:167]
  v_exp_f32 v173, v157
  v_mfma_f32_16x16x32_bf16 v[164:167], a[236:239], a[60:63], v[164:167]
  v_cvt_pk_bf16_f32 v180, v172, v173
  v_add_f32 v221, v221, v229
  v_mfma_f32_16x16x32_bf16 v[168:171], a[240:243], a[48:51], v[140:143]
  v_exp_f32 v174, v158
  v_mfma_f32_16x16x32_bf16 v[168:171], a[244:247], a[52:55], v[168:171]
  buffer_load_dwordx4 v245, s[40:43], s69 offen offset:1024  lds
  v_add_f32 v221, v221, v230
  v_mfma_f32_16x16x32_bf16 v[168:171], a[248:251], a[56:59], v[168:171]
  v_exp_f32 v175, v159
  v_mfma_f32_16x16x32_bf16 v[168:171], a[252:255], a[60:63], v[168:171]
  v_cvt_pk_bf16_f32 v181, v174, v175
  v_add_f32 v221, v221, v231
  v_mfma_f32_16x16x32_bf16 v[32:35], v[188:191], v[184:187], v[32:35]
  v_exp_f32 v176, v160
  v_mfma_f32_16x16x32_bf16 v[36:39], v[192:195], v[184:187], v[36:39]
  buffer_load_dwordx4 v246, s[40:43], s69 offen offset:2048  lds
  v_add_f32 v221, v221, v232
  v_mfma_f32_16x16x32_bf16 v[40:43], v[196:199], v[184:187], v[40:43]
  v_exp_f32 v177, v161
  v_mfma_f32_16x16x32_bf16 v[44:47], v[200:203], v[184:187], v[44:47]
  v_cvt_pk_bf16_f32 v182, v176, v177
  v_add_f32 v221, v221, v233
  v_mfma_f32_16x16x32_bf16 a[128:131], v[204:207], v[184:187], a[128:131]
  v_exp_f32 v178, v162
  v_mfma_f32_16x16x32_bf16 a[132:135], v[208:211], v[184:187], a[132:135]
  buffer_load_dwordx4 v247, s[40:43], s69 offen offset:3072  lds
  v_add_f32 v221, v221, v234
  v_mfma_f32_16x16x32_bf16 a[136:139], v[212:215], v[184:187], a[136:139]
  v_exp_f32 v179, v163
  v_mfma_f32_16x16x32_bf16 a[140:143], v[216:219], v[184:187], a[140:143]
  v_cvt_pk_bf16_f32 v183, v178, v179
  v_add_f32 v221, v221, v235
  v_mfma_f32_16x16x32_bf16 v[156:159], a[224:227], a[64:67], v[144:147]
  v_exp_f32 v228, v164
  v_mfma_f32_16x16x32_bf16 v[156:159], a[228:231], a[68:71], v[156:159]
  v_min_u32 v2, L_end-L_epi-4, v0
  v_add_f32 v222, v222, v172
  v_mfma_f32_16x16x32_bf16 v[156:159], a[232:235], a[72:75], v[156:159]
  v_exp_f32 v229, v165
  v_mfma_f32_16x16x32_bf16 v[156:159], a[236:239], a[76:79], v[156:159]
  v_cvt_pk_bf16_f32 v184, v228, v229
  v_add_u32 v2, L_epi-L_pc, v2
  v_mfma_f32_16x16x32_bf16 v[160:163], a[240:243], a[64:67], v[144:147]
  v_exp_f32 v230, v166
  v_mfma_f32_16x16x32_bf16 v[160:163], a[244:247], a[68:71], v[160:163]
  v_mov_b32 v3, s83
  v_add_f32 v222, v222, v173
  v_mfma_f32_16x16x32_bf16 v[160:163], a[248:251], a[72:75], v[160:163]
  v_exp_f32 v231, v167
  v_mfma_f32_16x16x32_bf16 v[160:163], a[252:255], a[76:79], v[160:163]
  v_cvt_pk_bf16_f32 v185, v230, v231
  v_add_co_u32 v2, vcc, s82, v2
  v_mfma_f32_16x16x32_bf16 v[48:51], v[188:191], v[180:183], v[48:51]
  v_exp_f32 v232, v168
  v_mfma_f32_16x16x32_bf16 v[52:55], v[192:195], v[180:183], v[52:55]
  s_nop 1
  v_add_f32 v222, v222, v174
  v_mfma_f32_16x16x32_bf16 v[56:59], v[196:199], v[180:183], v[56:59]
  v_exp_f32 v233, v169
  v_mfma_f32_16x16x32_bf16 v[60:63], v[200:203], v[180:183], v[60:63]
  v_cvt_pk_bf16_f32 v186, v232, v233
  v_addc_co_u32 v3, vcc, 0, v3, vcc
  v_mfma_f32_16x16x32_bf16 a[144:147], v[204:207], v[180:183], a[144:147]
  v_exp_f32 v234, v170
  v_mfma_f32_16x16x32_bf16 a[148:151], v[208:211], v[180:183], a[148:151]
  v_add_f32 v222, v222, v175
  v_add_f32 v222, v222, v176
  v_mfma_f32_16x16x32_bf16 a[152:155], v[212:215], v[180:183], a[152:155]
  v_exp_f32 v235, v171
  v_mfma_f32_16x16x32_bf16 a[156:159], v[216:219], v[180:183], a[156:159]
  global_load_dword v253, v[2:3], off
  v_cvt_pk_bf16_f32 v187, v234, v235
  v_add_f32 v222, v222, v177
  v_add_f32 v222, v222, v178
  v_add_f32 v222, v222, v179
  v_mfma_f32_16x16x32_bf16 v[164:167], a[224:227], a[80:83], v[148:151]
  v_exp_f32 v172, v156
  v_mfma_f32_16x16x32_bf16 v[164:167], a[228:231], a[84:87], v[164:167]
  s_lshl_b32 s65, s2, 2
  s_add_u32 s65, s65, s48
  v_mfma_f32_16x16x32_bf16 v[164:167], a[232:235], a[88:91], v[164:167]
  v_exp_f32 v173, v157
  v_mfma_f32_16x16x32_bf16 v[164:167], a[236:239], a[92:95], v[164:167]
  v_cvt_pk_bf16_f32 v180, v172, v173
  s_lshl_b32 s65, s65, 7
  s_add_u32 s65, s65, 0x1000000
  v_mfma_f32_16x16x32_bf16 v[168:171], a[240:243], a[80:83], v[148:151]
  v_exp_f32 v174, v158
  v_mfma_f32_16x16x32_bf16 v[168:171], a[244:247], a[84:87], v[168:171]
  v_min_u32 v252, 5, v1
  v_lshlrev_b32 v252, 2, v252
  v_mfma_f32_16x16x32_bf16 v[168:171], a[248:251], a[88:91], v[168:171]
  v_exp_f32 v175, v159
  v_mfma_f32_16x16x32_bf16 v[168:171], a[252:255], a[92:95], v[168:171]
  v_cvt_pk_bf16_f32 v181, v174, v175
  v_add_u32 v252, s65, v252
  v_mfma_f32_16x16x32_bf16 v[64:67], v[188:191], v[184:187], v[64:67]
  v_exp_f32 v176, v160
  v_mfma_f32_16x16x32_bf16 v[68:71], v[192:195], v[184:187], v[68:71]
  v_add_f32 v223, v223, v228
  v_add_f32 v223, v223, v229
  v_mfma_f32_16x16x32_bf16 v[72:75], v[196:199], v[184:187], v[72:75]
  v_exp_f32 v177, v161
  v_mfma_f32_16x16x32_bf16 v[76:79], v[200:203], v[184:187], v[76:79]
  v_cvt_pk_bf16_f32 v182, v176, v177
  s_mov_b64 exec, 64
  v_xor_b32 v252, 0x200, v252
  s_mov_b64 exec, -1
  v_mfma_f32_16x16x32_bf16 a[160:163], v[204:207], v[184:187], a[160:163]
  v_exp_f32 v178, v162
  v_mfma_f32_16x16x32_bf16 a[164:167], v[208:211], v[184:187], a[164:167]
  s_waitcnt vmcnt(25)
  v_add_f32 v223, v223, v230
  v_mfma_f32_16x16x32_bf16 a[168:171], v[212:215], v[184:187], a[168:171]
  v_exp_f32 v179, v163
  v_mfma_f32_16x16x32_bf16 a[172:175], v[216:219], v[184:187], a[172:175]
  v_cvt_pk_bf16_f32 v183, v178, v179
  v_add_f32 v223, v223, v231
  v_add_f32 v223, v223, v232
  v_add_f32 v223, v223, v233
  v_add_f32 v223, v223, v234
  v_add_f32 v223, v223, v235
  v_add_f32 v224, v224, v172
  v_add_f32 v224, v224, v173
  v_add_f32 v224, v224, v174
  v_add_f32 v224, v224, v175
  v_add_f32 v224, v224, v176
  v_add_f32 v224, v224, v177
  v_add_f32 v224, v224, v178
  v_add_f32 v224, v224, v179
  v_mfma_f32_16x16x32_bf16 v[156:159], a[224:227], a[96:99], v[152:155]
  s_barrier
  v_exp_f32 v228, v164
  v_mfma_f32_16x16x32_bf16 v[156:159], a[228:231], a[100:103], v[156:159]
  ds_read_b128 a[224:227], v240 offset:24576
  ds_read_b128 a[228:231], v240 offset:24832
  v_mfma_f32_16x16x32_bf16 v[156:159], a[232:235], a[104:107], v[156:159]
  v_exp_f32 v229, v165
  v_mfma_f32_16x16x32_bf16 v[156:159], a[236:239], a[108:111], v[156:159]
  ds_read_b128 a[232:235], v240 offset:25088
  v_cvt_pk_bf16_f32 v184, v228, v229
  v_mfma_f32_16x16x32_bf16 v[160:163], a[240:243], a[96:99], v[152:155]
  v_exp_f32 v230, v166
  v_mfma_f32_16x16x32_bf16 v[160:163], a[244:247], a[100:103], v[160:163]
  ds_read_b128 a[236:239], v240 offset:25344
  ds_read_b128 a[240:243], v240 offset:28672
  v_mfma_f32_16x16x32_bf16 v[160:163], a[248:251], a[104:107], v[160:163]
  v_exp_f32 v231, v167
  v_mfma_f32_16x16x32_bf16 v[160:163], a[252:255], a[108:111], v[160:163]
  ds_read_b128 a[244:247], v240 offset:28928
  v_cvt_pk_bf16_f32 v185, v230, v231
  v_mfma_f32_16x16x32_bf16 v[80:83], v[188:191], v[180:183], v[80:83]
  s_add_u32 m0, s58, 16384
  s_xor_b32 s69, s1, 0x20000
  v_exp_f32 v232, v168
  v_mfma_f32_16x16x32_bf16 v[84:87], v[192:195], v[180:183], v[84:87]
  buffer_load_dwordx4 v244, s[40:43], s69 offen offset:0  lds
  ds_read_b128 a[248:251], v240 offset:29184
  ds_read_b128 a[252:255], v240 offset:29440
  v_mfma_f32_16x16x32_bf16 v[88:91], v[196:199], v[180:183], v[88:91]
  v_exp_f32 v233, v169
  v_mfma_f32_16x16x32_bf16 v[92:95], v[200:203], v[180:183], v[92:95]
  buffer_load_dwordx4 v245, s[40:43], s69 offen offset:1024  lds
  v_cvt_pk_bf16_f32 v186, v232, v233
  v_mfma_f32_16x16x32_bf16 a[176:179], v[204:207], v[180:183], a[176:179]
  v_exp_f32 v234, v170
  v_mfma_f32_16x16x32_bf16 a[180:183], v[208:211], v[180:183], a[180:183]
  buffer_load_dwordx4 v246, s[40:43], s69 offen offset:2048  lds
  v_add_f32 v225, v225, v228
  v_mfma_f32_16x16x32_bf16 a[184:187], v[212:215], v[180:183], a[184:187]
  v_exp_f32 v235, v171
  v_mfma_f32_16x16x32_bf16 a[188:191], v[216:219], v[180:183], a[188:191]
  s_waitcnt lgkmcnt(0)
  buffer_load_dwordx4 v247, s[40:43], s69 offen offset:3072  lds
  v_cvt_pk_bf16_f32 v187, v234, v235
  v_mfma_f32_16x16x32_bf16 v[164:167], a[224:227], a[0:3], v[128:131]
  v_exp_f32 v172, v156
  v_mfma_f32_16x16x32_bf16 v[164:167], a[228:231], a[4:7], v[164:167]
  v_add_f32 v225, v225, v229
  v_add_f32 v225, v225, v230
  v_mfma_f32_16x16x32_bf16 v[164:167], a[232:235], a[8:11], v[164:167]
  v_exp_f32 v173, v157
  v_mfma_f32_16x16x32_bf16 v[164:167], a[236:239], a[12:15], v[164:167]
  v_cvt_pk_bf16_f32 v180, v172, v173
  v_add_f32 v225, v225, v231
  v_mfma_f32_16x16x32_bf16 v[168:171], a[240:243], a[0:3], v[128:131]
  v_exp_f32 v174, v158
  v_mfma_f32_16x16x32_bf16 v[168:171], a[244:247], a[4:7], v[168:171]
  v_add_f32 v225, v225, v232
  v_add_f32 v225, v225, v233
  v_mfma_f32_16x16x32_bf16 v[168:171], a[248:251], a[8:11], v[168:171]
  v_exp_f32 v175, v159
  v_mfma_f32_16x16x32_bf16 v[168:171], a[252:255], a[12:15], v[168:171]
  v_cvt_pk_bf16_f32 v181, v174, v175
  v_add_f32 v225, v225, v234
  v_mfma_f32_16x16x32_bf16 v[96:99], v[188:191], v[184:187], v[96:99]
  v_exp_f32 v176, v160
  v_mfma_f32_16x16x32_bf16 v[100:103], v[192:195], v[184:187], v[100:103]
  v_add_f32 v225, v225, v235
  v_add_f32 v226, v226, v172
  v_mfma_f32_16x16x32_bf16 v[104:107], v[196:199], v[184:187], v[104:107]
  v_exp_f32 v177, v161
  v_mfma_f32_16x16x32_bf16 v[108:111], v[200:203], v[184:187], v[108:111]
  v_cvt_pk_bf16_f32 v182, v176, v177
  v_add_f32 v226, v226, v173
  v_mfma_f32_16x16x32_bf16 a[192:195], v[204:207], v[184:187], a[192:195]
  v_exp_f32 v178, v162
  v_mfma_f32_16x16x32_bf16 a[196:199], v[208:211], v[184:187], a[196:199]
  v_add_f32 v226, v226, v174
  v_add_f32 v226, v226, v175
  v_mfma_f32_16x16x32_bf16 a[200:203], v[212:215], v[184:187], a[200:203]
  v_exp_f32 v179, v163
  v_mfma_f32_16x16x32_bf16 a[204:207], v[216:219], v[184:187], a[204:207]
  v_cvt_pk_bf16_f32 v183, v178, v179
  v_add_f32 v226, v226, v176
  v_add_f32 v226, v226, v177
  v_add_f32 v226, v226, v178
  v_add_f32 v226, v226, v179
  v_mfma_f32_16x16x32_bf16 v[156:159], a[224:227], a[16:19], v[132:135]
  s_add_u32 m0, s58, 20480
  s_xor_b32 s69, s1, 0x28000
  s_waitcnt vmcnt(25)
  s_waitcnt vmcnt(17)
  ds_read_b64_tr_b16 a[0:1], v10 offset:0
  v_exp_f32 v172, v164
  v_mfma_f32_16x16x32_bf16 v[156:159], a[228:231], a[20:23], v[156:159]
  buffer_load_dwordx4 v244, s[40:43], s69 offen offset:0  lds
  ds_read_b64_tr_b16 a[2:3], v10 offset:4096
  v_add_f32 v220, v220, v172
  v_mfma_f32_16x16x32_bf16 v[156:159], a[232:235], a[24:27], v[156:159]
  ds_read_b64_tr_b16 a[4:5], v11 offset:0
  v_exp_f32 v173, v165
  v_mfma_f32_16x16x32_bf16 v[156:159], a[236:239], a[28:31], v[156:159]
  buffer_load_dwordx4 v245, s[40:43], s69 offen offset:1024  lds
  ds_read_b64_tr_b16 a[6:7], v11 offset:4096
  v_add_f32 v220, v220, v173
  v_cvt_pk_bf16_f32 v184, v172, v173
  v_mfma_f32_16x16x32_bf16 v[160:163], a[240:243], a[16:19], v[132:135]
  ds_read_b64_tr_b16 a[8:9], v10 offset:256
  v_exp_f32 v174, v166
  v_mfma_f32_16x16x32_bf16 v[160:163], a[244:247], a[20:23], v[160:163]
  buffer_load_dwordx4 v246, s[40:43], s69 offen offset:2048  lds
  ds_read_b64_tr_b16 a[10:11], v10 offset:4352
  v_add_f32 v220, v220, v174
  v_mfma_f32_16x16x32_bf16 v[160:163], a[248:251], a[24:27], v[160:163]
  ds_read_b64_tr_b16 a[12:13], v11 offset:256
  v_exp_f32 v175, v167
  v_mfma_f32_16x16x32_bf16 v[160:163], a[252:255], a[28:31], v[160:163]
  buffer_load_dwordx4 v247, s[40:43], s69 offen offset:3072  lds
  ds_read_b64_tr_b16 a[14:15], v11 offset:4352
  v_add_f32 v220, v220, v175
  v_cvt_pk_bf16_f32 v185, v174, v175
  v_mfma_f32_16x16x32_bf16 v[112:115], v[188:191], v[180:183], v[112:115]
  ds_read_b64_tr_b16 v[188:189], v241 offset:24576
  ds_read_b64_tr_b16 v[190:191], v241 offset:28672
  v_exp_f32 v176, v168
  v_mfma_f32_16x16x32_bf16 v[116:119], v[192:195], v[180:183], v[116:119]
  ds_read_b64_tr_b16 v[192:193], v242 offset:24576
  ds_read_b64_tr_b16 v[194:195], v242 offset:28672
  v_add_f32 v220, v220, v176
  v_mfma_f32_16x16x32_bf16 v[120:123], v[196:199], v[180:183], v[120:123]
  ds_read_b64_tr_b16 v[196:197], v241 offset:24832
  ds_read_b64_tr_b16 v[198:199], v241 offset:28928
  v_exp_f32 v177, v169
  v_mfma_f32_16x16x32_bf16 v[124:127], v[200:203], v[180:183], v[124:127]
  ds_read_b64_tr_b16 v[200:201], v242 offset:24832
  ds_read_b64_tr_b16 v[202:203], v242 offset:28928
  v_add_f32 v220, v220, v177
  v_cvt_pk_bf16_f32 v186, v176, v177
  v_mfma_f32_16x16x32_bf16 a[208:211], v[204:207], v[180:183], a[208:211]
  ds_read_b64_tr_b16 v[204:205], v241 offset:25088
  ds_read_b64_tr_b16 v[206:207], v241 offset:29184
  v_exp_f32 v178, v170
  v_mfma_f32_16x16x32_bf16 a[212:215], v[208:211], v[180:183], a[212:215]
  ds_read_b64_tr_b16 v[208:209], v242 offset:25088
  ds_read_b64_tr_b16 v[210:211], v242 offset:29184
  v_add_f32 v220, v220, v178
  v_mfma_f32_16x16x32_bf16 a[216:219], v[212:215], v[180:183], a[216:219]
  ds_read_b64_tr_b16 v[212:213], v241 offset:25344
  ds_read_b64_tr_b16 v[214:215], v241 offset:29440
  v_exp_f32 v179, v171
  v_mfma_f32_16x16x32_bf16 a[220:223], v[216:219], v[180:183], a[220:223]
  ds_read_b64_tr_b16 v[216:217], v242 offset:25344
  ds_read_b64_tr_b16 v[218:219], v242 offset:29440
  v_add_f32 v220, v220, v179
  v_cvt_pk_bf16_f32 v187, v178, v179
  v_mfma_f32_16x16x32_bf16 v[164:167], a[224:227], a[32:35], v[136:139]
  ds_read_b64_tr_b16 a[16:17], v10 offset:512
  v_exp_f32 v172, v156
  v_mfma_f32_16x16x32_bf16 v[164:167], a[228:231], a[36:39], v[164:167]
  ds_read_b64_tr_b16 a[18:19], v10 offset:4608
  v_add_f32 v221, v221, v172
  v_mfma_f32_16x16x32_bf16 v[164:167], a[232:235], a[40:43], v[164:167]
  ds_read_b64_tr_b16 a[20:21], v11 offset:512
  v_exp_f32 v173, v157
  v_mfma_f32_16x16x32_bf16 v[164:167], a[236:239], a[44:47], v[164:167]
  ds_read_b64_tr_b16 a[22:23], v11 offset:4608
  v_add_f32 v221, v221, v173
  v_cvt_pk_bf16_f32 v180, v172, v173
  v_mov_b32 v228, v220
  v_mfma_f32_16x16x32_bf16 v[168:171], a[240:243], a[32:35], v[136:139]
  ds_read_b64_tr_b16 a[24:25], v10 offset:768
  v_exp_f32 v174, v158
  v_mfma_f32_16x16x32_bf16 v[168:171], a[244:247], a[36:39], v[168:171]
  s_waitcnt lgkmcnt(5)
  ds_read_b64_tr_b16 a[26:27], v10 offset:4864
  v_add_f32 v221, v221, v174
  v_permlane32_swap_b32 v220, v228
  v_mfma_f32_16x16x32_bf16 v[168:171], a[248:251], a[40:43], v[168:171]
  ds_read_b64_tr_b16 a[28:29], v11 offset:768
  v_exp_f32 v175, v159
  v_mfma_f32_16x16x32_bf16 v[168:171], a[252:255], a[44:47], v[168:171]
  ds_read_b64_tr_b16 a[30:31], v11 offset:4864
  v_add_f32 v221, v221, v175
  v_cvt_pk_bf16_f32 v181, v174, v175
  v_add_f32 v220, v220, v228
  v_mfma_f32_16x16x32_bf16 v[16:19], v[188:191], v[184:187], v[16:19]
  v_exp_f32 v176, v160
  v_mfma_f32_16x16x32_bf16 v[20:23], v[192:195], v[184:187], v[20:23]
  s_barrier
  v_add_f32 v221, v221, v176
  v_mov_b32 v228, v220
  v_mfma_f32_16x16x32_bf16 v[24:27], v[196:199], v[184:187], v[24:27]
  v_exp_f32 v177, v161
  v_mfma_f32_16x16x32_bf16 v[28:31], v[200:203], v[184:187], v[28:31]
  v_add_f32 v221, v221, v177
  v_cvt_pk_bf16_f32 v182, v176, v177
  v_permlane16_swap_b32 v220, v228
  v_mfma_f32_16x16x32_bf16 a[112:115], v[204:207], v[184:187], a[112:115]
  v_exp_f32 v178, v162
  v_mfma_f32_16x16x32_bf16 a[116:119], v[208:211], v[184:187], a[116:119]
  v_add_f32 v221, v221, v178
  v_add_f32 v220, v220, v228
  v_mfma_f32_16x16x32_bf16 a[120:123], v[212:215], v[184:187], a[120:123]
  v_exp_f32 v179, v163
  v_mfma_f32_16x16x32_bf16 a[124:127], v[216:219], v[184:187], a[124:127]
  v_add_f32 v221, v221, v179
  v_cvt_pk_bf16_f32 v183, v178, v179
  v_mfma_f32_16x16x32_bf16 v[156:159], a[224:227], a[48:51], v[140:143]
  v_exp_f32 v172, v164
  v_mfma_f32_16x16x32_bf16 v[156:159], a[228:231], a[52:55], v[156:159]
  ds_write_b128 v237, a[112:115] offset:0
  v_add_f32 v222, v222, v172
  v_mfma_f32_16x16x32_bf16 v[156:159], a[232:235], a[56:59], v[156:159]
  ds_write_b128 v237, a[116:119] offset:1024
  v_exp_f32 v173, v165
  v_mfma_f32_16x16x32_bf16 v[156:159], a[236:239], a[60:63], v[156:159]
  ds_write_b128 v237, a[120:123] offset:2048
  v_add_f32 v222, v222, v173
  v_cvt_pk_bf16_f32 v184, v172, v173
  v_mov_b32 v228, v221
  v_mfma_f32_16x16x32_bf16 v[160:163], a[240:243], a[48:51], v[140:143]
  ds_write_b128 v237, a[124:127] offset:3072
  v_exp_f32 v174, v166
  v_mfma_f32_16x16x32_bf16 v[160:163], a[244:247], a[52:55], v[160:163]
  ds_write_b32 v237, v220 offset:28672
  v_add_f32 v222, v222, v174
  v_permlane32_swap_b32 v221, v228
  v_mfma_f32_16x16x32_bf16 v[160:163], a[248:251], a[56:59], v[160:163]
  v_exp_f32 v175, v167
  v_mfma_f32_16x16x32_bf16 v[160:163], a[252:255], a[60:63], v[160:163]
  v_add_f32 v222, v222, v175
  v_cvt_pk_bf16_f32 v185, v174, v175
  v_add_f32 v221, v221, v228
  v_mfma_f32_16x16x32_bf16 v[32:35], v[188:191], v[180:183], v[32:35]
  s_waitcnt vmcnt(13)
  s_waitcnt vmcnt(9)
  s_waitcnt lgkmcnt(0)
  s_barrier
  ds_read_b32 v230, v238 offset:28672
  v_exp_f32 v176, v168
  v_mfma_f32_16x16x32_bf16 v[36:39], v[192:195], v[180:183], v[36:39]
  ds_read_b128 v[128:131], v238 offset:0
  ds_read_b128 v[132:135], v238 offset:1024
  v_add_f32 v222, v222, v176
  v_mov_b32 v228, v221
  v_mfma_f32_16x16x32_bf16 v[40:43], v[196:199], v[180:183], v[40:43]
  ds_read_b128 v[136:139], v238 offset:2048
  ds_read_b128 v[140:143], v238 offset:3072
  v_exp_f32 v177, v169
  v_mfma_f32_16x16x32_bf16 v[44:47], v[200:203], v[180:183], v[44:47]
  ds_read_b64_tr_b16 a[32:33], v10 offset:8192
  ds_read_b64_tr_b16 a[34:35], v10 offset:12288
  v_add_f32 v222, v222, v177
  v_cvt_pk_bf16_f32 v186, v176, v177
  v_permlane16_swap_b32 v221, v228
  v_mfma_f32_16x16x32_bf16 a[128:131], v[204:207], v[180:183], a[128:131]
  ds_read_b64_tr_b16 a[36:37], v11 offset:8192
  ds_read_b64_tr_b16 a[38:39], v11 offset:12288
  v_exp_f32 v178, v170
  v_mfma_f32_16x16x32_bf16 a[132:135], v[208:211], v[180:183], a[132:135]
  ds_read_b64_tr_b16 a[40:41], v10 offset:8448
  ds_read_b64_tr_b16 a[42:43], v10 offset:12544
  v_add_f32 v222, v222, v178
  v_add_f32 v221, v221, v228
  v_mfma_f32_16x16x32_bf16 a[136:139], v[212:215], v[180:183], a[136:139]
  ds_read_b64_tr_b16 a[44:45], v11 offset:8448
  ds_read_b64_tr_b16 a[46:47], v11 offset:12544
  v_exp_f32 v179, v171
  v_mfma_f32_16x16x32_bf16 a[140:143], v[216:219], v[180:183], a[140:143]
  v_add_f32 v222, v222, v179
  v_cvt_pk_bf16_f32 v187, v178, v179
  v_mfma_f32_16x16x32_bf16 v[164:167], a[224:227], a[64:67], v[144:147]
  s_waitcnt lgkmcnt(0)
  v_exp_f32 v172, v156
  v_mfma_f32_16x16x32_bf16 v[164:167], a[228:231], a[68:71], v[164:167]
  ds_write_b128 v237, a[128:131] offset:4096
  v_add_f32 v223, v223, v172
  v_add_f32 v230, v230, v220
  v_rcp_f32 v230, v230
  v_mfma_f32_16x16x32_bf16 v[164:167], a[232:235], a[72:75], v[164:167]
  ds_write_b128 v237, a[132:135] offset:5120
  v_exp_f32 v173, v157
  v_mfma_f32_16x16x32_bf16 v[164:167], a[236:239], a[76:79], v[164:167]
  ds_write_b128 v237, a[136:139] offset:6144
  v_add_f32 v223, v223, v173
  v_cvt_pk_bf16_f32 v180, v172, v173
  v_mov_b32 v228, v222
  v_pk_add_f32 v[16:17], v[16:17], v[128:129]
  v_pk_add_f32 v[18:19], v[18:19], v[130:131]
  v_pk_add_f32 v[20:21], v[20:21], v[132:133]
  v_pk_add_f32 v[22:23], v[22:23], v[134:135]
  v_pk_add_f32 v[24:25], v[24:25], v[136:137]
  v_pk_add_f32 v[26:27], v[26:27], v[138:139]
  v_pk_add_f32 v[28:29], v[28:29], v[140:141]
  v_pk_add_f32 v[30:31], v[30:31], v[142:143]
  v_pk_mul_f32 v[16:17], v[16:17], v[230:231] op_sel_hi:[1,0]
  v_pk_mul_f32 v[18:19], v[18:19], v[230:231] op_sel_hi:[1,0]
  v_pk_mul_f32 v[20:21], v[20:21], v[230:231] op_sel_hi:[1,0]
  v_pk_mul_f32 v[22:23], v[22:23], v[230:231] op_sel_hi:[1,0]
  v_pk_mul_f32 v[24:25], v[24:25], v[230:231] op_sel_hi:[1,0]
  v_pk_mul_f32 v[26:27], v[26:27], v[230:231] op_sel_hi:[1,0]
  v_pk_mul_f32 v[28:29], v[28:29], v[230:231] op_sel_hi:[1,0]
  v_pk_mul_f32 v[30:31], v[30:31], v[230:231] op_sel_hi:[1,0]
  v_mfma_f32_16x16x32_bf16 v[168:171], a[240:243], a[64:67], v[144:147]
  ds_write_b128 v237, a[140:143] offset:7168
  v_exp_f32 v174, v158
  v_mfma_f32_16x16x32_bf16 v[168:171], a[244:247], a[68:71], v[168:171]
  ds_write_b32 v237, v221 offset:28676
  v_add_f32 v223, v223, v174
  v_permlane32_swap_b32 v222, v228
  v_mfma_f32_16x16x32_bf16 v[168:171], a[248:251], a[72:75], v[168:171]
  v_exp_f32 v175, v159
  v_mfma_f32_16x16x32_bf16 v[168:171], a[252:255], a[76:79], v[168:171]
  v_add_f32 v223, v223, v175
  v_cvt_pk_bf16_f32 v181, v174, v175
  v_add_f32 v222, v222, v228
  v_mfma_f32_16x16x32_bf16 v[48:51], v[188:191], v[184:187], v[48:51]
  s_waitcnt lgkmcnt(0)
  s_barrier
  ds_read_b32 v231, v238 offset:28676
  v_exp_f32 v176, v160
  v_cvt_pk_bf16_f32 v16, v16, v17
  v_cvt_pk_bf16_f32 v17, v18, v19
  v_mfma_f32_16x16x32_bf16 v[52:55], v[192:195], v[184:187], v[52:55]
  ds_read_b128 v[128:131], v238 offset:4096
  ds_read_b128 v[132:135], v238 offset:5120
  v_add_f32 v223, v223, v176
  v_cvt_pk_bf16_f32 v18, v20, v21
  v_mov_b32 v228, v222
  v_mfma_f32_16x16x32_bf16 v[56:59], v[196:199], v[184:187], v[56:59]
  ds_read_b128 v[136:139], v238 offset:6144
  ds_read_b128 v[140:143], v238 offset:7168
  v_exp_f32 v177, v161
  v_cvt_pk_bf16_f32 v19, v22, v23
  v_mfma_f32_16x16x32_bf16 v[60:63], v[200:203], v[184:187], v[60:63]
  ds_read_b64_tr_b16 a[48:49], v10 offset:8704
  ds_read_b64_tr_b16 a[50:51], v10 offset:12800
  v_add_f32 v223, v223, v177
  v_cvt_pk_bf16_f32 v182, v176, v177
  v_cvt_pk_bf16_f32 v20, v24, v25
  v_cvt_pk_bf16_f32 v21, v26, v27
  v_permlane16_swap_b32 v222, v228
  v_mfma_f32_16x16x32_bf16 a[144:147], v[204:207], v[184:187], a[144:147]
  ds_read_b64_tr_b16 a[52:53], v11 offset:8704
  ds_read_b64_tr_b16 a[54:55], v11 offset:12800
  v_exp_f32 v178, v162
  v_cvt_pk_bf16_f32 v22, v28, v29
  v_mfma_f32_16x16x32_bf16 a[148:151], v[208:211], v[184:187], a[148:151]
  ds_read_b64_tr_b16 a[56:57], v10 offset:8960
  ds_read_b64_tr_b16 a[58:59], v10 offset:13056
  v_add_f32 v223, v223, v178
  v_cvt_pk_bf16_f32 v23, v30, v31
  v_add_f32 v222, v222, v228
  v_mfma_f32_16x16x32_bf16 a[152:155], v[212:215], v[184:187], a[152:155]
  ds_read_b64_tr_b16 a[60:61], v11 offset:8960
  ds_read_b64_tr_b16 a[62:63], v11 offset:13056
  v_exp_f32 v179, v163
  v_mfma_f32_16x16x32_bf16 a[156:159], v[216:219], v[184:187], a[156:159]
  buffer_store_dwordx4 v[16:19], v5, s[32:35], s74 offen offset:0 sc1
  buffer_store_dwordx4 v[20:23], v5, s[32:35], s74 offen offset:1024 sc1
  v_add_f32 v223, v223, v179
  v_cvt_pk_bf16_f32 v183, v178, v179
  v_mfma_f32_16x16x32_bf16 v[156:159], a[224:227], a[80:83], v[148:151]
  s_waitcnt lgkmcnt(0)
  s_add_u32 m0, s59, 0
  s_xor_b32 s69, s1, 0x40000
  v_exp_f32 v172, v164
  v_mfma_f32_16x16x32_bf16 v[156:159], a[228:231], a[84:87], v[156:159]
  ds_write_b128 v237, a[144:147] offset:8192
  v_add_f32 v224, v224, v172
  v_add_f32 v231, v231, v221
  v_rcp_f32 v231, v231
  v_mfma_f32_16x16x32_bf16 v[156:159], a[232:235], a[88:91], v[156:159]
  ds_write_b128 v237, a[148:151] offset:9216
  buffer_load_dwordx4 v244, s[40:43], s69 offen offset:0  lds
  v_exp_f32 v173, v165
  v_mfma_f32_16x16x32_bf16 v[156:159], a[236:239], a[92:95], v[156:159]
  ds_write_b128 v237, a[152:155] offset:10240
  buffer_load_dwordx4 v245, s[40:43], s69 offen offset:1024  lds
  v_add_f32 v224, v224, v173
  v_cvt_pk_bf16_f32 v184, v172, v173
  v_mov_b32 v228, v223
  v_pk_add_f32 v[32:33], v[32:33], v[128:129]
  v_pk_add_f32 v[34:35], v[34:35], v[130:131]
  v_pk_add_f32 v[36:37], v[36:37], v[132:133]
  v_pk_add_f32 v[38:39], v[38:39], v[134:135]
  v_pk_add_f32 v[40:41], v[40:41], v[136:137]
  v_pk_add_f32 v[42:43], v[42:43], v[138:139]
  v_pk_add_f32 v[44:45], v[44:45], v[140:141]
  v_pk_add_f32 v[46:47], v[46:47], v[142:143]
  v_pk_mul_f32 v[32:33], v[32:33], v[230:231] op_sel:[0,1]
  v_pk_mul_f32 v[34:35], v[34:35], v[230:231] op_sel:[0,1]
  v_pk_mul_f32 v[36:37], v[36:37], v[230:231] op_sel:[0,1]
  v_pk_mul_f32 v[38:39], v[38:39], v[230:231] op_sel:[0,1]
  v_pk_mul_f32 v[40:41], v[40:41], v[230:231] op_sel:[0,1]
  v_pk_mul_f32 v[42:43], v[42:43], v[230:231] op_sel:[0,1]
  v_pk_mul_f32 v[44:45], v[44:45], v[230:231] op_sel:[0,1]
  v_pk_mul_f32 v[46:47], v[46:47], v[230:231] op_sel:[0,1]
  v_mfma_f32_16x16x32_bf16 v[160:163], a[240:243], a[80:83], v[148:151]
  ds_write_b128 v237, a[156:159] offset:11264
  buffer_load_dwordx4 v246, s[40:43], s69 offen offset:2048  lds
  v_exp_f32 v174, v166
  v_mfma_f32_16x16x32_bf16 v[160:163], a[244:247], a[84:87], v[160:163]
  ds_write_b32 v237, v222 offset:28680
  buffer_load_dwordx4 v247, s[40:43], s69 offen offset:3072  lds
  v_add_f32 v224, v224, v174
  v_permlane32_swap_b32 v223, v228
  v_mfma_f32_16x16x32_bf16 v[160:163], a[248:251], a[88:91], v[160:163]
  v_exp_f32 v175, v167
  v_mfma_f32_16x16x32_bf16 v[160:163], a[252:255], a[92:95], v[160:163]
  v_add_f32 v224, v224, v175
  v_cvt_pk_bf16_f32 v185, v174, v175
  v_add_f32 v223, v223, v228
  v_mfma_f32_16x16x32_bf16 v[64:67], v[188:191], v[180:183], v[64:67]
  s_waitcnt vmcnt(10)
  s_waitcnt vmcnt(6)
  s_waitcnt lgkmcnt(0)
  s_barrier
  ds_read_b32 v230, v238 offset:28680
  v_exp_f32 v176, v168
  v_cvt_pk_bf16_f32 v32, v32, v33
  v_cvt_pk_bf16_f32 v33, v34, v35
  v_mfma_f32_16x16x32_bf16 v[68:71], v[192:195], v[180:183], v[68:71]
  ds_read_b128 v[128:131], v238 offset:8192
  ds_read_b128 v[132:135], v238 offset:9216
  v_add_f32 v224, v224, v176
  v_cvt_pk_bf16_f32 v34, v36, v37
  v_mov_b32 v228, v223
  v_mfma_f32_16x16x32_bf16 v[72:75], v[196:199], v[180:183], v[72:75]
  ds_read_b128 v[136:139], v238 offset:10240
  ds_read_b128 v[140:143], v238 offset:11264
  v_exp_f32 v177, v169
  v_cvt_pk_bf16_f32 v35, v38, v39
  v_mfma_f32_16x16x32_bf16 v[76:79], v[200:203], v[180:183], v[76:79]
  ds_read_b64_tr_b16 a[64:65], v10 offset:16384
  ds_read_b64_tr_b16 a[66:67], v10 offset:20480
  v_add_f32 v224, v224, v177
  v_cvt_pk_bf16_f32 v186, v176, v177
  v_cvt_pk_bf16_f32 v36, v40, v41
  v_cvt_pk_bf16_f32 v37, v42, v43
  v_permlane16_swap_b32 v223, v228
  v_mfma_f32_16x16x32_bf16 a[160:163], v[204:207], v[180:183], a[160:163]
  ds_read_b64_tr_b16 a[68:69], v11 offset:16384
  ds_read_b64_tr_b16 a[70:71], v11 offset:20480
  v_exp_f32 v178, v170
  v_cvt_pk_bf16_f32 v38, v44, v45
  v_mfma_f32_16x16x32_bf16 a[164:167], v[208:211], v[180:183], a[164:167]
  ds_read_b64_tr_b16 a[72:73], v10 offset:16640
  ds_read_b64_tr_b16 a[74:75], v10 offset:20736
  v_add_f32 v224, v224, v178
  v_cvt_pk_bf16_f32 v39, v46, v47
  v_add_f32 v223, v223, v228
  v_mfma_f32_16x16x32_bf16 a[168:171], v[212:215], v[180:183], a[168:171]
  ds_read_b64_tr_b16 a[76:77], v11 offset:16640
  ds_read_b64_tr_b16 a[78:79], v11 offset:20736
  v_exp_f32 v179, v171
  v_mfma_f32_16x16x32_bf16 a[172:175], v[216:219], v[180:183], a[172:175]
  buffer_store_dwordx4 v[32:35], v5, s[32:35], s75 offen offset:0 sc1
  buffer_store_dwordx4 v[36:39], v5, s[32:35], s75 offen offset:1024 sc1
  v_add_f32 v224, v224, v179
  v_cvt_pk_bf16_f32 v187, v178, v179
  v_mfma_f32_16x16x32_bf16 v[164:167], a[224:227], a[96:99], v[152:155]
  s_waitcnt lgkmcnt(0)
  s_add_u32 m0, s59, 4096
  s_xor_b32 s69, s1, 0x48000
  v_exp_f32 v172, v156
  v_mfma_f32_16x16x32_bf16 v[164:167], a[228:231], a[100:103], v[164:167]
  ds_write_b128 v237, a[160:163] offset:12288
  v_add_f32 v225, v225, v172
  v_add_f32 v230, v230, v222
  v_rcp_f32 v230, v230
  v_mfma_f32_16x16x32_bf16 v[164:167], a[232:235], a[104:107], v[164:167]
  ds_write_b128 v237, a[164:167] offset:13312
  buffer_load_dwordx4 v244, s[40:43], s69 offen offset:0  lds
  v_exp_f32 v173, v157
  v_mfma_f32_16x16x32_bf16 v[164:167], a[236:239], a[108:111], v[164:167]
  ds_write_b128 v237, a[168:171] offset:14336
  buffer_load_dwordx4 v245, s[40:43], s69 offen offset:1024  lds
  v_add_f32 v225, v225, v173
  v_cvt_pk_bf16_f32 v180, v172, v173
  v_mov_b32 v228, v224
  v_pk_add_f32 v[48:49], v[48:49], v[128:129]
  v_pk_add_f32 v[50:51], v[50:51], v[130:131]
  v_pk_add_f32 v[52:53], v[52:53], v[132:133]
  v_pk_add_f32 v[54:55], v[54:55], v[134:135]
  v_pk_add_f32 v[56:57], v[56:57], v[136:137]
  v_pk_add_f32 v[58:59], v[58:59], v[138:139]
  v_pk_add_f32 v[60:61], v[60:61], v[140:141]
  v_pk_add_f32 v[62:63], v[62:63], v[142:143]
  v_pk_mul_f32 v[48:49], v[48:49], v[230:231] op_sel_hi:[1,0]
  v_pk_mul_f32 v[50:51], v[50:51], v[230:231] op_sel_hi:[1,0]
  v_pk_mul_f32 v[52:53], v[52:53], v[230:231] op_sel_hi:[1,0]
  v_pk_mul_f32 v[54:55], v[54:55], v[230:231] op_sel_hi:[1,0]
  v_pk_mul_f32 v[56:57], v[56:57], v[230:231] op_sel_hi:[1,0]
  v_pk_mul_f32 v[58:59], v[58:59], v[230:231] op_sel_hi:[1,0]
  v_pk_mul_f32 v[60:61], v[60:61], v[230:231] op_sel_hi:[1,0]
  v_pk_mul_f32 v[62:63], v[62:63], v[230:231] op_sel_hi:[1,0]
  v_mfma_f32_16x16x32_bf16 v[168:171], a[240:243], a[96:99], v[152:155]
  ds_write_b128 v237, a[172:175] offset:15360
  buffer_load_dwordx4 v246, s[40:43], s69 offen offset:2048  lds
  v_exp_f32 v174, v158
  v_mfma_f32_16x16x32_bf16 v[168:171], a[244:247], a[100:103], v[168:171]
  ds_write_b32 v237, v223 offset:28684
  buffer_load_dwordx4 v247, s[40:43], s69 offen offset:3072  lds
  v_add_f32 v225, v225, v174
  v_permlane32_swap_b32 v224, v228
  v_mfma_f32_16x16x32_bf16 v[168:171], a[248:251], a[104:107], v[168:171]
  v_exp_f32 v175, v159
  v_mfma_f32_16x16x32_bf16 v[168:171], a[252:255], a[108:111], v[168:171]
  v_add_f32 v225, v225, v175
  v_cvt_pk_bf16_f32 v181, v174, v175
  v_add_f32 v224, v224, v228
  v_mfma_f32_16x16x32_bf16 v[80:83], v[188:191], v[184:187], v[80:83]
  s_waitcnt lgkmcnt(0)
  s_barrier
  ds_read_b32 v231, v238 offset:28684
  v_exp_f32 v176, v160
  v_cvt_pk_bf16_f32 v48, v48, v49
  v_cvt_pk_bf16_f32 v49, v50, v51
  v_mfma_f32_16x16x32_bf16 v[84:87], v[192:195], v[184:187], v[84:87]
  ds_read_b128 v[128:131], v238 offset:12288
  ds_read_b128 v[132:135], v238 offset:13312
  v_add_f32 v225, v225, v176
  v_cvt_pk_bf16_f32 v50, v52, v53
  v_mov_b32 v228, v224
  v_mfma_f32_16x16x32_bf16 v[88:91], v[196:199], v[184:187], v[88:91]
  ds_read_b128 v[136:139], v238 offset:14336
  ds_read_b128 v[140:143], v238 offset:15360
  v_exp_f32 v177, v161
  v_cvt_pk_bf16_f32 v51, v54, v55
  v_mfma_f32_16x16x32_bf16 v[92:95], v[200:203], v[184:187], v[92:95]
  ds_read_b64_tr_b16 a[80:81], v10 offset:16896
  ds_read_b64_tr_b16 a[82:83], v10 offset:20992
  v_add_f32 v225, v225, v177
  v_cvt_pk_bf16_f32 v182, v176, v177
  v_cvt_pk_bf16_f32 v52, v56, v57
  v_cvt_pk_bf16_f32 v53, v58, v59
  v_permlane16_swap_b32 v224, v228
  v_mfma_f32_16x16x32_bf16 a[176:179], v[204:207], v[184:187], a[176:179]
  ds_read_b64_tr_b16 a[84:85], v11 offset:16896
  ds_read_b64_tr_b16 a[86:87], v11 offset:20992
  v_exp_f32 v178, v162
  v_cvt_pk_bf16_f32 v54, v60, v61
  v_mfma_f32_16x16x32_bf16 a[180:183], v[208:211], v[184:187], a[180:183]
  ds_read_b64_tr_b16 a[88:89], v10 offset:17152
  ds_read_b64_tr_b16 a[90:91], v10 offset:21248
  v_add_f32 v225, v225, v178
  v_cvt_pk_bf16_f32 v55, v62, v63
  v_add_f32 v224, v224, v228
  v_mfma_f32_16x16x32_bf16 a[184:187], v[212:215], v[184:187], a[184:187]
  ds_read_b64_tr_b16 a[92:93], v11 offset:17152
  ds_read_b64_tr_b16 a[94:95], v11 offset:21248
  v_exp_f32 v179, v163
  v_mfma_f32_16x16x32_bf16 a[188:191], v[216:219], v[184:187], a[188:191]
  buffer_store_dwordx4 v[48:51], v5, s[32:35], s76 offen offset:0 sc1
  buffer_store_dwordx4 v[52:55], v5, s[32:35], s76 offen offset:1024 sc1
  v_add_f32 v225, v225, v179
  v_cvt_pk_bf16_f32 v183, v178, v179
  v_add_u32 v10, s70, v10
  v_add_u32 v11, s70, v11
  s_nop 1
  v_mfma_f32_16x16x32_bf16 v[96:99], v[188:191], v[180:183], v[96:99]
  s_waitcnt lgkmcnt(0)
  ds_write_b128 v237, a[176:179] offset:16384
  s_waitcnt vmcnt(39)
  s_waitcnt vmcnt(31)
  ds_read_b64_tr_b16 a[224:225], v10 offset:0
  ds_read_b64_tr_b16 a[226:227], v10 offset:4096
  s_add_u32 m0, s59, 8192
  s_xor_b32 s69, s1, 0x50000
  v_exp_f32 v172, v164
  s_nop 0
  v_add_f32 v226, v226, v172
  v_add_f32 v231, v231, v223
  v_rcp_f32 v231, v231
  v_mfma_f32_16x16x32_bf16 v[100:103], v[192:195], v[180:183], v[100:103]
  ds_write_b128 v237, a[180:183] offset:17408
  ds_write_b128 v237, a[184:187] offset:18432
  ds_read_b64_tr_b16 a[228:229], v11 offset:0
  ds_read_b64_tr_b16 a[230:231], v11 offset:4096
  buffer_load_dwordx4 v244, s[40:43], s69 offen offset:0  lds
  buffer_load_dwordx4 v245, s[40:43], s69 offen offset:1024  lds
  v_exp_f32 v173, v165
  s_nop 0
  v_add_f32 v226, v226, v173
  v_cvt_pk_bf16_f32 v184, v172, v173
  v_mov_b32 v228, v225
  v_pk_add_f32 v[64:65], v[64:65], v[128:129]
  v_pk_add_f32 v[66:67], v[66:67], v[130:131]
  v_pk_add_f32 v[68:69], v[68:69], v[132:133]
  v_pk_add_f32 v[70:71], v[70:71], v[134:135]
  v_pk_add_f32 v[72:73], v[72:73], v[136:137]
  v_pk_add_f32 v[74:75], v[74:75], v[138:139]
  v_pk_add_f32 v[76:77], v[76:77], v[140:141]
  v_pk_add_f32 v[78:79], v[78:79], v[142:143]
  v_pk_mul_f32 v[64:65], v[64:65], v[230:231] op_sel:[0,1]
  v_pk_mul_f32 v[66:67], v[66:67], v[230:231] op_sel:[0,1]
  v_pk_mul_f32 v[68:69], v[68:69], v[230:231] op_sel:[0,1]
  v_pk_mul_f32 v[70:71], v[70:71], v[230:231] op_sel:[0,1]
  v_pk_mul_f32 v[72:73], v[72:73], v[230:231] op_sel:[0,1]
  v_pk_mul_f32 v[74:75], v[74:75], v[230:231] op_sel:[0,1]
  v_pk_mul_f32 v[76:77], v[76:77], v[230:231] op_sel:[0,1]
  v_pk_mul_f32 v[78:79], v[78:79], v[230:231] op_sel:[0,1]
  v_mfma_f32_16x16x32_bf16 v[104:107], v[196:199], v[180:183], v[104:107]
  ds_write_b128 v237, a[188:191] offset:19456
  ds_write_b32 v237, v224 offset:29696
  ds_read_b64_tr_b16 a[232:233], v10 offset:256
  ds_read_b64_tr_b16 a[234:235], v10 offset:4352
  buffer_load_dwordx4 v246, s[40:43], s69 offen offset:2048  lds
  buffer_load_dwordx4 v247, s[40:43], s69 offen offset:3072  lds
  v_exp_f32 v174, v166
  s_nop 0
  v_add_f32 v226, v226, v174
  v_permlane32_swap_b32 v225, v228
  v_mfma_f32_16x16x32_bf16 v[108:111], v[200:203], v[180:183], v[108:111]
  ds_read_b64_tr_b16 a[236:237], v11 offset:256
  ds_read_b64_tr_b16 a[238:239], v11 offset:4352
  v_exp_f32 v175, v167
  s_nop 0
  v_add_f32 v226, v226, v175
  v_cvt_pk_bf16_f32 v185, v174, v175
  v_add_f32 v225, v225, v228
  v_mfma_f32_16x16x32_bf16 a[192:195], v[204:207], v[180:183], a[192:195]
  s_waitcnt lgkmcnt(0)
  s_barrier
  ds_read_b32 v230, v238 offset:29696
  ds_read_b128 v[128:131], v238 offset:16384
  ds_read_b128 v[132:135], v238 offset:17408
  ds_read_b64_tr_b16 a[240:241], v10 offset:512
  ds_read_b64_tr_b16 a[242:243], v10 offset:4608
  v_exp_f32 v176, v168
  s_nop 0
  v_cvt_pk_bf16_f32 v64, v64, v65
  v_cvt_pk_bf16_f32 v65, v66, v67
  v_add_f32 v226, v226, v176
  v_cvt_pk_bf16_f32 v66, v68, v69
  v_mov_b32 v228, v225
  v_mfma_f32_16x16x32_bf16 a[196:199], v[208:211], v[180:183], a[196:199]
  ds_read_b128 v[136:139], v238 offset:18432
  ds_read_b128 v[140:143], v238 offset:19456
  ds_read_b64_tr_b16 a[244:245], v11 offset:512
  ds_read_b64_tr_b16 a[246:247], v11 offset:4608
  v_exp_f32 v177, v169
  s_nop 0
  v_cvt_pk_bf16_f32 v67, v70, v71
  v_add_f32 v226, v226, v177
  v_cvt_pk_bf16_f32 v186, v176, v177
  v_cvt_pk_bf16_f32 v68, v72, v73
  v_cvt_pk_bf16_f32 v69, v74, v75
  v_permlane16_swap_b32 v225, v228
  v_mfma_f32_16x16x32_bf16 a[200:203], v[212:215], v[180:183], a[200:203]
  ds_read_b64_tr_b16 a[248:249], v10 offset:768
  ds_read_b64_tr_b16 a[250:251], v10 offset:4864
  v_exp_f32 v178, v170
  s_nop 0
  v_cvt_pk_bf16_f32 v70, v76, v77
  v_add_f32 v226, v226, v178
  v_cvt_pk_bf16_f32 v71, v78, v79
  v_add_f32 v225, v225, v228
  v_mfma_f32_16x16x32_bf16 a[204:207], v[216:219], v[180:183], a[204:207]
  ds_read_b64_tr_b16 a[252:253], v11 offset:768
  ds_read_b64_tr_b16 a[254:255], v11 offset:4864
  buffer_store_dwordx4 v[64:67], v5, s[32:35], s77 offen offset:0 sc1
  buffer_store_dwordx4 v[68:71], v5, s[32:35], s77 offen offset:1024 sc1
  v_exp_f32 v179, v171
  s_nop 0
  v_add_f32 v226, v226, v179
  v_cvt_pk_bf16_f32 v187, v178, v179
L_epi:
  s_waitcnt lgkmcnt(0)
  s_nop 0
  v_mfma_f32_16x16x32_bf16 a[208:211], v[204:207], v[184:187], a[208:211]
  v_add_f32 v236, v220, v221
  v_add_f32 v236, v236, v222
  v_mfma_f32_16x16x32_bf16 a[212:215], v[208:211], v[184:187], a[212:215]
  v_add_f32 v236, v236, v223
  v_add_f32 v236, v236, v224
  v_mfma_f32_16x16x32_bf16 a[216:219], v[212:215], v[184:187], a[216:219]
  ds_write_b128 v237, a[192:195] offset:20480
  v_add_f32 v236, v236, v225
  v_add_f32 v236, v236, v226
  v_mov_b32 v228, v226
  v_mfma_f32_16x16x32_bf16 a[220:223], v[216:219], v[184:187], a[220:223]
  ds_write_b128 v237, a[196:199] offset:21504
  s_mov_b32 s65, 0x4e800000
  s_lshl_b32 s61, s48, 2
  v_permlane32_swap_b32 v226, v228
  v_mfma_f32_16x16x32_bf16 v[112:115], v[188:191], v[184:187], v[112:115]
  ds_write_b128 v237, a[200:203] offset:22528
  v_cmp_ngt_f32 vcc, s65, v236
  s_add_u32 s61, s61, 30720
  v_add_f32 v226, v226, v228
  v_mfma_f32_16x16x32_bf16 v[116:119], v[192:195], v[184:187], v[116:119]
  ds_write_b128 v237, a[204:207] offset:23552
  v_mov_b32 v2, s61
  s_cmp_lg_u64 vcc, 0
  v_mov_b32 v228, v226
  v_mfma_f32_16x16x32_bf16 v[120:123], v[196:199], v[184:187], v[120:123]
  ds_write_b32 v237, v225 offset:29700
  s_cselect_b32 s65, 1, 0
  v_mov_b32 v3, 30720
  v_permlane16_swap_b32 v226, v228
  v_mfma_f32_16x16x32_bf16 v[124:127], v[200:203], v[184:187], v[124:127]
  v_mov_b32 v227, s65
  v_add_f32 v226, v226, v228
  s_mov_b64 exec, 31
  global_load_dword v249, v252, s[18:19] sc1
  s_mov_b64 exec, -1
  ds_write_b128 v237, a[208:211] offset:24576
  ds_write_b128 v237, a[212:215] offset:25600
  ds_write_b128 v237, a[216:219] offset:26624
  ds_write_b128 v237, a[220:223] offset:27648
  ds_write_b32 v237, v226 offset:29704
  ds_write_b32 v2, v227
  v_add_f32 v230, v230, v224
  v_rcp_f32 v230, v230
  v_pk_add_f32 v[80:81], v[80:81], v[128:129]
  v_pk_add_f32 v[82:83], v[82:83], v[130:131]
  v_pk_add_f32 v[84:85], v[84:85], v[132:133]
  v_pk_add_f32 v[86:87], v[86:87], v[134:135]
  v_pk_add_f32 v[88:89], v[88:89], v[136:137]
  v_pk_add_f32 v[90:91], v[90:91], v[138:139]
  v_pk_add_f32 v[92:93], v[92:93], v[140:141]
  v_pk_add_f32 v[94:95], v[94:95], v[142:143]
  v_pk_mul_f32 v[80:81], v[80:81], v[230:231] op_sel_hi:[1,0]
  v_pk_mul_f32 v[82:83], v[82:83], v[230:231] op_sel_hi:[1,0]
  v_pk_mul_f32 v[84:85], v[84:85], v[230:231] op_sel_hi:[1,0]
  v_pk_mul_f32 v[86:87], v[86:87], v[230:231] op_sel_hi:[1,0]
  v_pk_mul_f32 v[88:89], v[88:89], v[230:231] op_sel_hi:[1,0]
  v_pk_mul_f32 v[90:91], v[90:91], v[230:231] op_sel_hi:[1,0]
  v_pk_mul_f32 v[92:93], v[92:93], v[230:231] op_sel_hi:[1,0]
  v_pk_mul_f32 v[94:95], v[94:95], v[230:231] op_sel_hi:[1,0]
  s_waitcnt lgkmcnt(0)
  s_barrier
  ds_read_b128 v[216:219], v3
  ds_read_b32 v231, v238 offset:29700
  ds_read_b128 v[144:147], v238 offset:20480
  ds_read_b128 v[148:151], v238 offset:21504
  ds_read_b128 v[152:155], v238 offset:22528
  ds_read_b128 v[156:159], v238 offset:23552
  ds_read_b32 v230, v238 offset:29704
  ds_read_b128 v[160:163], v238 offset:24576
  ds_read_b128 v[164:167], v238 offset:25600
  ds_read_b128 v[168:171], v238 offset:26624
  ds_read_b128 v[172:175], v238 offset:27648
  v_cvt_pk_bf16_f32 v80, v80, v81
  v_cvt_pk_bf16_f32 v81, v82, v83
  v_cvt_pk_bf16_f32 v82, v84, v85
  v_cvt_pk_bf16_f32 v83, v86, v87
  v_cvt_pk_bf16_f32 v84, v88, v89
  v_cvt_pk_bf16_f32 v85, v90, v91
  v_cvt_pk_bf16_f32 v86, v92, v93
  v_cvt_pk_bf16_f32 v87, v94, v95
  buffer_store_dwordx4 v[80:83], v5, s[32:35], s78 offen offset:0 sc1
  buffer_store_dwordx4 v[84:87], v5, s[32:35], s78 offen offset:1024 sc1
  v_add_u32 v10, s71, v10
  v_add_u32 v11, s71, v11
  s_waitcnt lgkmcnt(5)
  v_or3_b32 v216, v216, v217, v218
  v_or_b32 v216, v216, v219
  v_add_f32 v231, v231, v225
  v_rcp_f32 v231, v231
  v_pk_add_f32 v[96:97], v[96:97], v[144:145]
  v_pk_add_f32 v[98:99], v[98:99], v[146:147]
  v_pk_add_f32 v[100:101], v[100:101], v[148:149]
  v_pk_add_f32 v[102:103], v[102:103], v[150:151]
  v_pk_add_f32 v[104:105], v[104:105], v[152:153]
  v_pk_add_f32 v[106:107], v[106:107], v[154:155]
  v_pk_add_f32 v[108:109], v[108:109], v[156:157]
  v_pk_add_f32 v[110:111], v[110:111], v[158:159]
  v_pk_mul_f32 v[96:97], v[96:97], v[230:231] op_sel:[0,1]
  v_pk_mul_f32 v[98:99], v[98:99], v[230:231] op_sel:[0,1]
  v_pk_mul_f32 v[100:101], v[100:101], v[230:231] op_sel:[0,1]
  v_pk_mul_f32 v[102:103], v[102:103], v[230:231] op_sel:[0,1]
  v_pk_mul_f32 v[104:105], v[104:105], v[230:231] op_sel:[0,1]
  v_pk_mul_f32 v[106:107], v[106:107], v[230:231] op_sel:[0,1]
  v_pk_mul_f32 v[108:109], v[108:109], v[230:231] op_sel:[0,1]
  v_pk_mul_f32 v[110:111], v[110:111], v[230:231] op_sel:[0,1]
  v_cvt_pk_bf16_f32 v96, v96, v97
  v_cvt_pk_bf16_f32 v97, v98, v99
  v_cvt_pk_bf16_f32 v98, v100, v101
  v_cvt_pk_bf16_f32 v99, v102, v103
  v_cvt_pk_bf16_f32 v100, v104, v105
  v_cvt_pk_bf16_f32 v101, v106, v107
  v_cvt_pk_bf16_f32 v102, v108, v109
  v_cvt_pk_bf16_f32 v103, v110, v111
  v_readfirstlane_b32 s65, v216
  buffer_store_dwordx4 v[96:99], v5, s[32:35], s79 offen offset:0 sc1
  buffer_store_dwordx4 v[100:103], v5, s[32:35], s79 offen offset:1024 sc1
  s_waitcnt lgkmcnt(0)
  v_add_f32 v230, v230, v226
  v_rcp_f32 v230, v230
  v_pk_add_f32 v[112:113], v[112:113], v[160:161]
  v_pk_add_f32 v[114:115], v[114:115], v[162:163]
  v_pk_add_f32 v[116:117], v[116:117], v[164:165]
  v_pk_add_f32 v[118:119], v[118:119], v[166:167]
  v_pk_add_f32 v[120:121], v[120:121], v[168:169]
  v_pk_add_f32 v[122:123], v[122:123], v[170:171]
  v_pk_add_f32 v[124:125], v[124:125], v[172:173]
  v_pk_add_f32 v[126:127], v[126:127], v[174:175]
  v_pk_mul_f32 v[112:113], v[112:113], v[230:231] op_sel_hi:[1,0]
  v_pk_mul_f32 v[114:115], v[114:115], v[230:231] op_sel_hi:[1,0]
  v_pk_mul_f32 v[116:117], v[116:117], v[230:231] op_sel_hi:[1,0]
  v_pk_mul_f32 v[118:119], v[118:119], v[230:231] op_sel_hi:[1,0]
  v_pk_mul_f32 v[120:121], v[120:121], v[230:231] op_sel_hi:[1,0]
  v_pk_mul_f32 v[122:123], v[122:123], v[230:231] op_sel_hi:[1,0]
  v_pk_mul_f32 v[124:125], v[124:125], v[230:231] op_sel_hi:[1,0]
  v_pk_mul_f32 v[126:127], v[126:127], v[230:231] op_sel_hi:[1,0]
  v_cvt_pk_bf16_f32 v112, v112, v113
  v_cvt_pk_bf16_f32 v113, v114, v115
  v_cvt_pk_bf16_f32 v114, v116, v117
  v_cvt_pk_bf16_f32 v115, v118, v119
  v_cvt_pk_bf16_f32 v116, v120, v121
  v_cvt_pk_bf16_f32 v117, v122, v123
  v_cvt_pk_bf16_f32 v118, v124, v125
  v_cvt_pk_bf16_f32 v119, v126, v127
  buffer_store_dwordx4 v[112:115], v5, s[32:35], s80 offen offset:0 sc1
  buffer_store_dwordx4 v[116:119], v5, s[32:35], s80 offen offset:1024 sc1
  s_andn2_b32 s65, s65, s64
  s_cbranch_scc1 L_slow
  s_waitcnt vmcnt(6)
  v_cmp_eq_u32 s[72:73], v249, v255
  s_mov_b64 vcc, 0
  s_and_b32 s72, s72, 31
  s_cbranch_scc1 L_late
  buffer_load_dwordx4 v[128:131], v248, s[36:39], s74 offen sc1
  buffer_load_dwordx4 v[132:135], v248, s[36:39], s75 offen sc1
  buffer_load_dwordx4 v[136:139], v248, s[36:39], s76 offen sc1
  buffer_load_dwordx4 v[140:143], v248, s[36:39], s77 offen sc1
  buffer_load_dwordx4 v[144:147], v248, s[36:39], s78 offen sc1
  buffer_load_dwordx4 v[148:151], v248, s[36:39], s79 offen sc1
  buffer_load_dwordx4 v[152:155], v248, s[36:39], s80 offen sc1
  v_xor_b32 v248, 0x400, v248
  buffer_load_dwordx4 v[156:159], v248, s[36:39], s74 offen sc1
  buffer_load_dwordx4 v[160:163], v248, s[36:39], s75 offen sc1
  buffer_load_dwordx4 v[164:167], v248, s[36:39], s76 offen sc1
  buffer_load_dwordx4 v[168:171], v248, s[36:39], s77 offen sc1
  buffer_load_dwordx4 v[172:175], v248, s[36:39], s78 offen sc1
  buffer_load_dwordx4 v[176:179], v248, s[36:39], s79 offen sc1
  buffer_load_dwordx4 v[180:183], v248, s[36:39], s80 offen sc1
  v_xor_b32 v248, 0xc00, v248
  s_lshl_b32 s65, s49, 5
  s_add_u32 s65, s65, s50
  v_mov_b32 v3, s65
  v_mov_b32 v4, 1
  v_mov_b32 v241, v252
  s_waitcnt vmcnt(14)
  s_barrier
  s_cmp_lg_u32 s48, 0
  s_cbranch_scc1 L_join
  s_mov_b64 exec, 0xfffff
  global_store_dword v239, v254, s[18:19] sc1
  s_mov_b64 exec, 1
  global_store_byte v3, v4, s[16:17] sc1
  s_mov_b64 exec, -1
  s_branch L_join
L_late:
  s_mov_b64 exec, 31
  global_load_dword v2, v252, s[18:19] sc1
  s_mov_b64 exec, -1
  s_lshl_b32 s65, s49, 5
  s_add_u32 s65, s65, s50
  v_mov_b32 v3, s65
  v_mov_b32 v4, 1
  v_mov_b32 v241, v252
  v_xor_b32 v243, 0x80, v3
  s_lshr_b32 s65, s67, 1
  s_lshl_b32 s65, s65, 5
  s_lshl_b32 s61, s0, 2
  s_add_u32 s65, s65, s61
  v_mov_b32 v242, s65
  s_mov_b32 s55, 0x40000
  s_waitcnt vmcnt(0)
  v_cmp_eq_u32 s[72:73], v2, v255
  s_barrier
  s_cmp_lg_u32 s48, 0
  s_cbranch_scc1 L_noflag
  s_mov_b64 exec, 0xfffff
  global_store_dword v239, v254, s[18:19] sc1
  s_mov_b64 exec, 1
  global_store_byte v3, v4, s[16:17] sc1
  s_mov_b64 exec, -1
L_noflag:
  s_and_b32 s72, s72, 31
  s_cbranch_scc0 L_go
  s_mov_b64 vcc, -1
  s_add_u32 m0, s59, 12288
  s_xor_b32 s69, s1, 0x58000
  buffer_load_dwordx4 v244, s[40:43], s69 offen offset:0  lds
  buffer_load_dwordx4 v245, s[40:43], s69 offen offset:1024  lds
  buffer_load_dwordx4 v246, s[40:43], s69 offen offset:2048  lds
  buffer_load_dwordx4 v247, s[40:43], s69 offen offset:3072  lds
  s_add_u32 m0, s59, 16384
  s_xor_b32 s69, s1, 0x60000
  buffer_load_dwordx4 v244, s[40:43], s69 offen offset:0  lds
  buffer_load_dwordx4 v245, s[40:43], s69 offen offset:1024  lds
  buffer_load_dwordx4 v246, s[40:43], s69 offen offset:2048  lds
  buffer_load_dwordx4 v247, s[40:43], s69 offen offset:3072  lds
  s_add_u32 m0, s59, 20480
  s_xor_b32 s69, s1, 0x68000
  buffer_load_dwordx4 v244, s[40:43], s69 offen offset:0  lds
  buffer_load_dwordx4 v245, s[40:43], s69 offen offset:1024  lds
  buffer_load_dwordx4 v246, s[40:43], s69 offen offset:2048  lds
  buffer_load_dwordx4 v247, s[40:43], s69 offen offset:3072  lds
  s_add_u32 m0, s59, 24576
  s_xor_b32 s69, s1, 0x70000
  buffer_load_dwordx4 v244, s[40:43], s69 offen offset:0  lds
  buffer_load_dwordx4 v245, s[40:43], s69 offen offset:1024  lds
  buffer_load_dwordx4 v246, s[40:43], s69 offen offset:2048  lds
  buffer_load_dwordx4 v247, s[40:43], s69 offen offset:3072  lds
  s_add_u32 m0, s59, 28672
  s_xor_b32 s69, s1, 0x78000
  buffer_load_dwordx4 v244, s[40:43], s69 offen offset:0  lds
  buffer_load_dwordx4 v245, s[40:43], s69 offen offset:1024  lds
  buffer_load_dwordx4 v246, s[40:43], s69 offen offset:2048  lds
  buffer_load_dwordx4 v247, s[40:43], s69 offen offset:3072  lds
  s_mov_b64 exec, 31
L_poll:
  global_load_dword v2, v241, s[18:19] sc1
  s_waitcnt vmcnt(0)
  s_sub_u32 s55, s55, 1
  s_cbranch_scc1 L_go
  v_cmp_eq_u32 s[72:73], v2, v255
  s_nop 0
  s_cmp_eq_u64 s[72:73], 0
  s_cbranch_scc1 L_go
  s_and_b32 s65, s55, 15
  s_cbranch_scc1 L_poll
  global_load_dword v2, v242, s[16:17] sc1
  global_load_ubyte v3, v243, s[16:17] sc1
  s_waitcnt vmcnt(0)
  v_add_u32 v2, v2, v3
  s_nop 0
  v_readfirstlane_b32 s65, v2
  s_nop 0
  s_cmp_eq_u32 s65, 0x01010102
  s_cbranch_scc0 L_poll
L_go:
  s_mov_b64 exec, -1
  buffer_load_dwordx4 v[128:131], v248, s[36:39], s74 offen sc1
  buffer_load_dwordx4 v[132:135], v248, s[36:39], s75 offen sc1
  buffer_load_dwordx4 v[136:139], v248, s[36:39], s76 offen sc1
  buffer_load_dwordx4 v[140:143], v248, s[36:39], s77 offen sc1
  buffer_load_dwordx4 v[144:147], v248, s[36:39], s78 offen sc1
  buffer_load_dwordx4 v[148:151], v248, s[36:39], s79 offen sc1
  buffer_load_dwordx4 v[152:155], v248, s[36:39], s80 offen sc1
  v_xor_b32 v248, 0x400, v248
  buffer_load_dwordx4 v[156:159], v248, s[36:39], s74 offen sc1
  buffer_load_dwordx4 v[160:163], v248, s[36:39], s75 offen sc1
  buffer_load_dwordx4 v[164:167], v248, s[36:39], s76 offen sc1
  buffer_load_dwordx4 v[168:171], v248, s[36:39], s77 offen sc1
  buffer_load_dwordx4 v[172:175], v248, s[36:39], s78 offen sc1
  buffer_load_dwordx4 v[176:179], v248, s[36:39], s79 offen sc1
  buffer_load_dwordx4 v[180:183], v248, s[36:39], s80 offen sc1
  v_xor_b32 v248, 0xc00, v248
L_join:
  v_add_u32 v6, s59, v5
  v_xor_b32 v7, 0x8000, v6
  v_xor_b32 v8, 0x10000, v6
  v_xor_b32 v9, 0x18000, v6
  v_and_b32 v2, 15, v1
  v_lshrrev_b32 v3, 4, v1
  v_lshlrev_b32 v3, 3, v3
  v_lshl_add_u32 v2, v2, 11, v3
  s_lshl_b32 s65, s68, 8
  s_lshl_b32 s61, s0, 5
  s_add_u32 s65, s65, s61
  v_add_u32 v249, s65, v2
  s_lshl_b32 s65, s2, 2
  s_add_u32 s65, s65, s48
  s_lshl_b32 s65, s65, 13
  s_add_u32 s65, s65, 0x2000c00
  v_add_u32 v250, s65, v5
  v_xor_b32 v251, 0x8000, v250
  s_waitcnt vmcnt(13)
  v_mfma_f32_16x16x32_bf16 v[16:19], a[0:3], v[128:131], 0
  v_mfma_f32_16x16x32_bf16 v[20:23], a[4:7], v[128:131], 0
  buffer_load_dwordx4 v[184:187], v248, s[36:39], s74 offen sc1
  v_mfma_f32_16x16x32_bf16 a[112:115], a[8:11], v[128:131], 0
  v_mfma_f32_16x16x32_bf16 a[116:119], a[12:15], v[128:131], 0
  v_mfma_f32_16x16x32_bf16 v[24:27], a[16:19], v[128:131], 0
  buffer_load_dwordx4 v[188:191], v248, s[36:39], s75 offen sc1
  v_mfma_f32_16x16x32_bf16 v[28:31], a[20:23], v[128:131], 0
  v_mfma_f32_16x16x32_bf16 a[120:123], a[24:27], v[128:131], 0
  v_mfma_f32_16x16x32_bf16 a[124:127], a[28:31], v[128:131], 0
  s_waitcnt vmcnt(14)
  v_mfma_f32_16x16x32_bf16 v[32:35], a[0:3], v[132:135], 0
  buffer_load_dwordx4 v[192:195], v248, s[36:39], s76 offen sc1
  v_mfma_f32_16x16x32_bf16 v[36:39], a[4:7], v[132:135], 0
  v_mfma_f32_16x16x32_bf16 a[128:131], a[8:11], v[132:135], 0
  v_mfma_f32_16x16x32_bf16 a[132:135], a[12:15], v[132:135], 0
  buffer_load_dwordx4 v[196:199], v248, s[36:39], s77 offen sc1
  v_mfma_f32_16x16x32_bf16 v[40:43], a[16:19], v[132:135], 0
  v_mfma_f32_16x16x32_bf16 v[44:47], a[20:23], v[132:135], 0
  v_mfma_f32_16x16x32_bf16 a[136:139], a[24:27], v[132:135], 0
  v_mfma_f32_16x16x32_bf16 a[140:143], a[28:31], v[132:135], 0
  buffer_load_dwordx4 v[200:203], v248, s[36:39], s78 offen sc1
  s_waitcnt vmcnt(16)
  v_mfma_f32_16x16x32_bf16 v[48:51], a[0:3], v[136:139], 0
  v_mfma_f32_16x16x32_bf16 v[52:55], a[4:7], v[136:139], 0
  v_mfma_f32_16x16x32_bf16 a[144:147], a[8:11], v[136:139], 0
  buffer_load_dwordx4 v[204:207], v248, s[36:39], s79 offen sc1
  v_mfma_f32_16x16x32_bf16 a[148:151], a[12:15], v[136:139], 0
  v_mfma_f32_16x16x32_bf16 v[56:59], a[16:19], v[136:139], 0
  v_mfma_f32_16x16x32_bf16 v[60:63], a[20:23], v[136:139], 0
  v_mfma_f32_16x16x32_bf16 a[152:155], a[24:27], v[136:139], 0
  buffer_load_dwordx4 v[208:211], v248, s[36:39], s80 offen sc1
  v_xor_b32 v248, 0x400, v248
  v_mfma_f32_16x16x32_bf16 a[156:159], a[28:31], v[136:139], 0
  s_waitcnt vmcnt(17)
  v_mfma_f32_16x16x32_bf16 v[64:67], a[0:3], v[140:143], 0
  v_mfma_f32_16x16x32_bf16 v[68:71], a[4:7], v[140:143], 0
  s_cbranch_vccnz L_sk1
  s_add_u32 m0, s59, 12288
  s_xor_b32 s69, s1, 0x58000
  buffer_load_dwordx4 v244, s[40:43], s69 offen offset:0  lds
  buffer_load_dwordx4 v245, s[40:43], s69 offen offset:1024  lds
  buffer_load_dwordx4 v246, s[40:43], s69 offen offset:2048  lds
  buffer_load_dwordx4 v247, s[40:43], s69 offen offset:3072  lds
L_sk1:
  v_mfma_f32_16x16x32_bf16 a[160:163], a[8:11], v[140:143], 0
  v_mfma_f32_16x16x32_bf16 a[164:167], a[12:15], v[140:143], 0
  v_mfma_f32_16x16x32_bf16 v[72:75], a[16:19], v[140:143], 0
  v_mfma_f32_16x16x32_bf16 v[76:79], a[20:23], v[140:143], 0
  buffer_load_dwordx4 v[212:215], v248, s[36:39], s74 offen sc1
  v_mfma_f32_16x16x32_bf16 a[168:171], a[24:27], v[140:143], 0
  v_mfma_f32_16x16x32_bf16 a[172:175], a[28:31], v[140:143], 0
  s_waitcnt vmcnt(17)
  v_mfma_f32_16x16x32_bf16 v[80:83], a[0:3], v[144:147], 0
  buffer_load_dwordx4 v[216:219], v248, s[36:39], s75 offen sc1
  v_mfma_f32_16x16x32_bf16 v[84:87], a[4:7], v[144:147], 0
  v_mfma_f32_16x16x32_bf16 a[176:179], a[8:11], v[144:147], 0
  v_mfma_f32_16x16x32_bf16 a[180:183], a[12:15], v[144:147], 0
  v_mfma_f32_16x16x32_bf16 v[88:91], a[16:19], v[144:147], 0
  buffer_load_dwordx4 v[220:223], v248, s[36:39], s76 offen sc1
  v_mfma_f32_16x16x32_bf16 v[92:95], a[20:23], v[144:147], 0
  v_mfma_f32_16x16x32_bf16 a[184:187], a[24:27], v[144:147], 0
  v_mfma_f32_16x16x32_bf16 a[188:191], a[28:31], v[144:147], 0
  buffer_load_dwordx4 v[224:227], v248, s[36:39], s77 offen sc1
  s_waitcnt vmcnt(19)
  v_mfma_f32_16x16x32_bf16 v[96:99], a[0:3], v[148:151], 0
  v_mfma_f32_16x16x32_bf16 v[100:103], a[4:7], v[148:151], 0
  v_mfma_f32_16x16x32_bf16 a[192:195], a[8:11], v[148:151], 0
  v_mfma_f32_16x16x32_bf16 a[196:199], a[12:15], v[148:151], 0
  buffer_load_dwordx4 v[228:231], v248, s[36:39], s78 offen sc1
  v_mfma_f32_16x16x32_bf16 v[104:107], a[16:19], v[148:151], 0
  v_mfma_f32_16x16x32_bf16 v[108:111], a[20:23], v[148:151], 0
  v_mfma_f32_16x16x32_bf16 a[200:203], a[24:27], v[148:151], 0
  buffer_load_dwordx4 v[232:235], v248, s[36:39], s79 offen sc1
  v_mfma_f32_16x16x32_bf16 a[204:207], a[28:31], v[148:151], 0
  s_waitcnt vmcnt(20)
  v_mfma_f32_16x16x32_bf16 v[112:115], a[0:3], v[152:155], 0
  v_mfma_f32_16x16x32_bf16 v[116:119], a[4:7], v[152:155], 0
  v_mfma_f32_16x16x32_bf16 a[208:211], a[8:11], v[152:155], 0
  buffer_load_dwordx4 v[236:239], v248, s[36:39], s80 offen sc1
  v_xor_b32 v248, 0x1c00, v248
  v_mfma_f32_16x16x32_bf16 a[212:215], a[12:15], v[152:155], 0
  v_mfma_f32_16x16x32_bf16 v[120:123], a[16:19], v[152:155], 0
  v_mfma_f32_16x16x32_bf16 v[124:127], a[20:23], v[152:155], 0
  v_mfma_f32_16x16x32_bf16 a[216:219], a[24:27], v[152:155], 0
  v_mfma_f32_16x16x32_bf16 a[220:223], a[28:31], v[152:155], 0
  s_waitcnt vmcnt(14)
  v_mfma_f32_16x16x32_bf16 v[16:19], a[32:35], v[156:159], v[16:19]
  ds_read_b64_tr_b16 a[0:1], v10 offset:0
  v_mfma_f32_16x16x32_bf16 v[20:23], a[36:39], v[156:159], v[20:23]
  buffer_load_dwordx4 v[128:131], v248, s[36:39], s74 offen sc1
  ds_read_b64_tr_b16 a[2:3], v10 offset:4096
  v_mfma_f32_16x16x32_bf16 a[112:115], a[40:43], v[156:159], a[112:115]
  ds_read_b64_tr_b16 a[4:5], v11 offset:0
  v_mfma_f32_16x16x32_bf16 a[116:119], a[44:47], v[156:159], a[116:119]
  ds_read_b64_tr_b16 a[6:7], v11 offset:4096
  v_mfma_f32_16x16x32_bf16 v[24:27], a[48:51], v[156:159], v[24:27]
  ds_read_b64_tr_b16 a[8:9], v10 offset:256
  v_mfma_f32_16x16x32_bf16 v[28:31], a[52:55], v[156:159], v[28:31]
  ds_read_b64_tr_b16 a[10:11], v10 offset:4352
  v_mfma_f32_16x16x32_bf16 a[120:123], a[56:59], v[156:159], a[120:123]
  buffer_load_dwordx4 v[132:135], v248, s[36:39], s75 offen sc1
  ds_read_b64_tr_b16 a[12:13], v11 offset:256
  v_mfma_f32_16x16x32_bf16 a[124:127], a[60:63], v[156:159], a[124:127]
  ds_read_b64_tr_b16 a[14:15], v11 offset:4352
  v_mfma_f32_16x16x32_bf16 v[32:35], a[32:35], v[160:163], v[32:35]
  ds_read_b64_tr_b16 a[16:17], v10 offset:512
  v_mfma_f32_16x16x32_bf16 v[36:39], a[36:39], v[160:163], v[36:39]
  ds_read_b64_tr_b16 a[18:19], v10 offset:4608
  v_mfma_f32_16x16x32_bf16 a[128:131], a[40:43], v[160:163], a[128:131]
  ds_read_b64_tr_b16 a[20:21], v11 offset:512
  v_mfma_f32_16x16x32_bf16 a[132:135], a[44:47], v[160:163], a[132:135]
  ds_read_b64_tr_b16 a[22:23], v11 offset:4608
  v_mfma_f32_16x16x32_bf16 v[40:43], a[48:51], v[160:163], v[40:43]
  s_cbranch_vccnz L_sk2
  s_add_u32 m0, s59, 16384
  s_xor_b32 s69, s1, 0x60000
  buffer_load_dwordx4 v244, s[40:43], s69 offen offset:0  lds
  buffer_load_dwordx4 v245, s[40:43], s69 offen offset:1024  lds
  buffer_load_dwordx4 v246, s[40:43], s69 offen offset:2048  lds
  buffer_load_dwordx4 v247, s[40:43], s69 offen offset:3072  lds
L_sk2:
  ds_read_b64_tr_b16 a[24:25], v10 offset:768
  v_mfma_f32_16x16x32_bf16 v[44:47], a[52:55], v[160:163], v[44:47]
  ds_read_b64_tr_b16 a[26:27], v10 offset:4864
  v_mfma_f32_16x16x32_bf16 a[136:139], a[56:59], v[160:163], a[136:139]
  ds_read_b64_tr_b16 a[28:29], v11 offset:768
  v_mfma_f32_16x16x32_bf16 a[140:143], a[60:63], v[160:163], a[140:143]
  ds_read_b64_tr_b16 a[30:31], v11 offset:4864
  v_mfma_f32_16x16x32_bf16 v[48:51], a[32:35], v[164:167], v[48:51]
  v_mfma_f32_16x16x32_bf16 v[52:55], a[36:39], v[164:167], v[52:55]
  v_mfma_f32_16x16x32_bf16 a[144:147], a[40:43], v[164:167], a[144:147]
  buffer_load_dwordx4 v[136:139], v248, s[36:39], s76 offen sc1
  v_mfma_f32_16x16x32_bf16 a[148:151], a[44:47], v[164:167], a[148:151]
  v_mfma_f32_16x16x32_bf16 v[56:59], a[48:51], v[164:167], v[56:59]
  v_mfma_f32_16x16x32_bf16 v[60:63], a[52:55], v[164:167], v[60:63]
  v_mfma_f32_16x16x32_bf16 a[152:155], a[56:59], v[164:167], a[152:155]
  v_mfma_f32_16x16x32_bf16 a[156:159], a[60:63], v[164:167], a[156:159]
  v_mfma_f32_16x16x32_bf16 v[64:67], a[32:35], v[168:171], v[64:67]
  buffer_load_dwordx4 v[140:143], v248, s[36:39], s77 offen sc1
  v_mfma_f32_16x16x32_bf16 v[68:71], a[36:39], v[168:171], v[68:71]
  v_mfma_f32_16x16x32_bf16 a[160:163], a[40:43], v[168:171], a[160:163]
  v_mfma_f32_16x16x32_bf16 a[164:167], a[44:47], v[168:171], a[164:167]
  v_mfma_f32_16x16x32_bf16 v[72:75], a[48:51], v[168:171], v[72:75]
  v_mfma_f32_16x16x32_bf16 v[76:79], a[52:55], v[168:171], v[76:79]
  v_mfma_f32_16x16x32_bf16 a[168:171], a[56:59], v[168:171], a[168:171]
  buffer_load_dwordx4 v[144:147], v248, s[36:39], s78 offen sc1
  v_mfma_f32_16x16x32_bf16 a[172:175], a[60:63], v[168:171], a[172:175]
  v_mfma_f32_16x16x32_bf16 v[80:83], a[32:35], v[172:175], v[80:83]
  v_mfma_f32_16x16x32_bf16 v[84:87], a[36:39], v[172:175], v[84:87]
  v_mfma_f32_16x16x32_bf16 a[176:179], a[40:43], v[172:175], a[176:179]
  v_mfma_f32_16x16x32_bf16 a[180:183], a[44:47], v[172:175], a[180:183]
  v_mfma_f32_16x16x32_bf16 v[88:91], a[48:51], v[172:175], v[88:91]
  s_cbranch_vccnz L_sk3
  s_add_u32 m0, s59, 20480
  s_xor_b32 s69, s1, 0x68000
  buffer_load_dwordx4 v244, s[40:43], s69 offen offset:0  lds
  buffer_load_dwordx4 v245, s[40:43], s69 offen offset:1024  lds
  buffer_load_dwordx4 v246, s[40:43], s69 offen offset:2048  lds
  buffer_load_dwordx4 v247, s[40:43], s69 offen offset:3072  lds
L_sk3:
  v_mfma_f32_16x16x32_bf16 v[92:95], a[52:55], v[172:175], v[92:95]
  v_mfma_f32_16x16x32_bf16 a[184:187], a[56:59], v[172:175], a[184:187]
  v_mfma_f32_16x16x32_bf16 a[188:191], a[60:63], v[172:175], a[188:191]
  v_mfma_f32_16x16x32_bf16 v[96:99], a[32:35], v[176:179], v[96:99]
  v_mfma_f32_16x16x32_bf16 v[100:103], a[36:39], v[176:179], v[100:103]
  v_mfma_f32_16x16x32_bf16 a[192:195], a[40:43], v[176:179], a[192:195]
  buffer_load_dwordx4 v[148:151], v248, s[36:39], s79 offen sc1
  v_mfma_f32_16x16x32_bf16 a[196:199], a[44:47], v[176:179], a[196:199]
  v_mfma_f32_16x16x32_bf16 v[104:107], a[48:51], v[176:179], v[104:107]
  v_mfma_f32_16x16x32_bf16 v[108:111], a[52:55], v[176:179], v[108:111]
  v_mfma_f32_16x16x32_bf16 a[200:203], a[56:59], v[176:179], a[200:203]
  v_mfma_f32_16x16x32_bf16 a[204:207], a[60:63], v[176:179], a[204:207]
  v_mfma_f32_16x16x32_bf16 v[112:115], a[32:35], v[180:183], v[112:115]
  buffer_load_dwordx4 v[152:155], v248, s[36:39], s80 offen sc1
  v_xor_b32 v248, 0x400, v248
  v_mfma_f32_16x16x32_bf16 v[116:119], a[36:39], v[180:183], v[116:119]
  v_mfma_f32_16x16x32_bf16 a[208:211], a[40:43], v[180:183], a[208:211]
  v_mfma_f32_16x16x32_bf16 a[212:215], a[44:47], v[180:183], a[212:215]
  v_mfma_f32_16x16x32_bf16 v[120:123], a[48:51], v[180:183], v[120:123]
  v_mfma_f32_16x16x32_bf16 v[124:127], a[52:55], v[180:183], v[124:127]
  v_mfma_f32_16x16x32_bf16 a[216:219], a[56:59], v[180:183], a[216:219]
  v_mfma_f32_16x16x32_bf16 a[220:223], a[60:63], v[180:183], a[220:223]
  s_waitcnt vmcnt(14) lgkmcnt(0)
  v_mfma_f32_16x16x32_bf16 v[16:19], a[64:67], v[184:187], v[16:19]
  ds_read_b64_tr_b16 a[32:33], v10 offset:8192
  v_mfma_f32_16x16x32_bf16 v[20:23], a[68:71], v[184:187], v[20:23]
  buffer_load_dwordx4 v[156:159], v248, s[36:39], s74 offen sc1
  ds_read_b64_tr_b16 a[34:35], v10 offset:12288
  v_mfma_f32_16x16x32_bf16 a[112:115], a[72:75], v[184:187], a[112:115]
  ds_read_b64_tr_b16 a[36:37], v11 offset:8192
  v_mfma_f32_16x16x32_bf16 a[116:119], a[76:79], v[184:187], a[116:119]
  ds_read_b64_tr_b16 a[38:39], v11 offset:12288
  v_mfma_f32_16x16x32_bf16 v[24:27], a[80:83], v[184:187], v[24:27]
  s_cbranch_vccnz L_sk4
  s_add_u32 m0, s59, 24576
  s_xor_b32 s69, s1, 0x70000
  buffer_load_dwordx4 v244, s[40:43], s69 offen offset:0  lds
  buffer_load_dwordx4 v245, s[40:43], s69 offen offset:1024  lds
  buffer_load_dwordx4 v246, s[40:43], s69 offen offset:2048  lds
  buffer_load_dwordx4 v247, s[40:43], s69 offen offset:3072  lds
L_sk4:
  ds_read_b64_tr_b16 a[40:41], v10 offset:8448
  v_mfma_f32_16x16x32_bf16 v[28:31], a[84:87], v[184:187], v[28:31]
  ds_read_b64_tr_b16 a[42:43], v10 offset:12544
  v_mfma_f32_16x16x32_bf16 a[120:123], a[88:91], v[184:187], a[120:123]
  ds_read_b64_tr_b16 a[44:45], v11 offset:8448
  v_mfma_f32_16x16x32_bf16 a[124:127], a[92:95], v[184:187], a[124:127]
  s_cbranch_vccnz L_sk5
  s_add_u32 m0, s59, 28672
  s_xor_b32 s69, s1, 0x78000
  buffer_load_dwordx4 v244, s[40:43], s69 offen offset:0  lds
  buffer_load_dwordx4 v245, s[40:43], s69 offen offset:1024  lds
  buffer_load_dwordx4 v246, s[40:43], s69 offen offset:2048  lds
  buffer_load_dwordx4 v247, s[40:43], s69 offen offset:3072  lds
L_sk5:
  ds_read_b64_tr_b16 a[46:47], v11 offset:12544
  v_mfma_f32_16x16x32_bf16 v[32:35], a[64:67], v[188:191], v[32:35]
  ds_read_b64_tr_b16 a[48:49], v10 offset:8704
  v_mfma_f32_16x16x32_bf16 v[36:39], a[68:71], v[188:191], v[36:39]
  ds_read_b64_tr_b16 a[50:51], v10 offset:12800
  v_mfma_f32_16x16x32_bf16 a[128:131], a[72:75], v[188:191], a[128:131]
  buffer_load_dwordx4 v[160:163], v248, s[36:39], s75 offen sc1
  ds_read_b64_tr_b16 a[52:53], v11 offset:8704
  v_mfma_f32_16x16x32_bf16 a[132:135], a[76:79], v[188:191], a[132:135]
  ds_read_b64_tr_b16 a[54:55], v11 offset:12800
  v_mfma_f32_16x16x32_bf16 v[40:43], a[80:83], v[188:191], v[40:43]
  ds_read_b64_tr_b16 a[56:57], v10 offset:8960
  v_mfma_f32_16x16x32_bf16 v[44:47], a[84:87], v[188:191], v[44:47]
  ds_read_b64_tr_b16 a[58:59], v10 offset:13056
  s_add_u32 m0, s59, 0
  s_xor_b32 s69, s1, 0x80000
  v_mfma_f32_16x16x32_bf16 a[136:139], a[88:91], v[188:191], a[136:139]
  buffer_load_dwordx4 v244, s[40:43], s69 offen offset:0  lds
  ds_read_b64_tr_b16 a[60:61], v11 offset:8960
  v_mfma_f32_16x16x32_bf16 a[140:143], a[92:95], v[188:191], a[140:143]
  ds_read_b64_tr_b16 a[62:63], v11 offset:13056
  v_mfma_f32_16x16x32_bf16 v[48:51], a[64:67], v[192:195], v[48:51]
  v_mfma_f32_16x16x32_bf16 v[52:55], a[68:71], v[192:195], v[52:55]
  buffer_load_dwordx4 v[164:167], v248, s[36:39], s76 offen sc1
  v_mfma_f32_16x16x32_bf16 a[144:147], a[72:75], v[192:195], a[144:147]
  v_mfma_f32_16x16x32_bf16 a[148:151], a[76:79], v[192:195], a[148:151]
  v_mfma_f32_16x16x32_bf16 v[56:59], a[80:83], v[192:195], v[56:59]
  buffer_load_dwordx4 v245, s[40:43], s69 offen offset:1024  lds
  v_mfma_f32_16x16x32_bf16 v[60:63], a[84:87], v[192:195], v[60:63]
  v_mfma_f32_16x16x32_bf16 a[152:155], a[88:91], v[192:195], a[152:155]
  v_mfma_f32_16x16x32_bf16 a[156:159], a[92:95], v[192:195], a[156:159]
  v_mfma_f32_16x16x32_bf16 v[64:67], a[64:67], v[196:199], v[64:67]
  buffer_load_dwordx4 v[168:171], v248, s[36:39], s77 offen sc1
  v_mfma_f32_16x16x32_bf16 v[68:71], a[68:71], v[196:199], v[68:71]
  v_mfma_f32_16x16x32_bf16 a[160:163], a[72:75], v[196:199], a[160:163]
  v_mfma_f32_16x16x32_bf16 a[164:167], a[76:79], v[196:199], a[164:167]
  buffer_load_dwordx4 v246, s[40:43], s69 offen offset:2048  lds
  v_mfma_f32_16x16x32_bf16 v[72:75], a[80:83], v[196:199], v[72:75]
  v_mfma_f32_16x16x32_bf16 v[76:79], a[84:87], v[196:199], v[76:79]
  v_mfma_f32_16x16x32_bf16 a[168:171], a[88:91], v[196:199], a[168:171]
  buffer_load_dwordx4 v[172:175], v248, s[36:39], s78 offen sc1
  v_mfma_f32_16x16x32_bf16 a[172:175], a[92:95], v[196:199], a[172:175]
  v_mfma_f32_16x16x32_bf16 v[80:83], a[64:67], v[200:203], v[80:83]
  v_mfma_f32_16x16x32_bf16 v[84:87], a[68:71], v[200:203], v[84:87]
  v_mfma_f32_16x16x32_bf16 a[176:179], a[72:75], v[200:203], a[176:179]
  buffer_load_dwordx4 v247, s[40:43], s69 offen offset:3072  lds
  v_mfma_f32_16x16x32_bf16 a[180:183], a[76:79], v[200:203], a[180:183]
  v_mfma_f32_16x16x32_bf16 v[88:91], a[80:83], v[200:203], v[88:91]
  s_add_u32 m0, s59, 4096
  s_xor_b32 s69, s1, 0x88000
  v_mfma_f32_16x16x32_bf16 v[92:95], a[84:87], v[200:203], v[92:95]
  buffer_load_dwordx4 v244, s[40:43], s69 offen offset:0  lds
  v_mfma_f32_16x16x32_bf16 a[184:187], a[88:91], v[200:203], a[184:187]
  v_mfma_f32_16x16x32_bf16 a[188:191], a[92:95], v[200:203], a[188:191]
  v_mfma_f32_16x16x32_bf16 v[96:99], a[64:67], v[204:207], v[96:99]
  buffer_load_dwordx4 v[176:179], v248, s[36:39], s79 offen sc1
  v_mfma_f32_16x16x32_bf16 v[100:103], a[68:71], v[204:207], v[100:103]
  v_mfma_f32_16x16x32_bf16 a[192:195], a[72:75], v[204:207], a[192:195]
  v_mfma_f32_16x16x32_bf16 a[196:199], a[76:79], v[204:207], a[196:199]
  v_mfma_f32_16x16x32_bf16 v[104:107], a[80:83], v[204:207], v[104:107]
  buffer_load_dwordx4 v245, s[40:43], s69 offen offset:1024  lds
  v_mfma_f32_16x16x32_bf16 v[108:111], a[84:87], v[204:207], v[108:111]
  v_mfma_f32_16x16x32_bf16 a[200:203], a[88:91], v[204:207], a[200:203]
  v_mfma_f32_16x16x32_bf16 a[204:207], a[92:95], v[204:207], a[204:207]
  buffer_load_dwordx4 v[180:183], v248, s[36:39], s80 offen sc1
  v_xor_b32 v248, 0xc00, v248
  v_mfma_f32_16x16x32_bf16 v[112:115], a[64:67], v[208:211], v[112:115]
  v_mfma_f32_16x16x32_bf16 v[116:119], a[68:71], v[208:211], v[116:119]
  v_mfma_f32_16x16x32_bf16 a[208:211], a[72:75], v[208:211], a[208:211]
  buffer_load_dwordx4 v246, s[40:43], s69 offen offset:2048  lds
  v_mfma_f32_16x16x32_bf16 a[212:215], a[76:79], v[208:211], a[212:215]
  v_mfma_f32_16x16x32_bf16 v[120:123], a[80:83], v[208:211], v[120:123]
  v_mfma_f32_16x16x32_bf16 v[124:127], a[84:87], v[208:211], v[124:127]
  v_mfma_f32_16x16x32_bf16 a[216:219], a[88:91], v[208:211], a[216:219]
  v_mfma_f32_16x16x32_bf16 a[220:223], a[92:95], v[208:211], a[220:223]
  s_waitcnt vmcnt(21) lgkmcnt(0)
  v_mfma_f32_16x16x32_bf16 v[16:19], a[224:227], v[212:215], v[16:19]
  ds_read_b64_tr_b16 a[64:65], v10 offset:16384
  v_mfma_f32_16x16x32_bf16 v[20:23], a[228:231], v[212:215], v[20:23]
  buffer_load_dwordx4 v[184:187], v248, s[36:39], s74 offen sc1
  ds_read_b64_tr_b16 a[66:67], v10 offset:20480
  v_mfma_f32_16x16x32_bf16 a[112:115], a[232:235], v[212:215], a[112:115]
  ds_read_b64_tr_b16 a[68:69], v11 offset:16384
  v_mfma_f32_16x16x32_bf16 a[116:119], a[236:239], v[212:215], a[116:119]
  ds_read_b64_tr_b16 a[70:71], v11 offset:20480
  v_mfma_f32_16x16x32_bf16 v[24:27], a[240:243], v[212:215], v[24:27]
  ds_read_b64_tr_b16 a[72:73], v10 offset:16640
  v_mfma_f32_16x16x32_bf16 v[28:31], a[244:247], v[212:215], v[28:31]
  buffer_load_dwordx4 v247, s[40:43], s69 offen offset:3072  lds
  ds_read_b64_tr_b16 a[74:75], v10 offset:20736
  v_mfma_f32_16x16x32_bf16 a[120:123], a[248:251], v[212:215], a[120:123]
  ds_read_b64_tr_b16 a[76:77], v11 offset:16640
  v_mfma_f32_16x16x32_bf16 a[124:127], a[252:255], v[212:215], a[124:127]
  ds_read_b64_tr_b16 a[78:79], v11 offset:20736
  v_mfma_f32_16x16x32_bf16 v[32:35], a[224:227], v[216:219], v[32:35]
  ds_read_b64_tr_b16 a[80:81], v10 offset:16896
  v_mfma_f32_16x16x32_bf16 v[36:39], a[228:231], v[216:219], v[36:39]
  buffer_load_dwordx4 v[188:191], v248, s[36:39], s75 offen sc1
  ds_read_b64_tr_b16 a[82:83], v10 offset:20992
  v_mfma_f32_16x16x32_bf16 a[128:131], a[232:235], v[216:219], a[128:131]
  ds_read_b64_tr_b16 a[84:85], v11 offset:16896
  v_mfma_f32_16x16x32_bf16 a[132:135], a[236:239], v[216:219], a[132:135]
  ds_read_b64_tr_b16 a[86:87], v11 offset:20992
  v_mfma_f32_16x16x32_bf16 v[40:43], a[240:243], v[216:219], v[40:43]
  ds_read_b64_tr_b16 a[88:89], v10 offset:17152
  s_add_u32 m0, s59, 8192
  s_xor_b32 s69, s1, 0x90000
  v_mfma_f32_16x16x32_bf16 v[44:47], a[244:247], v[216:219], v[44:47]
  buffer_load_dwordx4 v244, s[40:43], s69 offen offset:0  lds
  ds_read_b64_tr_b16 a[90:91], v10 offset:21248
  v_mfma_f32_16x16x32_bf16 a[136:139], a[248:251], v[216:219], a[136:139]
  ds_read_b64_tr_b16 a[92:93], v11 offset:17152
  v_mfma_f32_16x16x32_bf16 a[140:143], a[252:255], v[216:219], a[140:143]
  ds_read_b64_tr_b16 a[94:95], v11 offset:21248
  v_mfma_f32_16x16x32_bf16 v[48:51], a[224:227], v[220:223], v[48:51]
  v_mfma_f32_16x16x32_bf16 v[52:55], a[228:231], v[220:223], v[52:55]
  buffer_load_dwordx4 v[192:195], v248, s[36:39], s76 offen sc1
  v_mfma_f32_16x16x32_bf16 a[144:147], a[232:235], v[220:223], a[144:147]
  v_mfma_f32_16x16x32_bf16 a[148:151], a[236:239], v[220:223], a[148:151]
  v_mfma_f32_16x16x32_bf16 v[56:59], a[240:243], v[220:223], v[56:59]
  v_mfma_f32_16x16x32_bf16 v[60:63], a[244:247], v[220:223], v[60:63]
  buffer_load_dwordx4 v245, s[40:43], s69 offen offset:1024  lds
  v_mfma_f32_16x16x32_bf16 a[152:155], a[248:251], v[220:223], a[152:155]
  v_mfma_f32_16x16x32_bf16 a[156:159], a[252:255], v[220:223], a[156:159]
  v_mfma_f32_16x16x32_bf16 v[64:67], a[224:227], v[224:227], v[64:67]
  v_mfma_f32_16x16x32_bf16 v[68:71], a[228:231], v[224:227], v[68:71]
  buffer_load_dwordx4 v[196:199], v248, s[36:39], s77 offen sc1
  v_mfma_f32_16x16x32_bf16 a[160:163], a[232:235], v[224:227], a[160:163]
  v_mfma_f32_16x16x32_bf16 a[164:167], a[236:239], v[224:227], a[164:167]
  v_mfma_f32_16x16x32_bf16 v[72:75], a[240:243], v[224:227], v[72:75]
  v_mfma_f32_16x16x32_bf16 v[76:79], a[244:247], v[224:227], v[76:79]
  buffer_load_dwordx4 v246, s[40:43], s69 offen offset:2048  lds
  v_mfma_f32_16x16x32_bf16 a[168:171], a[248:251], v[224:227], a[168:171]
  v_mfma_f32_16x16x32_bf16 a[172:175], a[252:255], v[224:227], a[172:175]
  v_mfma_f32_16x16x32_bf16 v[80:83], a[224:227], v[228:231], v[80:83]
  v_mfma_f32_16x16x32_bf16 v[84:87], a[228:231], v[228:231], v[84:87]
  buffer_load_dwordx4 v[200:203], v248, s[36:39], s78 offen sc1
  v_mfma_f32_16x16x32_bf16 a[176:179], a[232:235], v[228:231], a[176:179]
  v_mfma_f32_16x16x32_bf16 a[180:183], a[236:239], v[228:231], a[180:183]
  v_mfma_f32_16x16x32_bf16 v[88:91], a[240:243], v[228:231], v[88:91]
  v_mfma_f32_16x16x32_bf16 v[92:95], a[244:247], v[228:231], v[92:95]
  buffer_load_dwordx4 v247, s[40:43], s69 offen offset:3072  lds
  v_mfma_f32_16x16x32_bf16 a[184:187], a[248:251], v[228:231], a[184:187]
  v_mfma_f32_16x16x32_bf16 a[188:191], a[252:255], v[228:231], a[188:191]
  v_mfma_f32_16x16x32_bf16 v[96:99], a[224:227], v[232:235], v[96:99]
  v_mfma_f32_16x16x32_bf16 v[100:103], a[228:231], v[232:235], v[100:103]
  buffer_load_dwordx4 v[204:207], v248, s[36:39], s79 offen sc1
  v_mfma_f32_16x16x32_bf16 a[192:195], a[232:235], v[232:235], a[192:195]
  v_mfma_f32_16x16x32_bf16 a[196:199], a[236:239], v[232:235], a[196:199]
  v_mfma_f32_16x16x32_bf16 v[104:107], a[240:243], v[232:235], v[104:107]
  v_mfma_f32_16x16x32_bf16 v[108:111], a[244:247], v[232:235], v[108:111]
  buffer_load_dwordx4 v[208:211], v248, s[36:39], s80 offen sc1
  v_xor_b32 v248, 0x400, v248
  v_mfma_f32_16x16x32_bf16 a[200:203], a[248:251], v[232:235], a[200:203]
  v_mfma_f32_16x16x32_bf16 a[204:207], a[252:255], v[232:235], a[204:207]
  v_mfma_f32_16x16x32_bf16 v[112:115], a[224:227], v[236:239], v[112:115]
  s_add_u32 m0, s59, 12288
  s_xor_b32 s69, s1, 0x98000
  v_mfma_f32_16x16x32_bf16 v[116:119], a[228:231], v[236:239], v[116:119]
  buffer_load_dwordx4 v244, s[40:43], s69 offen offset:0  lds
  v_mfma_f32_16x16x32_bf16 a[208:211], a[232:235], v[236:239], a[208:211]
  v_mfma_f32_16x16x32_bf16 a[212:215], a[236:239], v[236:239], a[212:215]
  v_mfma_f32_16x16x32_bf16 v[120:123], a[240:243], v[236:239], v[120:123]
  v_mfma_f32_16x16x32_bf16 v[124:127], a[244:247], v[236:239], v[124:127]
  v_mfma_f32_16x16x32_bf16 a[216:219], a[248:251], v[236:239], a[216:219]
  v_mfma_f32_16x16x32_bf16 a[220:223], a[252:255], v[236:239], a[220:223]
  s_waitcnt vmcnt(26) lgkmcnt(0)
  v_mfma_f32_16x16x32_bf16 v[16:19], a[0:3], v[128:131], v[16:19]
  ds_read_b64_tr_b16 a[224:225], v10 offset:24576
  v_mfma_f32_16x16x32_bf16 v[20:23], a[4:7], v[128:131], v[20:23]
  buffer_load_dwordx4 v[212:215], v248, s[36:39], s74 offen sc1
  ds_read_b64_tr_b16 a[226:227], v10 offset:28672
  v_mfma_f32_16x16x32_bf16 a[112:115], a[8:11], v[128:131], a[112:115]
  ds_read_b64_tr_b16 a[228:229], v11 offset:24576
  v_mfma_f32_16x16x32_bf16 a[116:119], a[12:15], v[128:131], a[116:119]
  ds_read_b64_tr_b16 a[230:231], v11 offset:28672
  v_mfma_f32_16x16x32_bf16 v[24:27], a[16:19], v[128:131], v[24:27]
  buffer_load_dwordx4 v245, s[40:43], s69 offen offset:1024  lds
  ds_read_b64_tr_b16 a[232:233], v10 offset:24832
  v_mfma_f32_16x16x32_bf16 v[28:31], a[20:23], v[128:131], v[28:31]
  ds_read_b64_tr_b16 a[234:235], v10 offset:28928
  v_mfma_f32_16x16x32_bf16 a[120:123], a[24:27], v[128:131], a[120:123]
  ds_read_b64_tr_b16 a[236:237], v11 offset:24832
  v_mfma_f32_16x16x32_bf16 a[124:127], a[28:31], v[128:131], a[124:127]
  ds_read_b64_tr_b16 a[238:239], v11 offset:28928
  v_mfma_f32_16x16x32_bf16 v[32:35], a[0:3], v[132:135], v[32:35]
  buffer_load_dwordx4 v[216:219], v248, s[36:39], s75 offen sc1
  ds_read_b64_tr_b16 a[240:241], v10 offset:25088
  v_mfma_f32_16x16x32_bf16 v[36:39], a[4:7], v[132:135], v[36:39]
  ds_read_b64_tr_b16 a[242:243], v10 offset:29184
  v_mfma_f32_16x16x32_bf16 a[128:131], a[8:11], v[132:135], a[128:131]
  ds_read_b64_tr_b16 a[244:245], v11 offset:25088
  v_mfma_f32_16x16x32_bf16 a[132:135], a[12:15], v[132:135], a[132:135]
  ds_read_b64_tr_b16 a[246:247], v11 offset:29184
  v_mfma_f32_16x16x32_bf16 v[40:43], a[16:19], v[132:135], v[40:43]
  buffer_load_dwordx4 v246, s[40:43], s69 offen offset:2048  lds
  ds_read_b64_tr_b16 a[248:249], v10 offset:25344
  v_mfma_f32_16x16x32_bf16 v[44:47], a[20:23], v[132:135], v[44:47]
  ds_read_b64_tr_b16 a[250:251], v10 offset:29440
  v_mfma_f32_16x16x32_bf16 a[136:139], a[24:27], v[132:135], a[136:139]
  ds_read_b64_tr_b16 a[252:253], v11 offset:25344
  v_mfma_f32_16x16x32_bf16 a[140:143], a[28:31], v[132:135], a[140:143]
  ds_read_b64_tr_b16 a[254:255], v11 offset:29440
  v_mfma_f32_16x16x32_bf16 v[48:51], a[0:3], v[136:139], v[48:51]
  buffer_load_dwordx4 v[220:223], v248, s[36:39], s76 offen sc1
  v_mfma_f32_16x16x32_bf16 v[52:55], a[4:7], v[136:139], v[52:55]
  v_mfma_f32_16x16x32_bf16 a[144:147], a[8:11], v[136:139], a[144:147]
  v_mfma_f32_16x16x32_bf16 a[148:151], a[12:15], v[136:139], a[148:151]
  buffer_load_dwordx4 v247, s[40:43], s69 offen offset:3072  lds
  v_mfma_f32_16x16x32_bf16 v[56:59], a[16:19], v[136:139], v[56:59]
  v_mfma_f32_16x16x32_bf16 v[60:63], a[20:23], v[136:139], v[60:63]
  v_mfma_f32_16x16x32_bf16 a[152:155], a[24:27], v[136:139], a[152:155]
  v_mfma_f32_16x16x32_bf16 a[156:159], a[28:31], v[136:139], a[156:159]
  buffer_load_dwordx4 v[224:227], v248, s[36:39], s77 offen sc1
  v_mfma_f32_16x16x32_bf16 v[64:67], a[0:3], v[140:143], v[64:67]
  v_mfma_f32_16x16x32_bf16 v[68:71], a[4:7], v[140:143], v[68:71]
  v_mfma_f32_16x16x32_bf16 a[160:163], a[8:11], v[140:143], a[160:163]
  s_add_u32 m0, s59, 16384
  s_xor_b32 s69, s1, 0xa0000
  v_mfma_f32_16x16x32_bf16 a[164:167], a[12:15], v[140:143], a[164:167]
  buffer_load_dwordx4 v244, s[40:43], s69 offen offset:0  lds
  v_mfma_f32_16x16x32_bf16 v[72:75], a[16:19], v[140:143], v[72:75]
  v_mfma_f32_16x16x32_bf16 v[76:79], a[20:23], v[140:143], v[76:79]
  v_mfma_f32_16x16x32_bf16 a[168:171], a[24:27], v[140:143], a[168:171]
  v_mfma_f32_16x16x32_bf16 a[172:175], a[28:31], v[140:143], a[172:175]
  buffer_load_dwordx4 v[228:231], v248, s[36:39], s78 offen sc1
  v_mfma_f32_16x16x32_bf16 v[80:83], a[0:3], v[144:147], v[80:83]
  v_mfma_f32_16x16x32_bf16 v[84:87], a[4:7], v[144:147], v[84:87]
  v_mfma_f32_16x16x32_bf16 a[176:179], a[8:11], v[144:147], a[176:179]
  v_mfma_f32_16x16x32_bf16 a[180:183], a[12:15], v[144:147], a[180:183]
  buffer_load_dwordx4 v245, s[40:43], s69 offen offset:1024  lds
  v_mfma_f32_16x16x32_bf16 v[88:91], a[16:19], v[144:147], v[88:91]
  v_mfma_f32_16x16x32_bf16 v[92:95], a[20:23], v[144:147], v[92:95]
  v_mfma_f32_16x16x32_bf16 a[184:187], a[24:27], v[144:147], a[184:187]
  buffer_load_dwordx4 v[232:235], v248, s[36:39], s79 offen sc1
  v_mfma_f32_16x16x32_bf16 a[188:191], a[28:31], v[144:147], a[188:191]
  v_mfma_f32_16x16x32_bf16 v[96:99], a[0:3], v[148:151], v[96:99]
  v_mfma_f32_16x16x32_bf16 v[100:103], a[4:7], v[148:151], v[100:103]
  v_mfma_f32_16x16x32_bf16 a[192:195], a[8:11], v[148:151], a[192:195]
  buffer_load_dwordx4 v246, s[40:43], s69 offen offset:2048  lds
  v_mfma_f32_16x16x32_bf16 a[196:199], a[12:15], v[148:151], a[196:199]
  v_mfma_f32_16x16x32_bf16 v[104:107], a[16:19], v[148:151], v[104:107]
  v_mfma_f32_16x16x32_bf16 v[108:111], a[20:23], v[148:151], v[108:111]
  v_mfma_f32_16x16x32_bf16 a[200:203], a[24:27], v[148:151], a[200:203]
  buffer_load_dwordx4 v[236:239], v248, s[36:39], s80 offen sc1
  v_xor_b32 v248, 0x3c00, v248
  v_mfma_f32_16x16x32_bf16 a[204:207], a[28:31], v[148:151], a[204:207]
  v_mfma_f32_16x16x32_bf16 v[112:115], a[0:3], v[152:155], v[112:115]
  v_mfma_f32_16x16x32_bf16 v[116:119], a[4:7], v[152:155], v[116:119]
  v_mfma_f32_16x16x32_bf16 a[208:211], a[8:11], v[152:155], a[208:211]
  buffer_load_dwordx4 v247, s[40:43], s69 offen offset:3072  lds
  v_mfma_f32_16x16x32_bf16 a[212:215], a[12:15], v[152:155], a[212:215]
  v_mfma_f32_16x16x32_bf16 v[120:123], a[16:19], v[152:155], v[120:123]
  v_mfma_f32_16x16x32_bf16 v[124:127], a[20:23], v[152:155], v[124:127]
  v_mfma_f32_16x16x32_bf16 a[216:219], a[24:27], v[152:155], a[216:219]
  v_mfma_f32_16x16x32_bf16 a[220:223], a[28:31], v[152:155], a[220:223]
  s_waitcnt vmcnt(25) lgkmcnt(0)
  v_mfma_f32_16x16x32_bf16 v[16:19], a[32:35], v[156:159], v[16:19]
  ds_read_b64_tr_b16 a[0:1], v10 offset:0
  v_mfma_f32_16x16x32_bf16 v[20:23], a[36:39], v[156:159], v[20:23]
  buffer_load_dwordx4 v[128:131], v248, s[36:39], s74 offen sc1
  ds_read_b64_tr_b16 a[2:3], v10 offset:4096
  v_mfma_f32_16x16x32_bf16 a[112:115], a[40:43], v[156:159], a[112:115]
  ds_read_b64_tr_b16 a[4:5], v11 offset:0
  v_mfma_f32_16x16x32_bf16 a[116:119], a[44:47], v[156:159], a[116:119]
  ds_read_b64_tr_b16 a[6:7], v11 offset:4096
  v_mfma_f32_16x16x32_bf16 v[24:27], a[48:51], v[156:159], v[24:27]
  ds_read_b64_tr_b16 a[8:9], v10 offset:256
  s_add_u32 m0, s59, 20480
  s_xor_b32 s69, s1, 0xa8000
  v_mfma_f32_16x16x32_bf16 v[28:31], a[52:55], v[156:159], v[28:31]
  buffer_load_dwordx4 v244, s[40:43], s69 offen offset:0  lds
  ds_read_b64_tr_b16 a[10:11], v10 offset:4352
  v_mfma_f32_16x16x32_bf16 a[120:123], a[56:59], v[156:159], a[120:123]
  ds_read_b64_tr_b16 a[12:13], v11 offset:256
  v_mfma_f32_16x16x32_bf16 a[124:127], a[60:63], v[156:159], a[124:127]
  ds_read_b64_tr_b16 a[14:15], v11 offset:4352
  v_mfma_f32_16x16x32_bf16 v[32:35], a[32:35], v[160:163], v[32:35]
  ds_read_b64_tr_b16 a[16:17], v10 offset:512
  v_mfma_f32_16x16x32_bf16 v[36:39], a[36:39], v[160:163], v[36:39]
  buffer_load_dwordx4 v[132:135], v248, s[36:39], s75 offen sc1
  ds_read_b64_tr_b16 a[18:19], v10 offset:4608
  v_mfma_f32_16x16x32_bf16 a[128:131], a[40:43], v[160:163], a[128:131]
  ds_read_b64_tr_b16 a[20:21], v11 offset:512
  v_mfma_f32_16x16x32_bf16 a[132:135], a[44:47], v[160:163], a[132:135]
  ds_read_b64_tr_b16 a[22:23], v11 offset:4608
  v_mfma_f32_16x16x32_bf16 v[40:43], a[48:51], v[160:163], v[40:43]
  ds_read_b64_tr_b16 a[24:25], v10 offset:768
  v_mfma_f32_16x16x32_bf16 v[44:47], a[52:55], v[160:163], v[44:47]
  buffer_load_dwordx4 v245, s[40:43], s69 offen offset:1024  lds
  ds_read_b64_tr_b16 a[26:27], v10 offset:4864
  v_mfma_f32_16x16x32_bf16 a[136:139], a[56:59], v[160:163], a[136:139]
  ds_read_b64_tr_b16 a[28:29], v11 offset:768
  v_mfma_f32_16x16x32_bf16 a[140:143], a[60:63], v[160:163], a[140:143]
  ds_read_b64_tr_b16 a[30:31], v11 offset:4864
  v_mfma_f32_16x16x32_bf16 v[48:51], a[32:35], v[164:167], v[48:51]
  v_mfma_f32_16x16x32_bf16 v[52:55], a[36:39], v[164:167], v[52:55]
  buffer_load_dwordx4 v[136:139], v248, s[36:39], s76 offen sc1
  v_mfma_f32_16x16x32_bf16 a[144:147], a[40:43], v[164:167], a[144:147]
  v_mfma_f32_16x16x32_bf16 a[148:151], a[44:47], v[164:167], a[148:151]
  v_mfma_f32_16x16x32_bf16 v[56:59], a[48:51], v[164:167], v[56:59]
  v_mfma_f32_16x16x32_bf16 v[60:63], a[52:55], v[164:167], v[60:63]
  buffer_load_dwordx4 v246, s[40:43], s69 offen offset:2048  lds
  v_mfma_f32_16x16x32_bf16 a[152:155], a[56:59], v[164:167], a[152:155]
  v_mfma_f32_16x16x32_bf16 a[156:159], a[60:63], v[164:167], a[156:159]
  v_mfma_f32_16x16x32_bf16 v[64:67], a[32:35], v[168:171], v[64:67]
  v_mfma_f32_16x16x32_bf16 v[68:71], a[36:39], v[168:171], v[68:71]
  buffer_load_dwordx4 v[140:143], v248, s[36:39], s77 offen sc1
  v_mfma_f32_16x16x32_bf16 a[160:163], a[40:43], v[168:171], a[160:163]
  v_mfma_f32_16x16x32_bf16 a[164:167], a[44:47], v[168:171], a[164:167]
  v_mfma_f32_16x16x32_bf16 v[72:75], a[48:51], v[168:171], v[72:75]
  v_mfma_f32_16x16x32_bf16 v[76:79], a[52:55], v[168:171], v[76:79]
  buffer_load_dwordx4 v247, s[40:43], s69 offen offset:3072  lds
  v_mfma_f32_16x16x32_bf16 a[168:171], a[56:59], v[168:171], a[168:171]
  v_mfma_f32_16x16x32_bf16 a[172:175], a[60:63], v[168:171], a[172:175]
  v_mfma_f32_16x16x32_bf16 v[80:83], a[32:35], v[172:175], v[80:83]
  v_mfma_f32_16x16x32_bf16 v[84:87], a[36:39], v[172:175], v[84:87]
  buffer_load_dwordx4 v[144:147], v248, s[36:39], s78 offen sc1
  v_mfma_f32_16x16x32_bf16 a[176:179], a[40:43], v[172:175], a[176:179]
  v_mfma_f32_16x16x32_bf16 a[180:183], a[44:47], v[172:175], a[180:183]
  v_mfma_f32_16x16x32_bf16 v[88:91], a[48:51], v[172:175], v[88:91]
  s_add_u32 m0, s59, 24576
  s_xor_b32 s69, s1, 0xb0000
  v_mfma_f32_16x16x32_bf16 v[92:95], a[52:55], v[172:175], v[92:95]
  buffer_load_dwordx4 v244, s[40:43], s69 offen offset:0  lds
  v_mfma_f32_16x16x32_bf16 a[184:187], a[56:59], v[172:175], a[184:187]
  v_mfma_f32_16x16x32_bf16 a[188:191], a[60:63], v[172:175], a[188:191]
  v_mfma_f32_16x16x32_bf16 v[96:99], a[32:35], v[176:179], v[96:99]
  v_mfma_f32_16x16x32_bf16 v[100:103], a[36:39], v[176:179], v[100:103]
  buffer_load_dwordx4 v[148:151], v248, s[36:39], s79 offen sc1
  v_mfma_f32_16x16x32_bf16 a[192:195], a[40:43], v[176:179], a[192:195]
  v_mfma_f32_16x16x32_bf16 a[196:199], a[44:47], v[176:179], a[196:199]
  v_mfma_f32_16x16x32_bf16 v[104:107], a[48:51], v[176:179], v[104:107]
  v_mfma_f32_16x16x32_bf16 v[108:111], a[52:55], v[176:179], v[108:111]
  buffer_load_dwordx4 v[152:155], v248, s[36:39], s80 offen sc1
  v_xor_b32 v248, 0x400, v248
  v_mfma_f32_16x16x32_bf16 a[200:203], a[56:59], v[176:179], a[200:203]
  v_mfma_f32_16x16x32_bf16 a[204:207], a[60:63], v[176:179], a[204:207]
  v_mfma_f32_16x16x32_bf16 v[112:115], a[32:35], v[180:183], v[112:115]
  v_mfma_f32_16x16x32_bf16 v[116:119], a[36:39], v[180:183], v[116:119]
  buffer_load_dwordx4 v245, s[40:43], s69 offen offset:1024  lds
  v_mfma_f32_16x16x32_bf16 a[208:211], a[40:43], v[180:183], a[208:211]
  v_mfma_f32_16x16x32_bf16 a[212:215], a[44:47], v[180:183], a[212:215]
  v_mfma_f32_16x16x32_bf16 v[120:123], a[48:51], v[180:183], v[120:123]
  v_mfma_f32_16x16x32_bf16 v[124:127], a[52:55], v[180:183], v[124:127]
  v_mfma_f32_16x16x32_bf16 a[216:219], a[56:59], v[180:183], a[216:219]
  v_mfma_f32_16x16x32_bf16 a[220:223], a[60:63], v[180:183], a[220:223]
  s_waitcnt vmcnt(21) lgkmcnt(0)
  v_mfma_f32_16x16x32_bf16 v[16:19], a[64:67], v[184:187], v[16:19]
  ds_read_b64_tr_b16 a[32:33], v10 offset:8192
  v_mfma_f32_16x16x32_bf16 v[20:23], a[68:71], v[184:187], v[20:23]
  buffer_load_dwordx4 v[156:159], v248, s[36:39], s74 offen sc1
  ds_read_b64_tr_b16 a[34:35], v10 offset:12288
  v_mfma_f32_16x16x32_bf16 a[112:115], a[72:75], v[184:187], a[112:115]
  ds_read_b64_tr_b16 a[36:37], v11 offset:8192
  v_mfma_f32_16x16x32_bf16 a[116:119], a[76:79], v[184:187], a[116:119]
  ds_read_b64_tr_b16 a[38:39], v11 offset:12288
  v_mfma_f32_16x16x32_bf16 v[24:27], a[80:83], v[184:187], v[24:27]
  ds_read_b64_tr_b16 a[40:41], v10 offset:8448
  v_mfma_f32_16x16x32_bf16 v[28:31], a[84:87], v[184:187], v[28:31]
  buffer_load_dwordx4 v246, s[40:43], s69 offen offset:2048  lds
  ds_read_b64_tr_b16 a[42:43], v10 offset:12544
  v_mfma_f32_16x16x32_bf16 a[120:123], a[88:91], v[184:187], a[120:123]
  ds_read_b64_tr_b16 a[44:45], v11 offset:8448
  v_mfma_f32_16x16x32_bf16 a[124:127], a[92:95], v[184:187], a[124:127]
  ds_read_b64_tr_b16 a[46:47], v11 offset:12544
  v_mfma_f32_16x16x32_bf16 v[32:35], a[64:67], v[188:191], v[32:35]
  ds_read_b64_tr_b16 a[48:49], v10 offset:8704
  v_mfma_f32_16x16x32_bf16 v[36:39], a[68:71], v[188:191], v[36:39]
  buffer_load_dwordx4 v[160:163], v248, s[36:39], s75 offen sc1
  ds_read_b64_tr_b16 a[50:51], v10 offset:12800
  v_mfma_f32_16x16x32_bf16 a[128:131], a[72:75], v[188:191], a[128:131]
  ds_read_b64_tr_b16 a[52:53], v11 offset:8704
  v_mfma_f32_16x16x32_bf16 a[132:135], a[76:79], v[188:191], a[132:135]
  ds_read_b64_tr_b16 a[54:55], v11 offset:12800
  v_mfma_f32_16x16x32_bf16 v[40:43], a[80:83], v[188:191], v[40:43]
  ds_read_b64_tr_b16 a[56:57], v10 offset:8960
  v_mfma_f32_16x16x32_bf16 v[44:47], a[84:87], v[188:191], v[44:47]
  buffer_load_dwordx4 v247, s[40:43], s69 offen offset:3072  lds
  ds_read_b64_tr_b16 a[58:59], v10 offset:13056
  v_mfma_f32_16x16x32_bf16 a[136:139], a[88:91], v[188:191], a[136:139]
  ds_read_b64_tr_b16 a[60:61], v11 offset:8960
  v_mfma_f32_16x16x32_bf16 a[140:143], a[92:95], v[188:191], a[140:143]
  ds_read_b64_tr_b16 a[62:63], v11 offset:13056
  v_mfma_f32_16x16x32_bf16 v[48:51], a[64:67], v[192:195], v[48:51]
  v_mfma_f32_16x16x32_bf16 v[52:55], a[68:71], v[192:195], v[52:55]
  buffer_load_dwordx4 v[164:167], v248, s[36:39], s76 offen sc1
  v_mfma_f32_16x16x32_bf16 a[144:147], a[72:75], v[192:195], a[144:147]
  v_mfma_f32_16x16x32_bf16 a[148:151], a[76:79], v[192:195], a[148:151]
  v_mfma_f32_16x16x32_bf16 v[56:59], a[80:83], v[192:195], v[56:59]
  s_add_u32 m0, s59, 28672
  s_xor_b32 s69, s1, 0xb8000
  v_mfma_f32_16x16x32_bf16 v[60:63], a[84:87], v[192:195], v[60:63]
  buffer_load_dwordx4 v244, s[40:43], s69 offen offset:0  lds
  v_mfma_f32_16x16x32_bf16 a[152:155], a[88:91], v[192:195], a[152:155]
  v_mfma_f32_16x16x32_bf16 a[156:159], a[92:95], v[192:195], a[156:159]
  v_mfma_f32_16x16x32_bf16 v[64:67], a[64:67], v[196:199], v[64:67]
  v_mfma_f32_16x16x32_bf16 v[68:71], a[68:71], v[196:199], v[68:71]
  buffer_load_dwordx4 v[168:171], v248, s[36:39], s77 offen sc1
  v_mfma_f32_16x16x32_bf16 a[160:163], a[72:75], v[196:199], a[160:163]
  v_mfma_f32_16x16x32_bf16 a[164:167], a[76:79], v[196:199], a[164:167]
  v_mfma_f32_16x16x32_bf16 v[72:75], a[80:83], v[196:199], v[72:75]
  v_mfma_f32_16x16x32_bf16 v[76:79], a[84:87], v[196:199], v[76:79]
  buffer_load_dwordx4 v245, s[40:43], s69 offen offset:1024  lds
  v_mfma_f32_16x16x32_bf16 a[168:171], a[88:91], v[196:199], a[168:171]
  v_mfma_f32_16x16x32_bf16 a[172:175], a[92:95], v[196:199], a[172:175]
  v_mfma_f32_16x16x32_bf16 v[80:83], a[64:67], v[200:203], v[80:83]
  v_mfma_f32_16x16x32_bf16 v[84:87], a[68:71], v[200:203], v[84:87]
  buffer_load_dwordx4 v[172:175], v248, s[36:39], s78 offen sc1
  v_mfma_f32_16x16x32_bf16 a[176:179], a[72:75], v[200:203], a[176:179]
  v_mfma_f32_16x16x32_bf16 a[180:183], a[76:79], v[200:203], a[180:183]
  v_mfma_f32_16x16x32_bf16 v[88:91], a[80:83], v[200:203], v[88:91]
  v_mfma_f32_16x16x32_bf16 v[92:95], a[84:87], v[200:203], v[92:95]
  buffer_load_dwordx4 v246, s[40:43], s69 offen offset:2048  lds
  v_mfma_f32_16x16x32_bf16 a[184:187], a[88:91], v[200:203], a[184:187]
  v_mfma_f32_16x16x32_bf16 a[188:191], a[92:95], v[200:203], a[188:191]
  v_mfma_f32_16x16x32_bf16 v[96:99], a[64:67], v[204:207], v[96:99]
  v_mfma_f32_16x16x32_bf16 v[100:103], a[68:71], v[204:207], v[100:103]
  buffer_load_dwordx4 v[176:179], v248, s[36:39], s79 offen sc1
  v_mfma_f32_16x16x32_bf16 a[192:195], a[72:75], v[204:207], a[192:195]
  v_mfma_f32_16x16x32_bf16 a[196:199], a[76:79], v[204:207], a[196:199]
  v_mfma_f32_16x16x32_bf16 v[104:107], a[80:83], v[204:207], v[104:107]
  v_mfma_f32_16x16x32_bf16 v[108:111], a[84:87], v[204:207], v[108:111]
  buffer_load_dwordx4 v[180:183], v248, s[36:39], s80 offen sc1
  v_xor_b32 v248, 0xc00, v248
  v_mfma_f32_16x16x32_bf16 a[200:203], a[88:91], v[204:207], a[200:203]
  v_mfma_f32_16x16x32_bf16 a[204:207], a[92:95], v[204:207], a[204:207]
  v_mfma_f32_16x16x32_bf16 v[112:115], a[64:67], v[208:211], v[112:115]
  v_mfma_f32_16x16x32_bf16 v[116:119], a[68:71], v[208:211], v[116:119]
  buffer_load_dwordx4 v247, s[40:43], s69 offen offset:3072  lds
  v_mfma_f32_16x16x32_bf16 a[208:211], a[72:75], v[208:211], a[208:211]
  v_mfma_f32_16x16x32_bf16 a[212:215], a[76:79], v[208:211], a[212:215]
  v_mfma_f32_16x16x32_bf16 v[120:123], a[80:83], v[208:211], v[120:123]
  v_mfma_f32_16x16x32_bf16 v[124:127], a[84:87], v[208:211], v[124:127]
  v_mfma_f32_16x16x32_bf16 a[216:219], a[88:91], v[208:211], a[216:219]
  v_mfma_f32_16x16x32_bf16 a[220:223], a[92:95], v[208:211], a[220:223]
  s_waitcnt vmcnt(18) lgkmcnt(0)
  v_mfma_f32_16x16x32_bf16 v[16:19], a[224:227], v[212:215], v[16:19]
  ds_read_b64_tr_b16 a[64:65], v10 offset:16384
  v_mfma_f32_16x16x32_bf16 v[20:23], a[228:231], v[212:215], v[20:23]
  buffer_load_dwordx4 v[184:187], v248, s[36:39], s74 offen sc1
  ds_read_b64_tr_b16 a[66:67], v10 offset:20480
  v_mfma_f32_16x16x32_bf16 a[112:115], a[232:235], v[212:215], a[112:115]
  ds_read_b64_tr_b16 a[68:69], v11 offset:16384
  v_mfma_f32_16x16x32_bf16 a[116:119], a[236:239], v[212:215], a[116:119]
  ds_read_b64_tr_b16 a[70:71], v11 offset:20480
  s_add_u32 m0, s59, 0
  s_xor_b32 s69, s1, 0xc0000
  v_mfma_f32_16x16x32_bf16 v[24:27], a[240:243], v[212:215], v[24:27]
  buffer_load_dwordx4 v244, s[40:43], s69 offen offset:0  lds
  ds_read_b64_tr_b16 a[72:73], v10 offset:16640
  v_mfma_f32_16x16x32_bf16 v[28:31], a[244:247], v[212:215], v[28:31]
  ds_read_b64_tr_b16 a[74:75], v10 offset:20736
  v_mfma_f32_16x16x32_bf16 a[120:123], a[248:251], v[212:215], a[120:123]
  ds_read_b64_tr_b16 a[76:77], v11 offset:16640
  v_mfma_f32_16x16x32_bf16 a[124:127], a[252:255], v[212:215], a[124:127]
  ds_read_b64_tr_b16 a[78:79], v11 offset:20736
  v_mfma_f32_16x16x32_bf16 v[32:35], a[224:227], v[216:219], v[32:35]
  buffer_load_dwordx4 v[188:191], v248, s[36:39], s75 offen sc1
  ds_read_b64_tr_b16 a[80:81], v10 offset:16896
  v_mfma_f32_16x16x32_bf16 v[36:39], a[228:231], v[216:219], v[36:39]
  ds_read_b64_tr_b16 a[82:83], v10 offset:20992
  v_mfma_f32_16x16x32_bf16 a[128:131], a[232:235], v[216:219], a[128:131]
  ds_read_b64_tr_b16 a[84:85], v11 offset:16896
  v_mfma_f32_16x16x32_bf16 a[132:135], a[236:239], v[216:219], a[132:135]
  ds_read_b64_tr_b16 a[86:87], v11 offset:20992
  v_mfma_f32_16x16x32_bf16 v[40:43], a[240:243], v[216:219], v[40:43]
  buffer_load_dwordx4 v245, s[40:43], s69 offen offset:1024  lds
  ds_read_b64_tr_b16 a[88:89], v10 offset:17152
  v_mfma_f32_16x16x32_bf16 v[44:47], a[244:247], v[216:219], v[44:47]
  ds_read_b64_tr_b16 a[90:91], v10 offset:21248
  v_mfma_f32_16x16x32_bf16 a[136:139], a[248:251], v[216:219], a[136:139]
  ds_read_b64_tr_b16 a[92:93], v11 offset:17152
  v_mfma_f32_16x16x32_bf16 a[140:143], a[252:255], v[216:219], a[140:143]
  ds_read_b64_tr_b16 a[94:95], v11 offset:21248
  v_mfma_f32_16x16x32_bf16 v[48:51], a[224:227], v[220:223], v[48:51]
  buffer_load_dwordx4 v[192:195], v248, s[36:39], s76 offen sc1
  v_mfma_f32_16x16x32_bf16 v[52:55], a[228:231], v[220:223], v[52:55]
  v_mfma_f32_16x16x32_bf16 a[144:147], a[232:235], v[220:223], a[144:147]
  v_mfma_f32_16x16x32_bf16 a[148:151], a[236:239], v[220:223], a[148:151]
  buffer_load_dwordx4 v246, s[40:43], s69 offen offset:2048  lds
  v_mfma_f32_16x16x32_bf16 v[56:59], a[240:243], v[220:223], v[56:59]
  v_mfma_f32_16x16x32_bf16 v[60:63], a[244:247], v[220:223], v[60:63]
  v_mfma_f32_16x16x32_bf16 a[152:155], a[248:251], v[220:223], a[152:155]
  v_mfma_f32_16x16x32_bf16 a[156:159], a[252:255], v[220:223], a[156:159]
  buffer_load_dwordx4 v[196:199], v248, s[36:39], s77 offen sc1
  v_mfma_f32_16x16x32_bf16 v[64:67], a[224:227], v[224:227], v[64:67]
  v_mfma_f32_16x16x32_bf16 v[68:71], a[228:231], v[224:227], v[68:71]
  v_mfma_f32_16x16x32_bf16 a[160:163], a[232:235], v[224:227], a[160:163]
  v_mfma_f32_16x16x32_bf16 a[164:167], a[236:239], v[224:227], a[164:167]
  buffer_load_dwordx4 v247, s[40:43], s69 offen offset:3072  lds
  v_mfma_f32_16x16x32_bf16 v[72:75], a[240:243], v[224:227], v[72:75]
  v_mfma_f32_16x16x32_bf16 v[76:79], a[244:247], v[224:227], v[76:79]
  v_mfma_f32_16x16x32_bf16 a[168:171], a[248:251], v[224:227], a[168:171]
  v_mfma_f32_16x16x32_bf16 a[172:175], a[252:255], v[224:227], a[172:175]
  buffer_load_dwordx4 v[200:203], v248, s[36:39], s78 offen sc1
  v_mfma_f32_16x16x32_bf16 v[80:83], a[224:227], v[228:231], v[80:83]
  v_mfma_f32_16x16x32_bf16 v[84:87], a[228:231], v[228:231], v[84:87]
  v_mfma_f32_16x16x32_bf16 a[176:179], a[232:235], v[228:231], a[176:179]
  s_add_u32 m0, s59, 4096
  s_xor_b32 s69, s1, 0xc8000
  v_mfma_f32_16x16x32_bf16 a[180:183], a[236:239], v[228:231], a[180:183]
  buffer_load_dwordx4 v244, s[40:43], s69 offen offset:0  lds
  v_mfma_f32_16x16x32_bf16 v[88:91], a[240:243], v[228:231], v[88:91]
  v_mfma_f32_16x16x32_bf16 v[92:95], a[244:247], v[228:231], v[92:95]
  v_mfma_f32_16x16x32_bf16 a[184:187], a[248:251], v[228:231], a[184:187]
  buffer_load_dwordx4 v[204:207], v248, s[36:39], s79 offen sc1
  v_mfma_f32_16x16x32_bf16 a[188:191], a[252:255], v[228:231], a[188:191]
  v_mfma_f32_16x16x32_bf16 v[96:99], a[224:227], v[232:235], v[96:99]
  v_mfma_f32_16x16x32_bf16 v[100:103], a[228:231], v[232:235], v[100:103]
  v_mfma_f32_16x16x32_bf16 a[192:195], a[232:235], v[232:235], a[192:195]
  buffer_load_dwordx4 v245, s[40:43], s69 offen offset:1024  lds
  v_mfma_f32_16x16x32_bf16 a[196:199], a[236:239], v[232:235], a[196:199]
  v_mfma_f32_16x16x32_bf16 v[104:107], a[240:243], v[232:235], v[104:107]
  v_mfma_f32_16x16x32_bf16 v[108:111], a[244:247], v[232:235], v[108:111]
  v_mfma_f32_16x16x32_bf16 a[200:203], a[248:251], v[232:235], a[200:203]
  buffer_load_dwordx4 v[208:211], v248, s[36:39], s80 offen sc1
  v_xor_b32 v248, 0x400, v248
  v_mfma_f32_16x16x32_bf16 a[204:207], a[252:255], v[232:235], a[204:207]
  v_mfma_f32_16x16x32_bf16 v[112:115], a[224:227], v[236:239], v[112:115]
  v_mfma_f32_16x16x32_bf16 v[116:119], a[228:231], v[236:239], v[116:119]
  v_mfma_f32_16x16x32_bf16 a[208:211], a[232:235], v[236:239], a[208:211]
  buffer_load_dwordx4 v246, s[40:43], s69 offen offset:2048  lds
  v_mfma_f32_16x16x32_bf16 a[212:215], a[236:239], v[236:239], a[212:215]
  v_mfma_f32_16x16x32_bf16 v[120:123], a[240:243], v[236:239], v[120:123]
  v_mfma_f32_16x16x32_bf16 v[124:127], a[244:247], v[236:239], v[124:127]
  v_mfma_f32_16x16x32_bf16 a[216:219], a[248:251], v[236:239], a[216:219]
  v_mfma_f32_16x16x32_bf16 a[220:223], a[252:255], v[236:239], a[220:223]
  s_waitcnt vmcnt(14) lgkmcnt(0)
  v_mfma_f32_16x16x32_bf16 v[16:19], a[0:3], v[128:131], v[16:19]
  ds_read_b64_tr_b16 a[224:225], v10 offset:24576
  v_mfma_f32_16x16x32_bf16 v[20:23], a[4:7], v[128:131], v[20:23]
  buffer_load_dwordx4 v[212:215], v248, s[36:39], s74 offen sc1
  ds_read_b64_tr_b16 a[226:227], v10 offset:28672
  v_mfma_f32_16x16x32_bf16 a[112:115], a[8:11], v[128:131], a[112:115]
  ds_read_b64_tr_b16 a[228:229], v11 offset:24576
  v_mfma_f32_16x16x32_bf16 a[116:119], a[12:15], v[128:131], a[116:119]
  ds_read_b64_tr_b16 a[230:231], v11 offset:28672
  v_mfma_f32_16x16x32_bf16 v[24:27], a[16:19], v[128:131], v[24:27]
  ds_read_b64_tr_b16 a[232:233], v10 offset:24832
  v_mfma_f32_16x16x32_bf16 v[28:31], a[20:23], v[128:131], v[28:31]
  buffer_load_dwordx4 v247, s[40:43], s69 offen offset:3072  lds
  ds_read_b64_tr_b16 a[234:235], v10 offset:28928
  v_mfma_f32_16x16x32_bf16 a[120:123], a[24:27], v[128:131], a[120:123]
  ds_read_b64_tr_b16 a[236:237], v11 offset:24832
  v_mfma_f32_16x16x32_bf16 a[124:127], a[28:31], v[128:131], a[124:127]
  ds_read_b64_tr_b16 a[238:239], v11 offset:28928
  v_mfma_f32_16x16x32_bf16 v[32:35], a[0:3], v[132:135], v[32:35]
  ds_read_b64_tr_b16 a[240:241], v10 offset:25088
  v_mfma_f32_16x16x32_bf16 v[36:39], a[4:7], v[132:135], v[36:39]
  buffer_load_dwordx4 v[216:219], v248, s[36:39], s75 offen sc1
  ds_read_b64_tr_b16 a[242:243], v10 offset:29184
  v_mfma_f32_16x16x32_bf16 a[128:131], a[8:11], v[132:135], a[128:131]
  ds_read_b64_tr_b16 a[244:245], v11 offset:25088
  v_mfma_f32_16x16x32_bf16 a[132:135], a[12:15], v[132:135], a[132:135]
  ds_read_b64_tr_b16 a[246:247], v11 offset:29184
  v_mfma_f32_16x16x32_bf16 v[40:43], a[16:19], v[132:135], v[40:43]
  ds_read_b64_tr_b16 a[248:249], v10 offset:25344
  s_add_u32 m0, s59, 8192
  s_xor_b32 s69, s1, 0xd0000
  v_mfma_f32_16x16x32_bf16 v[44:47], a[20:23], v[132:135], v[44:47]
  buffer_load_dwordx4 v244, s[40:43], s69 offen offset:0  lds
  ds_read_b64_tr_b16 a[250:251], v10 offset:29440
  v_mfma_f32_16x16x32_bf16 a[136:139], a[24:27], v[132:135], a[136:139]
  ds_read_b64_tr_b16 a[252:253], v11 offset:25344
  v_mfma_f32_16x16x32_bf16 a[140:143], a[28:31], v[132:135], a[140:143]
  ds_read_b64_tr_b16 a[254:255], v11 offset:29440
  v_mfma_f32_16x16x32_bf16 v[48:51], a[0:3], v[136:139], v[48:51]
  v_mfma_f32_16x16x32_bf16 v[52:55], a[4:7], v[136:139], v[52:55]
  buffer_load_dwordx4 v[220:223], v248, s[36:39], s76 offen sc1
  v_mfma_f32_16x16x32_bf16 a[144:147], a[8:11], v[136:139], a[144:147]
  v_mfma_f32_16x16x32_bf16 a[148:151], a[12:15], v[136:139], a[148:151]
  v_mfma_f32_16x16x32_bf16 v[56:59], a[16:19], v[136:139], v[56:59]
  v_mfma_f32_16x16x32_bf16 v[60:63], a[20:23], v[136:139], v[60:63]
  buffer_load_dwordx4 v245, s[40:43], s69 offen offset:1024  lds
  v_mfma_f32_16x16x32_bf16 a[152:155], a[24:27], v[136:139], a[152:155]
  v_mfma_f32_16x16x32_bf16 a[156:159], a[28:31], v[136:139], a[156:159]
  v_mfma_f32_16x16x32_bf16 v[64:67], a[0:3], v[140:143], v[64:67]
  v_mfma_f32_16x16x32_bf16 v[68:71], a[4:7], v[140:143], v[68:71]
  buffer_load_dwordx4 v[224:227], v248, s[36:39], s77 offen sc1
  v_mfma_f32_16x16x32_bf16 a[160:163], a[8:11], v[140:143], a[160:163]
  v_mfma_f32_16x16x32_bf16 a[164:167], a[12:15], v[140:143], a[164:167]
  v_mfma_f32_16x16x32_bf16 v[72:75], a[16:19], v[140:143], v[72:75]
  v_mfma_f32_16x16x32_bf16 v[76:79], a[20:23], v[140:143], v[76:79]
  buffer_load_dwordx4 v246, s[40:43], s69 offen offset:2048  lds
  v_mfma_f32_16x16x32_bf16 a[168:171], a[24:27], v[140:143], a[168:171]
  v_mfma_f32_16x16x32_bf16 a[172:175], a[28:31], v[140:143], a[172:175]
  v_mfma_f32_16x16x32_bf16 v[80:83], a[0:3], v[144:147], v[80:83]
  v_mfma_f32_16x16x32_bf16 v[84:87], a[4:7], v[144:147], v[84:87]
  buffer_load_dwordx4 v[228:231], v248, s[36:39], s78 offen sc1
  v_mfma_f32_16x16x32_bf16 a[176:179], a[8:11], v[144:147], a[176:179]
  v_mfma_f32_16x16x32_bf16 a[180:183], a[12:15], v[144:147], a[180:183]
  v_mfma_f32_16x16x32_bf16 v[88:91], a[16:19], v[144:147], v[88:91]
  v_mfma_f32_16x16x32_bf16 v[92:95], a[20:23], v[144:147], v[92:95]
  buffer_load_dwordx4 v247, s[40:43], s69 offen offset:3072  lds
  v_mfma_f32_16x16x32_bf16 a[184:187], a[24:27], v[144:147], a[184:187]
  v_mfma_f32_16x16x32_bf16 a[188:191], a[28:31], v[144:147], a[188:191]
  v_mfma_f32_16x16x32_bf16 v[96:99], a[0:3], v[148:151], v[96:99]
  v_mfma_f32_16x16x32_bf16 v[100:103], a[4:7], v[148:151], v[100:103]
  buffer_load_dwordx4 v[232:235], v248, s[36:39], s79 offen sc1
  v_mfma_f32_16x16x32_bf16 a[192:195], a[8:11], v[148:151], a[192:195]
  v_mfma_f32_16x16x32_bf16 a[196:199], a[12:15], v[148:151], a[196:199]
  v_mfma_f32_16x16x32_bf16 v[104:107], a[16:19], v[148:151], v[104:107]
  v_mfma_f32_16x16x32_bf16 v[108:111], a[20:23], v[148:151], v[108:111]
  buffer_load_dwordx4 v[236:239], v248, s[36:39], s80 offen sc1
  v_xor_b32 v248, 0x1c00, v248
  v_mfma_f32_16x16x32_bf16 a[200:203], a[24:27], v[148:151], a[200:203]
  v_mfma_f32_16x16x32_bf16 a[204:207], a[28:31], v[148:151], a[204:207]
  v_mfma_f32_16x16x32_bf16 v[112:115], a[0:3], v[152:155], v[112:115]
  s_add_u32 m0, s59, 12288
  s_xor_b32 s69, s1, 0xd8000
  v_mfma_f32_16x16x32_bf16 v[116:119], a[4:7], v[152:155], v[116:119]
  buffer_load_dwordx4 v244, s[40:43], s69 offen offset:0  lds
  v_mfma_f32_16x16x32_bf16 a[208:211], a[8:11], v[152:155], a[208:211]
  v_mfma_f32_16x16x32_bf16 a[212:215], a[12:15], v[152:155], a[212:215]
  v_mfma_f32_16x16x32_bf16 v[120:123], a[16:19], v[152:155], v[120:123]
  v_mfma_f32_16x16x32_bf16 v[124:127], a[20:23], v[152:155], v[124:127]
  v_mfma_f32_16x16x32_bf16 a[216:219], a[24:27], v[152:155], a[216:219]
  v_mfma_f32_16x16x32_bf16 a[220:223], a[28:31], v[152:155], a[220:223]
  s_waitcnt vmcnt(28) lgkmcnt(0)
  v_mfma_f32_16x16x32_bf16 v[16:19], a[32:35], v[156:159], v[16:19]
  v_mfma_f32_16x16x32_bf16 v[20:23], a[36:39], v[156:159], v[20:23]
  buffer_load_dwordx4 v[128:131], v248, s[36:39], s74 offen sc1
  v_mfma_f32_16x16x32_bf16 a[112:115], a[40:43], v[156:159], a[112:115]
  v_mfma_f32_16x16x32_bf16 a[116:119], a[44:47], v[156:159], a[116:119]
  v_mfma_f32_16x16x32_bf16 v[24:27], a[48:51], v[156:159], v[24:27]
  buffer_load_dwordx4 v245, s[40:43], s69 offen offset:1024  lds
  v_mfma_f32_16x16x32_bf16 v[28:31], a[52:55], v[156:159], v[28:31]
  v_mfma_f32_16x16x32_bf16 a[120:123], a[56:59], v[156:159], a[120:123]
  v_mfma_f32_16x16x32_bf16 a[124:127], a[60:63], v[156:159], a[124:127]
  v_mfma_f32_16x16x32_bf16 v[32:35], a[32:35], v[160:163], v[32:35]
  buffer_load_dwordx4 v[132:135], v248, s[36:39], s75 offen sc1
  v_mfma_f32_16x16x32_bf16 v[36:39], a[36:39], v[160:163], v[36:39]
  v_mfma_f32_16x16x32_bf16 a[128:131], a[40:43], v[160:163], a[128:131]
  v_mfma_f32_16x16x32_bf16 a[132:135], a[44:47], v[160:163], a[132:135]
  v_mfma_f32_16x16x32_bf16 v[40:43], a[48:51], v[160:163], v[40:43]
  buffer_load_dwordx4 v246, s[40:43], s69 offen offset:2048  lds
  v_mfma_f32_16x16x32_bf16 v[44:47], a[52:55], v[160:163], v[44:47]
  v_mfma_f32_16x16x32_bf16 a[136:139], a[56:59], v[160:163], a[136:139]
  v_mfma_f32_16x16x32_bf16 a[140:143], a[60:63], v[160:163], a[140:143]
  v_mfma_f32_16x16x32_bf16 v[48:51], a[32:35], v[164:167], v[48:51]
  buffer_load_dwordx4 v[136:139], v248, s[36:39], s76 offen sc1
  v_mfma_f32_16x16x32_bf16 v[52:55], a[36:39], v[164:167], v[52:55]
  v_mfma_f32_16x16x32_bf16 a[144:147], a[40:43], v[164:167], a[144:147]
  v_mfma_f32_16x16x32_bf16 a[148:151], a[44:47], v[164:167], a[148:151]
  buffer_load_dwordx4 v247, s[40:43], s69 offen offset:3072  lds
  v_mfma_f32_16x16x32_bf16 v[56:59], a[48:51], v[164:167], v[56:59]
  v_mfma_f32_16x16x32_bf16 v[60:63], a[52:55], v[164:167], v[60:63]
  v_mfma_f32_16x16x32_bf16 a[152:155], a[56:59], v[164:167], a[152:155]
  v_mfma_f32_16x16x32_bf16 a[156:159], a[60:63], v[164:167], a[156:159]
  buffer_load_dwordx4 v[140:143], v248, s[36:39], s77 offen sc1
  v_mfma_f32_16x16x32_bf16 v[64:67], a[32:35], v[168:171], v[64:67]
  v_mfma_f32_16x16x32_bf16 v[68:71], a[36:39], v[168:171], v[68:71]
  v_mfma_f32_16x16x32_bf16 a[160:163], a[40:43], v[168:171], a[160:163]
  s_add_u32 m0, s59, 16384
  s_xor_b32 s69, s1, 0xe0000
  v_mfma_f32_16x16x32_bf16 a[164:167], a[44:47], v[168:171], a[164:167]
  buffer_load_dwordx4 v244, s[40:43], s69 offen offset:0  lds
  v_mfma_f32_16x16x32_bf16 v[72:75], a[48:51], v[168:171], v[72:75]
  v_mfma_f32_16x16x32_bf16 v[76:79], a[52:55], v[168:171], v[76:79]
  v_mfma_f32_16x16x32_bf16 a[168:171], a[56:59], v[168:171], a[168:171]
  v_mfma_f32_16x16x32_bf16 a[172:175], a[60:63], v[168:171], a[172:175]
  buffer_load_dwordx4 v[144:147], v248, s[36:39], s78 offen sc1
  v_mfma_f32_16x16x32_bf16 v[80:83], a[32:35], v[172:175], v[80:83]
  v_mfma_f32_16x16x32_bf16 v[84:87], a[36:39], v[172:175], v[84:87]
  v_mfma_f32_16x16x32_bf16 a[176:179], a[40:43], v[172:175], a[176:179]
  v_mfma_f32_16x16x32_bf16 a[180:183], a[44:47], v[172:175], a[180:183]
  buffer_load_dwordx4 v245, s[40:43], s69 offen offset:1024  lds
  v_mfma_f32_16x16x32_bf16 v[88:91], a[48:51], v[172:175], v[88:91]
  v_mfma_f32_16x16x32_bf16 v[92:95], a[52:55], v[172:175], v[92:95]
  v_mfma_f32_16x16x32_bf16 a[184:187], a[56:59], v[172:175], a[184:187]
  buffer_load_dwordx4 v[148:151], v248, s[36:39], s79 offen sc1
  v_mfma_f32_16x16x32_bf16 a[188:191], a[60:63], v[172:175], a[188:191]
  v_mfma_f32_16x16x32_bf16 v[96:99], a[32:35], v[176:179], v[96:99]
  v_mfma_f32_16x16x32_bf16 v[100:103], a[36:39], v[176:179], v[100:103]
  v_mfma_f32_16x16x32_bf16 a[192:195], a[40:43], v[176:179], a[192:195]
  buffer_load_dwordx4 v246, s[40:43], s69 offen offset:2048  lds
  v_mfma_f32_16x16x32_bf16 a[196:199], a[44:47], v[176:179], a[196:199]
  v_mfma_f32_16x16x32_bf16 v[104:107], a[48:51], v[176:179], v[104:107]
  v_mfma_f32_16x16x32_bf16 v[108:111], a[52:55], v[176:179], v[108:111]
  v_mfma_f32_16x16x32_bf16 a[200:203], a[56:59], v[176:179], a[200:203]
  buffer_load_dwordx4 v[152:155], v248, s[36:39], s80 offen sc1
  v_xor_b32 v248, 0x400, v248
  v_mfma_f32_16x16x32_bf16 a[204:207], a[60:63], v[176:179], a[204:207]
  v_mfma_f32_16x16x32_bf16 v[112:115], a[32:35], v[180:183], v[112:115]
  v_mfma_f32_16x16x32_bf16 v[116:119], a[36:39], v[180:183], v[116:119]
  v_mfma_f32_16x16x32_bf16 a[208:211], a[40:43], v[180:183], a[208:211]
  buffer_load_dwordx4 v247, s[40:43], s69 offen offset:3072  lds
  v_mfma_f32_16x16x32_bf16 a[212:215], a[44:47], v[180:183], a[212:215]
  v_mfma_f32_16x16x32_bf16 v[120:123], a[48:51], v[180:183], v[120:123]
  v_mfma_f32_16x16x32_bf16 v[124:127], a[52:55], v[180:183], v[124:127]
  v_mfma_f32_16x16x32_bf16 a[216:219], a[56:59], v[180:183], a[216:219]
  v_mfma_f32_16x16x32_bf16 a[220:223], a[60:63], v[180:183], a[220:223]
  s_waitcnt vmcnt(25)
  v_mfma_f32_16x16x32_bf16 v[16:19], a[64:67], v[184:187], v[16:19]
  ds_read_b64_tr_b16 a[0:1], v10 offset:0
  v_mfma_f32_16x16x32_bf16 v[20:23], a[68:71], v[184:187], v[20:23]
  buffer_load_dwordx4 v[156:159], v248, s[36:39], s74 offen sc1
  ds_read_b64_tr_b16 a[2:3], v10 offset:4096
  v_mfma_f32_16x16x32_bf16 a[112:115], a[72:75], v[184:187], a[112:115]
  ds_read_b64_tr_b16 a[4:5], v11 offset:0
  v_mfma_f32_16x16x32_bf16 a[116:119], a[76:79], v[184:187], a[116:119]
  ds_read_b64_tr_b16 a[6:7], v11 offset:4096
  v_mfma_f32_16x16x32_bf16 v[24:27], a[80:83], v[184:187], v[24:27]
  ds_read_b64_tr_b16 a[8:9], v10 offset:256
  s_add_u32 m0, s59, 20480
  s_xor_b32 s69, s1, 0xe8000
  v_mfma_f32_16x16x32_bf16 v[28:31], a[84:87], v[184:187], v[28:31]
  buffer_load_dwordx4 v244, s[40:43], s69 offen offset:0  lds
  ds_read_b64_tr_b16 a[10:11], v10 offset:4352
  v_mfma_f32_16x16x32_bf16 a[120:123], a[88:91], v[184:187], a[120:123]
  ds_read_b64_tr_b16 a[12:13], v11 offset:256
  v_mfma_f32_16x16x32_bf16 a[124:127], a[92:95], v[184:187], a[124:127]
  ds_read_b64_tr_b16 a[14:15], v11 offset:4352
  v_mfma_f32_16x16x32_bf16 v[32:35], a[64:67], v[188:191], v[32:35]
  ds_read_b64_tr_b16 a[16:17], v10 offset:512
  v_mfma_f32_16x16x32_bf16 v[36:39], a[68:71], v[188:191], v[36:39]
  buffer_load_dwordx4 v[160:163], v248, s[36:39], s75 offen sc1
  ds_read_b64_tr_b16 a[18:19], v10 offset:4608
  v_mfma_f32_16x16x32_bf16 a[128:131], a[72:75], v[188:191], a[128:131]
  ds_read_b64_tr_b16 a[20:21], v11 offset:512
  v_mfma_f32_16x16x32_bf16 a[132:135], a[76:79], v[188:191], a[132:135]
  ds_read_b64_tr_b16 a[22:23], v11 offset:4608
  v_mfma_f32_16x16x32_bf16 v[40:43], a[80:83], v[188:191], v[40:43]
  ds_read_b64_tr_b16 a[24:25], v10 offset:768
  v_mfma_f32_16x16x32_bf16 v[44:47], a[84:87], v[188:191], v[44:47]
  buffer_load_dwordx4 v245, s[40:43], s69 offen offset:1024  lds
  ds_read_b64_tr_b16 a[26:27], v10 offset:4864
  v_mfma_f32_16x16x32_bf16 a[136:139], a[88:91], v[188:191], a[136:139]
  ds_read_b64_tr_b16 a[28:29], v11 offset:768
  v_mfma_f32_16x16x32_bf16 a[140:143], a[92:95], v[188:191], a[140:143]
  ds_read_b64_tr_b16 a[30:31], v11 offset:4864
  v_mfma_f32_16x16x32_bf16 v[48:51], a[64:67], v[192:195], v[48:51]
  v_mfma_f32_16x16x32_bf16 v[52:55], a[68:71], v[192:195], v[52:55]
  buffer_load_dwordx4 v[164:167], v248, s[36:39], s76 offen sc1
  v_mfma_f32_16x16x32_bf16 a[144:147], a[72:75], v[192:195], a[144:147]
  v_mfma_f32_16x16x32_bf16 a[148:151], a[76:79], v[192:195], a[148:151]
  v_mfma_f32_16x16x32_bf16 v[56:59], a[80:83], v[192:195], v[56:59]
  v_mfma_f32_16x16x32_bf16 v[60:63], a[84:87], v[192:195], v[60:63]
  buffer_load_dwordx4 v246, s[40:43], s69 offen offset:2048  lds
  v_mfma_f32_16x16x32_bf16 a[152:155], a[88:91], v[192:195], a[152:155]
  v_mfma_f32_16x16x32_bf16 a[156:159], a[92:95], v[192:195], a[156:159]
  v_mfma_f32_16x16x32_bf16 v[64:67], a[64:67], v[196:199], v[64:67]
  v_mfma_f32_16x16x32_bf16 v[68:71], a[68:71], v[196:199], v[68:71]
  buffer_load_dwordx4 v[168:171], v248, s[36:39], s77 offen sc1
  v_mfma_f32_16x16x32_bf16 a[160:163], a[72:75], v[196:199], a[160:163]
  v_mfma_f32_16x16x32_bf16 a[164:167], a[76:79], v[196:199], a[164:167]
  v_mfma_f32_16x16x32_bf16 v[72:75], a[80:83], v[196:199], v[72:75]
  v_mfma_f32_16x16x32_bf16 v[76:79], a[84:87], v[196:199], v[76:79]
  buffer_load_dwordx4 v247, s[40:43], s69 offen offset:3072  lds
  v_mfma_f32_16x16x32_bf16 a[168:171], a[88:91], v[196:199], a[168:171]
  v_mfma_f32_16x16x32_bf16 a[172:175], a[92:95], v[196:199], a[172:175]
  v_mfma_f32_16x16x32_bf16 v[80:83], a[64:67], v[200:203], v[80:83]
  v_mfma_f32_16x16x32_bf16 v[84:87], a[68:71], v[200:203], v[84:87]
  buffer_load_dwordx4 v[172:175], v248, s[36:39], s78 offen sc1
  v_mfma_f32_16x16x32_bf16 a[176:179], a[72:75], v[200:203], a[176:179]
  v_mfma_f32_16x16x32_bf16 a[180:183], a[76:79], v[200:203], a[180:183]
  v_mfma_f32_16x16x32_bf16 v[88:91], a[80:83], v[200:203], v[88:91]
  s_add_u32 m0, s59, 24576
  s_xor_b32 s69, s1, 0xf0000
  v_mfma_f32_16x16x32_bf16 v[92:95], a[84:87], v[200:203], v[92:95]
  buffer_load_dwordx4 v244, s[40:43], s69 offen offset:0  lds
  v_mfma_f32_16x16x32_bf16 a[184:187], a[88:91], v[200:203], a[184:187]
  v_mfma_f32_16x16x32_bf16 a[188:191], a[92:95], v[200:203], a[188:191]
  v_mfma_f32_16x16x32_bf16 v[96:99], a[64:67], v[204:207], v[96:99]
  v_mfma_f32_16x16x32_bf16 v[100:103], a[68:71], v[204:207], v[100:103]
  buffer_load_dwordx4 v[176:179], v248, s[36:39], s79 offen sc1
  v_mfma_f32_16x16x32_bf16 a[192:195], a[72:75], v[204:207], a[192:195]
  v_mfma_f32_16x16x32_bf16 a[196:199], a[76:79], v[204:207], a[196:199]
  v_mfma_f32_16x16x32_bf16 v[104:107], a[80:83], v[204:207], v[104:107]
  v_mfma_f32_16x16x32_bf16 v[108:111], a[84:87], v[204:207], v[108:111]
  buffer_load_dwordx4 v[180:183], v248, s[36:39], s80 offen sc1
  v_xor_b32 v248, 0xc00, v248
  v_mfma_f32_16x16x32_bf16 a[200:203], a[88:91], v[204:207], a[200:203]
  v_mfma_f32_16x16x32_bf16 a[204:207], a[92:95], v[204:207], a[204:207]
  v_mfma_f32_16x16x32_bf16 v[112:115], a[64:67], v[208:211], v[112:115]
  v_mfma_f32_16x16x32_bf16 v[116:119], a[68:71], v[208:211], v[116:119]
  buffer_load_dwordx4 v245, s[40:43], s69 offen offset:1024  lds
  v_mfma_f32_16x16x32_bf16 a[208:211], a[72:75], v[208:211], a[208:211]
  v_mfma_f32_16x16x32_bf16 a[212:215], a[76:79], v[208:211], a[212:215]
  v_mfma_f32_16x16x32_bf16 v[120:123], a[80:83], v[208:211], v[120:123]
  v_mfma_f32_16x16x32_bf16 v[124:127], a[84:87], v[208:211], v[124:127]
  v_mfma_f32_16x16x32_bf16 a[216:219], a[88:91], v[208:211], a[216:219]
  v_mfma_f32_16x16x32_bf16 a[220:223], a[92:95], v[208:211], a[220:223]
  s_waitcnt vmcnt(21) lgkmcnt(0)
  v_mfma_f32_16x16x32_bf16 v[16:19], a[224:227], v[212:215], v[16:19]
  ds_read_b64_tr_b16 a[32:33], v10 offset:8192
  v_mfma_f32_16x16x32_bf16 v[20:23], a[228:231], v[212:215], v[20:23]
  buffer_load_dwordx4 v[184:187], v248, s[36:39], s74 offen sc1
  ds_read_b64_tr_b16 a[34:35], v10 offset:12288
  v_mfma_f32_16x16x32_bf16 a[112:115], a[232:235], v[212:215], a[112:115]
  ds_read_b64_tr_b16 a[36:37], v11 offset:8192
  v_mfma_f32_16x16x32_bf16 a[116:119], a[236:239], v[212:215], a[116:119]
  ds_read_b64_tr_b16 a[38:39], v11 offset:12288
  v_mfma_f32_16x16x32_bf16 v[24:27], a[240:243], v[212:215], v[24:27]
  ds_read_b64_tr_b16 a[40:41], v10 offset:8448
  v_mfma_f32_16x16x32_bf16 v[28:31], a[244:247], v[212:215], v[28:31]
  buffer_load_dwordx4 v246, s[40:43], s69 offen offset:2048  lds
  ds_read_b64_tr_b16 a[42:43], v10 offset:12544
  v_mfma_f32_16x16x32_bf16 a[120:123], a[248:251], v[212:215], a[120:123]
  ds_read_b64_tr_b16 a[44:45], v11 offset:8448
  v_mfma_f32_16x16x32_bf16 a[124:127], a[252:255], v[212:215], a[124:127]
  ds_read_b64_tr_b16 a[46:47], v11 offset:12544
  v_mfma_f32_16x16x32_bf16 v[32:35], a[224:227], v[216:219], v[32:35]
  ds_read_b64_tr_b16 a[48:49], v10 offset:8704
  v_mfma_f32_16x16x32_bf16 v[36:39], a[228:231], v[216:219], v[36:39]
  buffer_load_dwordx4 v[188:191], v248, s[36:39], s75 offen sc1
  ds_read_b64_tr_b16 a[50:51], v10 offset:12800
  v_mfma_f32_16x16x32_bf16 a[128:131], a[232:235], v[216:219], a[128:131]
  ds_read_b64_tr_b16 a[52:53], v11 offset:8704
  v_mfma_f32_16x16x32_bf16 a[132:135], a[236:239], v[216:219], a[132:135]
  ds_read_b64_tr_b16 a[54:55], v11 offset:12800
  v_mfma_f32_16x16x32_bf16 v[40:43], a[240:243], v[216:219], v[40:43]
  ds_read_b64_tr_b16 a[56:57], v10 offset:8960
  v_mfma_f32_16x16x32_bf16 v[44:47], a[244:247], v[216:219], v[44:47]
  buffer_load_dwordx4 v247, s[40:43], s69 offen offset:3072  lds
  ds_read_b64_tr_b16 a[58:59], v10 offset:13056
  v_mfma_f32_16x16x32_bf16 a[136:139], a[248:251], v[216:219], a[136:139]
  ds_read_b64_tr_b16 a[60:61], v11 offset:8960
  v_mfma_f32_16x16x32_bf16 a[140:143], a[252:255], v[216:219], a[140:143]
  ds_read_b64_tr_b16 a[62:63], v11 offset:13056
  v_mfma_f32_16x16x32_bf16 v[48:51], a[224:227], v[220:223], v[48:51]
  v_mfma_f32_16x16x32_bf16 v[52:55], a[228:231], v[220:223], v[52:55]
  buffer_load_dwordx4 v[192:195], v248, s[36:39], s76 offen sc1
  v_mfma_f32_16x16x32_bf16 a[144:147], a[232:235], v[220:223], a[144:147]
  v_mfma_f32_16x16x32_bf16 a[148:151], a[236:239], v[220:223], a[148:151]
  v_mfma_f32_16x16x32_bf16 v[56:59], a[240:243], v[220:223], v[56:59]
  s_add_u32 m0, s59, 28672
  s_xor_b32 s69, s1, 0xf8000
  v_mfma_f32_16x16x32_bf16 v[60:63], a[244:247], v[220:223], v[60:63]
  buffer_load_dwordx4 v244, s[40:43], s69 offen offset:0  lds
  v_mfma_f32_16x16x32_bf16 a[152:155], a[248:251], v[220:223], a[152:155]
  v_mfma_f32_16x16x32_bf16 a[156:159], a[252:255], v[220:223], a[156:159]
  v_mfma_f32_16x16x32_bf16 v[64:67], a[224:227], v[224:227], v[64:67]
  v_mfma_f32_16x16x32_bf16 v[68:71], a[228:231], v[224:227], v[68:71]
  buffer_load_dwordx4 v[196:199], v248, s[36:39], s77 offen sc1
  v_mfma_f32_16x16x32_bf16 a[160:163], a[232:235], v[224:227], a[160:163]
  v_mfma_f32_16x16x32_bf16 a[164:167], a[236:239], v[224:227], a[164:167]
  v_mfma_f32_16x16x32_bf16 v[72:75], a[240:243], v[224:227], v[72:75]
  v_mfma_f32_16x16x32_bf16 v[76:79], a[244:247], v[224:227], v[76:79]
  buffer_load_dwordx4 v245, s[40:43], s69 offen offset:1024  lds
  v_mfma_f32_16x16x32_bf16 a[168:171], a[248:251], v[224:227], a[168:171]
  v_mfma_f32_16x16x32_bf16 a[172:175], a[252:255], v[224:227], a[172:175]
  v_mfma_f32_16x16x32_bf16 v[80:83], a[224:227], v[228:231], v[80:83]
  v_mfma_f32_16x16x32_bf16 v[84:87], a[228:231], v[228:231], v[84:87]
  buffer_load_dwordx4 v[200:203], v248, s[36:39], s78 offen sc1
  v_mfma_f32_16x16x32_bf16 a[176:179], a[232:235], v[228:231], a[176:179]
  v_mfma_f32_16x16x32_bf16 a[180:183], a[236:239], v[228:231], a[180:183]
  v_mfma_f32_16x16x32_bf16 v[88:91], a[240:243], v[228:231], v[88:91]
  v_mfma_f32_16x16x32_bf16 v[92:95], a[244:247], v[228:231], v[92:95]
  buffer_load_dwordx4 v246, s[40:43], s69 offen offset:2048  lds
  v_mfma_f32_16x16x32_bf16 a[184:187], a[248:251], v[228:231], a[184:187]
  v_mfma_f32_16x16x32_bf16 a[188:191], a[252:255], v[228:231], a[188:191]
  v_mfma_f32_16x16x32_bf16 v[96:99], a[224:227], v[232:235], v[96:99]
  v_mfma_f32_16x16x32_bf16 v[100:103], a[228:231], v[232:235], v[100:103]
  buffer_load_dwordx4 v[204:207], v248, s[36:39], s79 offen sc1
  v_mfma_f32_16x16x32_bf16 a[192:195], a[232:235], v[232:235], a[192:195]
  v_mfma_f32_16x16x32_bf16 a[196:199], a[236:239], v[232:235], a[196:199]
  v_mfma_f32_16x16x32_bf16 v[104:107], a[240:243], v[232:235], v[104:107]
  v_mfma_f32_16x16x32_bf16 v[108:111], a[244:247], v[232:235], v[108:111]
  buffer_load_dwordx4 v[208:211], v248, s[36:39], s80 offen sc1
  v_xor_b32 v248, 0x400, v248
  v_mfma_f32_16x16x32_bf16 a[200:203], a[248:251], v[232:235], a[200:203]
  v_mfma_f32_16x16x32_bf16 a[204:207], a[252:255], v[232:235], a[204:207]
  v_mfma_f32_16x16x32_bf16 v[112:115], a[224:227], v[236:239], v[112:115]
  v_mfma_f32_16x16x32_bf16 v[116:119], a[228:231], v[236:239], v[116:119]
  buffer_load_dwordx4 v247, s[40:43], s69 offen offset:3072  lds
  v_mfma_f32_16x16x32_bf16 a[208:211], a[232:235], v[236:239], a[208:211]
  v_mfma_f32_16x16x32_bf16 a[212:215], a[236:239], v[236:239], a[212:215]
  v_mfma_f32_16x16x32_bf16 v[120:123], a[240:243], v[236:239], v[120:123]
  v_mfma_f32_16x16x32_bf16 v[124:127], a[244:247], v[236:239], v[124:127]
  v_mfma_f32_16x16x32_bf16 a[216:219], a[248:251], v[236:239], a[216:219]
  v_mfma_f32_16x16x32_bf16 a[220:223], a[252:255], v[236:239], a[220:223]
  s_waitcnt vmcnt(18) lgkmcnt(0)
  v_mfma_f32_16x16x32_bf16 v[16:19], a[0:3], v[128:131], v[16:19]
  ds_read_b64_tr_b16 a[64:65], v10 offset:16384
  v_mfma_f32_16x16x32_bf16 v[20:23], a[4:7], v[128:131], v[20:23]
  buffer_load_dwordx4 v[212:215], v248, s[36:39], s74 offen sc1
  ds_read_b64_tr_b16 a[66:67], v10 offset:20480
  v_mfma_f32_16x16x32_bf16 a[112:115], a[8:11], v[128:131], a[112:115]
  ds_read_b64_tr_b16 a[68:69], v11 offset:16384
  v_mfma_f32_16x16x32_bf16 a[116:119], a[12:15], v[128:131], a[116:119]
  ds_read_b64_tr_b16 a[70:71], v11 offset:20480
  v_mfma_f32_16x16x32_bf16 v[24:27], a[16:19], v[128:131], v[24:27]
  ds_read_b64_tr_b16 a[72:73], v10 offset:16640
  v_mfma_f32_16x16x32_bf16 v[28:31], a[20:23], v[128:131], v[28:31]
  ds_read_b64_tr_b16 a[74:75], v10 offset:20736
  v_mfma_f32_16x16x32_bf16 a[120:123], a[24:27], v[128:131], a[120:123]
  ds_read_b64_tr_b16 a[76:77], v11 offset:16640
  v_mfma_f32_16x16x32_bf16 a[124:127], a[28:31], v[128:131], a[124:127]
  ds_read_b64_tr_b16 a[78:79], v11 offset:20736
  v_mfma_f32_16x16x32_bf16 v[32:35], a[0:3], v[132:135], v[32:35]
  buffer_load_dwordx4 v[216:219], v248, s[36:39], s75 offen sc1
  ds_read_b64_tr_b16 a[80:81], v10 offset:16896
  v_mfma_f32_16x16x32_bf16 v[36:39], a[4:7], v[132:135], v[36:39]
  ds_read_b64_tr_b16 a[82:83], v10 offset:20992
  v_mfma_f32_16x16x32_bf16 a[128:131], a[8:11], v[132:135], a[128:131]
  ds_read_b64_tr_b16 a[84:85], v11 offset:16896
  v_mfma_f32_16x16x32_bf16 a[132:135], a[12:15], v[132:135], a[132:135]
  ds_read_b64_tr_b16 a[86:87], v11 offset:20992
  v_mfma_f32_16x16x32_bf16 v[40:43], a[16:19], v[132:135], v[40:43]
  ds_read_b64_tr_b16 a[88:89], v10 offset:17152
  v_mfma_f32_16x16x32_bf16 v[44:47], a[20:23], v[132:135], v[44:47]
  ds_read_b64_tr_b16 a[90:91], v10 offset:21248
  v_mfma_f32_16x16x32_bf16 a[136:139], a[24:27], v[132:135], a[136:139]
  ds_read_b64_tr_b16 a[92:93], v11 offset:17152
  v_mfma_f32_16x16x32_bf16 a[140:143], a[28:31], v[132:135], a[140:143]
  ds_read_b64_tr_b16 a[94:95], v11 offset:21248
  v_mfma_f32_16x16x32_bf16 v[48:51], a[0:3], v[136:139], v[48:51]
  buffer_load_dwordx4 v[220:223], v248, s[36:39], s76 offen sc1
  v_mfma_f32_16x16x32_bf16 v[52:55], a[4:7], v[136:139], v[52:55]
  v_mfma_f32_16x16x32_bf16 a[144:147], a[8:11], v[136:139], a[144:147]
  v_mfma_f32_16x16x32_bf16 a[148:151], a[12:15], v[136:139], a[148:151]
  v_mfma_f32_16x16x32_bf16 v[56:59], a[16:19], v[136:139], v[56:59]
  v_mfma_f32_16x16x32_bf16 v[60:63], a[20:23], v[136:139], v[60:63]
  v_mfma_f32_16x16x32_bf16 a[152:155], a[24:27], v[136:139], a[152:155]
  v_mfma_f32_16x16x32_bf16 a[156:159], a[28:31], v[136:139], a[156:159]
  buffer_load_dwordx4 v[224:227], v248, s[36:39], s77 offen sc1
  v_mfma_f32_16x16x32_bf16 v[64:67], a[0:3], v[140:143], v[64:67]
  v_mfma_f32_16x16x32_bf16 v[68:71], a[4:7], v[140:143], v[68:71]
  v_mfma_f32_16x16x32_bf16 a[160:163], a[8:11], v[140:143], a[160:163]
  v_mfma_f32_16x16x32_bf16 a[164:167], a[12:15], v[140:143], a[164:167]
  v_mfma_f32_16x16x32_bf16 v[72:75], a[16:19], v[140:143], v[72:75]
  v_mfma_f32_16x16x32_bf16 v[76:79], a[20:23], v[140:143], v[76:79]
  v_mfma_f32_16x16x32_bf16 a[168:171], a[24:27], v[140:143], a[168:171]
  v_mfma_f32_16x16x32_bf16 a[172:175], a[28:31], v[140:143], a[172:175]
  buffer_load_dwordx4 v[228:231], v248, s[36:39], s78 offen sc1
  v_mfma_f32_16x16x32_bf16 v[80:83], a[0:3], v[144:147], v[80:83]
  v_mfma_f32_16x16x32_bf16 v[84:87], a[4:7], v[144:147], v[84:87]
  v_mfma_f32_16x16x32_bf16 a[176:179], a[8:11], v[144:147], a[176:179]
  v_mfma_f32_16x16x32_bf16 a[180:183], a[12:15], v[144:147], a[180:183]
  v_mfma_f32_16x16x32_bf16 v[88:91], a[16:19], v[144:147], v[88:91]
  v_mfma_f32_16x16x32_bf16 v[92:95], a[20:23], v[144:147], v[92:95]
  v_mfma_f32_16x16x32_bf16 a[184:187], a[24:27], v[144:147], a[184:187]
  buffer_load_dwordx4 v[232:235], v248, s[36:39], s79 offen sc1
  v_mfma_f32_16x16x32_bf16 a[188:191], a[28:31], v[144:147], a[188:191]
  v_mfma_f32_16x16x32_bf16 v[96:99], a[0:3], v[148:151], v[96:99]
  v_mfma_f32_16x16x32_bf16 v[100:103], a[4:7], v[148:151], v[100:103]
  v_mfma_f32_16x16x32_bf16 a[192:195], a[8:11], v[148:151], a[192:195]
  v_mfma_f32_16x16x32_bf16 a[196:199], a[12:15], v[148:151], a[196:199]
  v_mfma_f32_16x16x32_bf16 v[104:107], a[16:19], v[148:151], v[104:107]
  v_mfma_f32_16x16x32_bf16 v[108:111], a[20:23], v[148:151], v[108:111]
  v_mfma_f32_16x16x32_bf16 a[200:203], a[24:27], v[148:151], a[200:203]
  buffer_load_dwordx4 v[236:239], v248, s[36:39], s80 offen sc1
  v_xor_b32 v248, 0x7c00, v248
  v_mfma_f32_16x16x32_bf16 a[204:207], a[28:31], v[148:151], a[204:207]
  v_mfma_f32_16x16x32_bf16 v[112:115], a[0:3], v[152:155], v[112:115]
  v_mfma_f32_16x16x32_bf16 v[116:119], a[4:7], v[152:155], v[116:119]
  v_mfma_f32_16x16x32_bf16 a[208:211], a[8:11], v[152:155], a[208:211]
  v_mfma_f32_16x16x32_bf16 a[212:215], a[12:15], v[152:155], a[212:215]
  v_mfma_f32_16x16x32_bf16 v[120:123], a[16:19], v[152:155], v[120:123]
  v_mfma_f32_16x16x32_bf16 v[124:127], a[20:23], v[152:155], v[124:127]
  v_mfma_f32_16x16x32_bf16 a[216:219], a[24:27], v[152:155], a[216:219]
  v_mfma_f32_16x16x32_bf16 a[220:223], a[28:31], v[152:155], a[220:223]
  s_waitcnt vmcnt(7) lgkmcnt(0)
  v_mfma_f32_16x16x32_bf16 v[24:27], a[48:51], v[156:159], v[24:27]
  ds_read_b64_tr_b16 a[224:225], v10 offset:24576
  v_mfma_f32_16x16x32_bf16 v[28:31], a[52:55], v[156:159], v[28:31]
  ds_read_b64_tr_b16 a[226:227], v10 offset:28672
  v_mfma_f32_16x16x32_bf16 a[120:123], a[56:59], v[156:159], a[120:123]
  ds_read_b64_tr_b16 a[228:229], v11 offset:24576
  v_mfma_f32_16x16x32_bf16 a[124:127], a[60:63], v[156:159], a[124:127]
  ds_read_b64_tr_b16 a[230:231], v11 offset:28672
  v_mfma_f32_16x16x32_bf16 v[40:43], a[48:51], v[160:163], v[40:43]
  ds_read_b64_tr_b16 a[232:233], v10 offset:24832
  v_mfma_f32_16x16x32_bf16 v[44:47], a[52:55], v[160:163], v[44:47]
  ds_read_b64_tr_b16 a[234:235], v10 offset:28928
  v_mfma_f32_16x16x32_bf16 a[136:139], a[56:59], v[160:163], a[136:139]
  ds_read_b64_tr_b16 a[236:237], v11 offset:24832
  v_mfma_f32_16x16x32_bf16 a[140:143], a[60:63], v[160:163], a[140:143]
  ds_read_b64_tr_b16 a[238:239], v11 offset:28928
  v_mfma_f32_16x16x32_bf16 v[56:59], a[48:51], v[164:167], v[56:59]
  ds_read_b64_tr_b16 a[240:241], v10 offset:25088
  v_mfma_f32_16x16x32_bf16 v[60:63], a[52:55], v[164:167], v[60:63]
  ds_read_b64_tr_b16 a[242:243], v10 offset:29184
  v_mfma_f32_16x16x32_bf16 a[152:155], a[56:59], v[164:167], a[152:155]
  ds_read_b64_tr_b16 a[244:245], v11 offset:25088
  v_mfma_f32_16x16x32_bf16 a[156:159], a[60:63], v[164:167], a[156:159]
  ds_read_b64_tr_b16 a[246:247], v11 offset:29184
  v_mfma_f32_16x16x32_bf16 v[72:75], a[48:51], v[168:171], v[72:75]
  ds_read_b64_tr_b16 a[248:249], v10 offset:25344
  v_mfma_f32_16x16x32_bf16 v[76:79], a[52:55], v[168:171], v[76:79]
  ds_read_b64_tr_b16 a[250:251], v10 offset:29440
  v_mfma_f32_16x16x32_bf16 a[168:171], a[56:59], v[168:171], a[168:171]
  ds_read_b64_tr_b16 a[252:253], v11 offset:25344
  v_mfma_f32_16x16x32_bf16 a[172:175], a[60:63], v[168:171], a[172:175]
  ds_read_b64_tr_b16 a[254:255], v11 offset:29440
  v_mfma_f32_16x16x32_bf16 v[88:91], a[48:51], v[172:175], v[88:91]
  v_mfma_f32_16x16x32_bf16 v[92:95], a[52:55], v[172:175], v[92:95]
  v_mfma_f32_16x16x32_bf16 a[184:187], a[56:59], v[172:175], a[184:187]
  v_mfma_f32_16x16x32_bf16 a[188:191], a[60:63], v[172:175], a[188:191]
  v_mfma_f32_16x16x32_bf16 v[104:107], a[48:51], v[176:179], v[104:107]
  v_mfma_f32_16x16x32_bf16 v[108:111], a[52:55], v[176:179], v[108:111]
  v_mfma_f32_16x16x32_bf16 a[200:203], a[56:59], v[176:179], a[200:203]
  v_mfma_f32_16x16x32_bf16 a[204:207], a[60:63], v[176:179], a[204:207]
  v_mfma_f32_16x16x32_bf16 v[120:123], a[48:51], v[180:183], v[120:123]
  v_mfma_f32_16x16x32_bf16 v[124:127], a[52:55], v[180:183], v[124:127]
  v_mfma_f32_16x16x32_bf16 a[216:219], a[56:59], v[180:183], a[216:219]
  v_mfma_f32_16x16x32_bf16 a[220:223], a[60:63], v[180:183], a[220:223]
  s_waitcnt vmcnt(8)
  v_mfma_f32_16x16x32_bf16 v[24:27], a[80:83], v[184:187], v[24:27]
  v_mfma_f32_16x16x32_bf16 v[28:31], a[84:87], v[184:187], v[28:31]
  v_mfma_f32_16x16x32_bf16 a[120:123], a[88:91], v[184:187], a[120:123]
  v_mfma_f32_16x16x32_bf16 a[124:127], a[92:95], v[184:187], a[124:127]
  v_mfma_f32_16x16x32_bf16 v[40:43], a[80:83], v[188:191], v[40:43]
  v_mfma_f32_16x16x32_bf16 v[44:47], a[84:87], v[188:191], v[44:47]
  v_mfma_f32_16x16x32_bf16 a[136:139], a[88:91], v[188:191], a[136:139]
  v_mfma_f32_16x16x32_bf16 a[140:143], a[92:95], v[188:191], a[140:143]
  v_mfma_f32_16x16x32_bf16 v[56:59], a[80:83], v[192:195], v[56:59]
  v_mfma_f32_16x16x32_bf16 v[60:63], a[84:87], v[192:195], v[60:63]
  v_mfma_f32_16x16x32_bf16 a[152:155], a[88:91], v[192:195], a[152:155]
  v_mfma_f32_16x16x32_bf16 a[156:159], a[92:95], v[192:195], a[156:159]
  v_mfma_f32_16x16x32_bf16 v[72:75], a[80:83], v[196:199], v[72:75]
  v_mfma_f32_16x16x32_bf16 v[76:79], a[84:87], v[196:199], v[76:79]
  v_mfma_f32_16x16x32_bf16 a[168:171], a[88:91], v[196:199], a[168:171]
  v_mfma_f32_16x16x32_bf16 a[172:175], a[92:95], v[196:199], a[172:175]
  v_mfma_f32_16x16x32_bf16 v[88:91], a[80:83], v[200:203], v[88:91]
  v_mfma_f32_16x16x32_bf16 v[92:95], a[84:87], v[200:203], v[92:95]
  v_mfma_f32_16x16x32_bf16 a[184:187], a[88:91], v[200:203], a[184:187]
  v_mfma_f32_16x16x32_bf16 a[188:191], a[92:95], v[200:203], a[188:191]
  v_mfma_f32_16x16x32_bf16 v[104:107], a[80:83], v[204:207], v[104:107]
  v_mfma_f32_16x16x32_bf16 v[108:111], a[84:87], v[204:207], v[108:111]
  v_mfma_f32_16x16x32_bf16 a[200:203], a[88:91], v[204:207], a[200:203]
  v_mfma_f32_16x16x32_bf16 a[204:207], a[92:95], v[204:207], a[204:207]
  v_mfma_f32_16x16x32_bf16 v[120:123], a[80:83], v[208:211], v[120:123]
  v_mfma_f32_16x16x32_bf16 v[124:127], a[84:87], v[208:211], v[124:127]
  v_mfma_f32_16x16x32_bf16 a[216:219], a[88:91], v[208:211], a[216:219]
  v_mfma_f32_16x16x32_bf16 a[220:223], a[92:95], v[208:211], a[220:223]
  s_waitcnt vmcnt(0) lgkmcnt(0)
  v_mfma_f32_16x16x32_bf16 v[24:27], a[240:243], v[212:215], v[24:27]
  v_mfma_f32_16x16x32_bf16 v[28:31], a[244:247], v[212:215], v[28:31]
  v_mfma_f32_16x16x32_bf16 a[120:123], a[248:251], v[212:215], a[120:123]
  v_mfma_f32_16x16x32_bf16 a[124:127], a[252:255], v[212:215], a[124:127]
  v_mfma_f32_16x16x32_bf16 v[40:43], a[240:243], v[216:219], v[40:43]
  v_mfma_f32_16x16x32_bf16 v[44:47], a[244:247], v[216:219], v[44:47]
  v_mfma_f32_16x16x32_bf16 a[136:139], a[248:251], v[216:219], a[136:139]
  v_mfma_f32_16x16x32_bf16 a[140:143], a[252:255], v[216:219], a[140:143]
  v_mfma_f32_16x16x32_bf16 v[56:59], a[240:243], v[220:223], v[56:59]
  v_mfma_f32_16x16x32_bf16 v[60:63], a[244:247], v[220:223], v[60:63]
  ds_write_b128 v6, v[28:31] offset:0
  v_mfma_f32_16x16x32_bf16 a[152:155], a[248:251], v[220:223], a[152:155]
  ds_write_b128 v6, a[120:123] offset:7168
  v_mfma_f32_16x16x32_bf16 a[156:159], a[252:255], v[220:223], a[156:159]
  ds_write_b128 v6, a[124:127] offset:14336
  v_mfma_f32_16x16x32_bf16 v[72:75], a[240:243], v[224:227], v[72:75]
  v_mfma_f32_16x16x32_bf16 v[76:79], a[244:247], v[224:227], v[76:79]
  ds_write_b128 v6, v[44:47] offset:1024
  v_mfma_f32_16x16x32_bf16 a[168:171], a[248:251], v[224:227], a[168:171]
  ds_write_b128 v6, a[136:139] offset:8192
  v_mfma_f32_16x16x32_bf16 a[172:175], a[252:255], v[224:227], a[172:175]
  ds_write_b128 v6, a[140:143] offset:15360
  v_mfma_f32_16x16x32_bf16 v[88:91], a[240:243], v[228:231], v[88:91]
  v_mfma_f32_16x16x32_bf16 v[92:95], a[244:247], v[228:231], v[92:95]
  ds_write_b128 v6, v[60:63] offset:2048
  v_mfma_f32_16x16x32_bf16 a[184:187], a[248:251], v[228:231], a[184:187]
  ds_write_b128 v6, a[152:155] offset:9216
  v_mfma_f32_16x16x32_bf16 a[188:191], a[252:255], v[228:231], a[188:191]
  ds_write_b128 v6, a[156:159] offset:16384
  v_mfma_f32_16x16x32_bf16 v[104:107], a[240:243], v[232:235], v[104:107]
  v_mfma_f32_16x16x32_bf16 v[108:111], a[244:247], v[232:235], v[108:111]
  ds_write_b128 v6, v[76:79] offset:3072
  v_mfma_f32_16x16x32_bf16 a[200:203], a[248:251], v[232:235], a[200:203]
  ds_write_b128 v6, a[168:171] offset:10240
  v_mfma_f32_16x16x32_bf16 a[204:207], a[252:255], v[232:235], a[204:207]
  ds_write_b128 v6, a[172:175] offset:17408
  v_mfma_f32_16x16x32_bf16 v[120:123], a[240:243], v[236:239], v[120:123]
  v_mfma_f32_16x16x32_bf16 v[124:127], a[244:247], v[236:239], v[124:127]
  ds_write_b128 v6, v[92:95] offset:4096
  v_mfma_f32_16x16x32_bf16 a[216:219], a[248:251], v[236:239], a[216:219]
  ds_write_b128 v6, a[184:187] offset:11264
  v_mfma_f32_16x16x32_bf16 a[220:223], a[252:255], v[236:239], a[220:223]
  ds_write_b128 v6, a[188:191] offset:18432
  v_mfma_f32_16x16x32_bf16 v[16:19], a[32:35], v[156:159], v[16:19]
  v_mfma_f32_16x16x32_bf16 v[20:23], a[36:39], v[156:159], v[20:23]
  ds_write_b128 v6, v[108:111] offset:5120
  v_mfma_f32_16x16x32_bf16 a[112:115], a[40:43], v[156:159], a[112:115]
  ds_write_b128 v6, a[200:203] offset:12288
  v_mfma_f32_16x16x32_bf16 a[116:119], a[44:47], v[156:159], a[116:119]
  ds_write_b128 v6, a[204:207] offset:19456
  v_mfma_f32_16x16x32_bf16 v[32:35], a[32:35], v[160:163], v[32:35]
  v_mfma_f32_16x16x32_bf16 v[36:39], a[36:39], v[160:163], v[36:39]
  ds_write_b128 v6, v[124:127] offset:6144
  v_mfma_f32_16x16x32_bf16 a[128:131], a[40:43], v[160:163], a[128:131]
  ds_write_b128 v6, a[216:219] offset:13312
  v_mfma_f32_16x16x32_bf16 a[132:135], a[44:47], v[160:163], a[132:135]
  ds_write_b128 v6, a[220:223] offset:20480
  v_mfma_f32_16x16x32_bf16 v[48:51], a[32:35], v[164:167], v[48:51]
  v_mfma_f32_16x16x32_bf16 v[52:55], a[36:39], v[164:167], v[52:55]
  v_mfma_f32_16x16x32_bf16 a[144:147], a[40:43], v[164:167], a[144:147]
  s_waitcnt lgkmcnt(0)
  v_mfma_f32_16x16x32_bf16 a[148:151], a[44:47], v[164:167], a[148:151]
  s_barrier
  v_mfma_f32_16x16x32_bf16 v[64:67], a[32:35], v[168:171], v[64:67]
  ds_read_b128 v[28:31], v7 offset:0
  ds_read_b128 v[128:131], v8 offset:7168
  v_mfma_f32_16x16x32_bf16 v[68:71], a[36:39], v[168:171], v[68:71]
  ds_read_b128 v[156:159], v9 offset:14336
  v_mfma_f32_16x16x32_bf16 a[160:163], a[40:43], v[168:171], a[160:163]
  v_mfma_f32_16x16x32_bf16 a[164:167], a[44:47], v[168:171], a[164:167]
  v_mfma_f32_16x16x32_bf16 v[80:83], a[32:35], v[172:175], v[80:83]
  ds_read_b128 v[44:47], v7 offset:1024
  ds_read_b128 v[132:135], v8 offset:8192
  v_mfma_f32_16x16x32_bf16 v[84:87], a[36:39], v[172:175], v[84:87]
  ds_read_b128 v[160:163], v9 offset:15360
  s_waitcnt lgkmcnt(3)
  v_mfma_f32_16x16x32_bf16 a[176:179], a[40:43], v[172:175], a[176:179]
  v_add_f32 v24, v24, v28
  v_add_f32 v25, v25, v29
  v_add_f32 v26, v26, v30
  v_add_f32 v27, v27, v31
  v_mfma_f32_16x16x32_bf16 a[180:183], a[44:47], v[172:175], a[180:183]
  v_add_f32 v128, v128, v156
  v_add_f32 v129, v129, v157
  v_add_f32 v130, v130, v158
  v_add_f32 v131, v131, v159
  v_mfma_f32_16x16x32_bf16 v[96:99], a[32:35], v[176:179], v[96:99]
  ds_read_b128 v[60:63], v7 offset:2048
  ds_read_b128 v[136:139], v8 offset:9216
  v_add_f32 v24, v24, v128
  v_add_f32 v25, v25, v129
  v_mfma_f32_16x16x32_bf16 v[100:103], a[36:39], v[176:179], v[100:103]
  ds_read_b128 v[164:167], v9 offset:16384
  v_add_f32 v26, v26, v130
  v_add_f32 v27, v27, v131
  s_waitcnt lgkmcnt(3)
  v_mfma_f32_16x16x32_bf16 a[192:195], a[40:43], v[176:179], a[192:195]
  global_store_dwordx4 v251, v[24:27], s[18:19] offset:-3072 sc1
  v_add_f32 v40, v40, v44
  v_add_f32 v41, v41, v45
  v_add_f32 v42, v42, v46
  v_add_f32 v43, v43, v47
  v_mfma_f32_16x16x32_bf16 a[196:199], a[44:47], v[176:179], a[196:199]
  v_add_f32 v132, v132, v160
  v_add_f32 v133, v133, v161
  v_add_f32 v134, v134, v162
  v_add_f32 v135, v135, v163
  v_mfma_f32_16x16x32_bf16 v[112:115], a[32:35], v[180:183], v[112:115]
  ds_read_b128 v[76:79], v7 offset:3072
  ds_read_b128 v[140:143], v8 offset:10240
  v_add_f32 v40, v40, v132
  v_add_f32 v41, v41, v133
  v_mfma_f32_16x16x32_bf16 v[116:119], a[36:39], v[180:183], v[116:119]
  ds_read_b128 v[168:171], v9 offset:17408
  v_add_f32 v42, v42, v134
  v_add_f32 v43, v43, v135
  s_waitcnt lgkmcnt(3)
  v_mfma_f32_16x16x32_bf16 a[208:211], a[40:43], v[180:183], a[208:211]
  global_store_dwordx4 v251, v[40:43], s[18:19] offset:-2048 sc1
  v_add_f32 v56, v56, v60
  v_add_f32 v57, v57, v61
  v_add_f32 v58, v58, v62
  v_add_f32 v59, v59, v63
  v_mfma_f32_16x16x32_bf16 a[212:215], a[44:47], v[180:183], a[212:215]
  v_add_f32 v136, v136, v164
  v_add_f32 v137, v137, v165
  v_add_f32 v138, v138, v166
  v_add_f32 v139, v139, v167
  v_mfma_f32_16x16x32_bf16 v[16:19], a[64:67], v[184:187], v[16:19]
  ds_read_b128 v[92:95], v7 offset:4096
  ds_read_b128 v[144:147], v8 offset:11264
  v_add_f32 v56, v56, v136
  v_add_f32 v57, v57, v137
  v_mfma_f32_16x16x32_bf16 v[20:23], a[68:71], v[184:187], v[20:23]
  ds_read_b128 v[172:175], v9 offset:18432
  v_add_f32 v58, v58, v138
  v_add_f32 v59, v59, v139
  s_waitcnt lgkmcnt(3)
  v_mfma_f32_16x16x32_bf16 a[112:115], a[72:75], v[184:187], a[112:115]
  global_store_dwordx4 v251, v[56:59], s[18:19] offset:-1024 sc1
  v_add_f32 v72, v72, v76
  v_add_f32 v73, v73, v77
  v_add_f32 v74, v74, v78
  v_add_f32 v75, v75, v79
  v_mfma_f32_16x16x32_bf16 a[116:119], a[76:79], v[184:187], a[116:119]
  v_add_f32 v140, v140, v168
  v_add_f32 v141, v141, v169
  v_add_f32 v142, v142, v170
  v_add_f32 v143, v143, v171
  v_mfma_f32_16x16x32_bf16 v[32:35], a[64:67], v[188:191], v[32:35]
  ds_read_b128 v[108:111], v7 offset:5120
  ds_read_b128 v[148:151], v8 offset:12288
  v_add_f32 v72, v72, v140
  v_add_f32 v73, v73, v141
  v_mfma_f32_16x16x32_bf16 v[36:39], a[68:71], v[188:191], v[36:39]
  ds_read_b128 v[176:179], v9 offset:19456
  v_add_f32 v74, v74, v142
  v_add_f32 v75, v75, v143
  s_waitcnt lgkmcnt(3)
  v_mfma_f32_16x16x32_bf16 a[128:131], a[72:75], v[188:191], a[128:131]
  global_store_dwordx4 v251, v[72:75], s[18:19] offset:0 sc1
  v_add_f32 v88, v88, v92
  v_add_f32 v89, v89, v93
  v_add_f32 v90, v90, v94
  v_add_f32 v91, v91, v95
  v_mfma_f32_16x16x32_bf16 a[132:135], a[76:79], v[188:191], a[132:135]
  v_add_f32 v144, v144, v172
  v_add_f32 v145, v145, v173
  v_add_f32 v146, v146, v174
  v_add_f32 v147, v147, v175
  v_mfma_f32_16x16x32_bf16 v[48:51], a[64:67], v[192:195], v[48:51]
  ds_read_b128 v[124:127], v7 offset:6144
  ds_read_b128 v[152:155], v8 offset:13312
  v_add_f32 v88, v88, v144
  v_add_f32 v89, v89, v145
  v_mfma_f32_16x16x32_bf16 v[52:55], a[68:71], v[192:195], v[52:55]
  ds_read_b128 v[180:183], v9 offset:20480
  v_add_f32 v90, v90, v146
  v_add_f32 v91, v91, v147
  s_waitcnt lgkmcnt(3)
  v_mfma_f32_16x16x32_bf16 a[144:147], a[72:75], v[192:195], a[144:147]
  global_store_dwordx4 v251, v[88:91], s[18:19] offset:1024 sc1
  v_add_f32 v104, v104, v108
  v_add_f32 v105, v105, v109
  v_add_f32 v106, v106, v110
  v_add_f32 v107, v107, v111
  v_mfma_f32_16x16x32_bf16 a[148:151], a[76:79], v[192:195], a[148:151]
  v_add_f32 v148, v148, v176
  v_add_f32 v149, v149, v177
  v_add_f32 v150, v150, v178
  v_add_f32 v151, v151, v179
  v_mfma_f32_16x16x32_bf16 v[64:67], a[64:67], v[196:199], v[64:67]
  v_add_f32 v104, v104, v148
  v_add_f32 v105, v105, v149
  v_mfma_f32_16x16x32_bf16 v[68:71], a[68:71], v[196:199], v[68:71]
  v_add_f32 v106, v106, v150
  v_add_f32 v107, v107, v151
  s_waitcnt lgkmcnt(0)
  v_mfma_f32_16x16x32_bf16 a[160:163], a[72:75], v[196:199], a[160:163]
  global_store_dwordx4 v251, v[104:107], s[18:19] offset:2048 sc1
  v_add_f32 v120, v120, v124
  v_add_f32 v121, v121, v125
  v_add_f32 v122, v122, v126
  v_add_f32 v123, v123, v127
  v_mfma_f32_16x16x32_bf16 a[164:167], a[76:79], v[196:199], a[164:167]
  v_add_f32 v152, v152, v180
  v_add_f32 v153, v153, v181
  v_add_f32 v154, v154, v182
  v_add_f32 v155, v155, v183
  v_mfma_f32_16x16x32_bf16 v[80:83], a[64:67], v[200:203], v[80:83]
  v_add_f32 v120, v120, v152
  v_add_f32 v121, v121, v153
  v_mfma_f32_16x16x32_bf16 v[84:87], a[68:71], v[200:203], v[84:87]
  v_add_f32 v122, v122, v154
  v_add_f32 v123, v123, v155
  v_mfma_f32_16x16x32_bf16 a[176:179], a[72:75], v[200:203], a[176:179]
  global_store_dwordx4 v251, v[120:123], s[18:19] offset:3072 sc1
  v_mfma_f32_16x16x32_bf16 a[180:183], a[76:79], v[200:203], a[180:183]
  v_mfma_f32_16x16x32_bf16 v[96:99], a[64:67], v[204:207], v[96:99]
  s_barrier
  v_mfma_f32_16x16x32_bf16 v[100:103], a[68:71], v[204:207], v[100:103]
  v_mfma_f32_16x16x32_bf16 a[192:195], a[72:75], v[204:207], a[192:195]
  v_add_u32 v3, 1, v255
  v_mfma_f32_16x16x32_bf16 a[196:199], a[76:79], v[204:207], a[196:199]
  v_mfma_f32_16x16x32_bf16 v[112:115], a[64:67], v[208:211], v[112:115]
  v_mfma_f32_16x16x32_bf16 v[116:119], a[68:71], v[208:211], v[116:119]
  v_mfma_f32_16x16x32_bf16 a[208:211], a[72:75], v[208:211], a[208:211]
  v_mfma_f32_16x16x32_bf16 a[212:215], a[76:79], v[208:211], a[212:215]
  v_mfma_f32_16x16x32_bf16 v[16:19], a[224:227], v[212:215], v[16:19]
  v_mfma_f32_16x16x32_bf16 v[20:23], a[228:231], v[212:215], v[20:23]
  v_mfma_f32_16x16x32_bf16 a[112:115], a[232:235], v[212:215], a[112:115]
  v_mfma_f32_16x16x32_bf16 a[116:119], a[236:239], v[212:215], a[116:119]
  v_mfma_f32_16x16x32_bf16 v[32:35], a[224:227], v[216:219], v[32:35]
  v_mfma_f32_16x16x32_bf16 v[36:39], a[228:231], v[216:219], v[36:39]
  v_mfma_f32_16x16x32_bf16 a[128:131], a[232:235], v[216:219], a[128:131]
  v_mfma_f32_16x16x32_bf16 a[132:135], a[236:239], v[216:219], a[132:135]
  v_mfma_f32_16x16x32_bf16 v[48:51], a[224:227], v[220:223], v[48:51]
  v_mfma_f32_16x16x32_bf16 v[52:55], a[228:231], v[220:223], v[52:55]
  ds_write_b128 v6, v[20:23] offset:0
  v_mfma_f32_16x16x32_bf16 a[144:147], a[232:235], v[220:223], a[144:147]
  ds_write_b128 v6, a[112:115] offset:7168
  v_mfma_f32_16x16x32_bf16 a[148:151], a[236:239], v[220:223], a[148:151]
  ds_write_b128 v6, a[116:119] offset:14336
  v_mfma_f32_16x16x32_bf16 v[64:67], a[224:227], v[224:227], v[64:67]
  v_mfma_f32_16x16x32_bf16 v[68:71], a[228:231], v[224:227], v[68:71]
  ds_write_b128 v6, v[36:39] offset:1024
  v_mfma_f32_16x16x32_bf16 a[160:163], a[232:235], v[224:227], a[160:163]
  ds_write_b128 v6, a[128:131] offset:8192
  v_mfma_f32_16x16x32_bf16 a[164:167], a[236:239], v[224:227], a[164:167]
  ds_write_b128 v6, a[132:135] offset:15360
  v_mfma_f32_16x16x32_bf16 v[80:83], a[224:227], v[228:231], v[80:83]
  s_waitcnt vmcnt(0)
  s_mov_b64 exec, 64
  global_store_dword v241, v3, s[18:19] sc1
  s_mov_b64 exec, -1
  v_mfma_f32_16x16x32_bf16 v[84:87], a[228:231], v[228:231], v[84:87]
  ds_write_b128 v6, v[52:55] offset:2048
  v_mfma_f32_16x16x32_bf16 a[176:179], a[232:235], v[228:231], a[176:179]
  ds_write_b128 v6, a[144:147] offset:9216
  v_mfma_f32_16x16x32_bf16 a[180:183], a[236:239], v[228:231], a[180:183]
  ds_write_b128 v6, a[148:151] offset:16384
  v_mfma_f32_16x16x32_bf16 v[96:99], a[224:227], v[232:235], v[96:99]
  v_mfma_f32_16x16x32_bf16 v[100:103], a[228:231], v[232:235], v[100:103]
  ds_write_b128 v6, v[68:71] offset:3072
  v_mfma_f32_16x16x32_bf16 a[192:195], a[232:235], v[232:235], a[192:195]
  ds_write_b128 v6, a[160:163] offset:10240
  v_mfma_f32_16x16x32_bf16 a[196:199], a[236:239], v[232:235], a[196:199]
  ds_write_b128 v6, a[164:167] offset:17408
  v_mfma_f32_16x16x32_bf16 v[112:115], a[224:227], v[236:239], v[112:115]
  v_mfma_f32_16x16x32_bf16 v[116:119], a[228:231], v[236:239], v[116:119]
  ds_write_b128 v6, v[84:87] offset:4096
  v_mfma_f32_16x16x32_bf16 a[208:211], a[232:235], v[236:239], a[208:211]
  ds_write_b128 v6, a[176:179] offset:11264
  v_mfma_f32_16x16x32_bf16 a[212:215], a[236:239], v[236:239], a[212:215]
  ds_write_b128 v6, a[180:183] offset:18432
  s_mov_b64 exec, 32
  global_load_dword v2, v241, s[18:19] sc1
  s_mov_b64 exec, -1
  ds_write_b128 v6, v[100:103] offset:5120
  ds_write_b128 v6, a[192:195] offset:12288
  ds_write_b128 v6, a[196:199] offset:19456
  s_nop 1
  ds_write_b128 v6, v[116:119] offset:6144
  ds_write_b128 v6, a[208:211] offset:13312
  ds_write_b128 v6, a[212:215] offset:20480
  s_mov_b32 s55, 0x40000
  s_waitcnt lgkmcnt(0)
  s_barrier
  ds_read_b128 v[128:131], v7 offset:0
  ds_read_b128 v[132:135], v8 offset:7168
  ds_read_b128 v[136:139], v9 offset:14336
  ds_read_b128 v[140:143], v7 offset:1024
  ds_read_b128 v[144:147], v8 offset:8192
  ds_read_b128 v[148:151], v9 offset:15360
  ds_read_b128 v[152:155], v7 offset:2048
  ds_read_b128 v[156:159], v8 offset:9216
  ds_read_b128 v[160:163], v9 offset:16384
  ds_read_b128 v[164:167], v7 offset:3072
  ds_read_b128 v[168:171], v8 offset:10240
  ds_read_b128 v[172:175], v9 offset:17408
  ds_read_b128 v[176:179], v7 offset:4096
  ds_read_b128 v[180:183], v8 offset:11264
  ds_read_b128 v[184:187], v9 offset:18432
  ds_read_b128 v[188:191], v7 offset:5120
  ds_read_b128 v[192:195], v8 offset:12288
  ds_read_b128 v[196:199], v9 offset:19456
  ds_read_b128 v[200:203], v7 offset:6144
  ds_read_b128 v[204:207], v8 offset:13312
  ds_read_b128 v[208:211], v9 offset:20480
  s_mov_b64 exec, 32
L_poll2:
  s_waitcnt vmcnt(0)
  v_cmp_eq_u32 vcc, v2, v255
  s_sub_u32 s55, s55, 1
  s_cbranch_vccz L_go2
  s_cbranch_scc1 L_go2
  global_load_dword v2, v241, s[18:19] sc1
  s_branch L_poll2
L_go2:
  s_mov_b64 exec, -1
  global_load_dwordx4 v[212:215], v250, s[18:19] offset:-3072 sc1
  global_load_dwordx4 v[216:219], v250, s[18:19] offset:-2048 sc1
  global_load_dwordx4 v[220:223], v250, s[18:19] offset:-1024 sc1
  global_load_dwordx4 v[224:227], v250, s[18:19] offset:0 sc1
  global_load_dwordx4 v[228:231], v250, s[18:19] offset:1024 sc1
  global_load_dwordx4 v[232:235], v250, s[18:19] offset:2048 sc1
  global_load_dwordx4 v[236:239], v250, s[18:19] offset:3072 sc1
  s_waitcnt lgkmcnt(15)
  v_pk_add_f32 v[16:17], v[16:17], v[128:129]
  v_pk_add_f32 v[132:133], v[132:133], v[136:137]
  v_pk_add_f32 v[18:19], v[18:19], v[130:131]
  v_pk_add_f32 v[134:135], v[134:135], v[138:139]
  v_pk_add_f32 v[16:17], v[16:17], v[132:133]
  v_pk_add_f32 v[18:19], v[18:19], v[134:135]
  s_waitcnt lgkmcnt(15)
  v_pk_add_f32 v[32:33], v[32:33], v[140:141]
  v_pk_add_f32 v[144:145], v[144:145], v[148:149]
  v_pk_add_f32 v[34:35], v[34:35], v[142:143]
  v_pk_add_f32 v[146:147], v[146:147], v[150:151]
  v_pk_add_f32 v[32:33], v[32:33], v[144:145]
  v_pk_add_f32 v[34:35], v[34:35], v[146:147]
  s_waitcnt lgkmcnt(12)
  v_pk_add_f32 v[48:49], v[48:49], v[152:153]
  v_pk_add_f32 v[156:157], v[156:157], v[160:161]
  v_pk_add_f32 v[50:51], v[50:51], v[154:155]
  v_pk_add_f32 v[158:159], v[158:159], v[162:163]
  v_pk_add_f32 v[48:49], v[48:49], v[156:157]
  v_pk_add_f32 v[50:51], v[50:51], v[158:159]
  s_waitcnt lgkmcnt(9)
  v_pk_add_f32 v[64:65], v[64:65], v[164:165]
  v_pk_add_f32 v[168:169], v[168:169], v[172:173]
  v_pk_add_f32 v[66:67], v[66:67], v[166:167]
  v_pk_add_f32 v[170:171], v[170:171], v[174:175]
  v_pk_add_f32 v[64:65], v[64:65], v[168:169]
  v_pk_add_f32 v[66:67], v[66:67], v[170:171]
  s_waitcnt lgkmcnt(6)
  v_pk_add_f32 v[80:81], v[80:81], v[176:177]
  v_pk_add_f32 v[180:181], v[180:181], v[184:185]
  v_pk_add_f32 v[82:83], v[82:83], v[178:179]
  v_pk_add_f32 v[182:183], v[182:183], v[186:187]
  v_pk_add_f32 v[80:81], v[80:81], v[180:181]
  v_pk_add_f32 v[82:83], v[82:83], v[182:183]
  s_waitcnt lgkmcnt(3)
  v_pk_add_f32 v[96:97], v[96:97], v[188:189]
  v_pk_add_f32 v[192:193], v[192:193], v[196:197]
  v_pk_add_f32 v[98:99], v[98:99], v[190:191]
  v_pk_add_f32 v[194:195], v[194:195], v[198:199]
  v_pk_add_f32 v[96:97], v[96:97], v[192:193]
  v_pk_add_f32 v[98:99], v[98:99], v[194:195]
  s_waitcnt lgkmcnt(0)
  v_pk_add_f32 v[112:113], v[112:113], v[200:201]
  v_pk_add_f32 v[204:205], v[204:205], v[208:209]
  v_pk_add_f32 v[114:115], v[114:115], v[202:203]
  v_pk_add_f32 v[206:207], v[206:207], v[210:211]
  v_pk_add_f32 v[112:113], v[112:113], v[204:205]
  v_pk_add_f32 v[114:115], v[114:115], v[206:207]
  s_waitcnt vmcnt(6)
  v_pk_add_f32 v[16:17], v[16:17], v[212:213]
  v_pk_add_f32 v[18:19], v[18:19], v[214:215]
  v_cvt_pk_bf16_f32 v16, v16, v17
  v_cvt_pk_bf16_f32 v17, v18, v19
  s_mov_b32 s65, 0
  buffer_store_dwordx2 v[16:17], v249, s[44:47], s65 offen
  s_waitcnt vmcnt(6)
  v_pk_add_f32 v[32:33], v[32:33], v[216:217]
  v_pk_add_f32 v[34:35], v[34:35], v[218:219]
  v_cvt_pk_bf16_f32 v32, v32, v33
  v_cvt_pk_bf16_f32 v33, v34, v35
  s_mov_b32 s65, 32768
  buffer_store_dwordx2 v[32:33], v249, s[44:47], s65 offen
  s_waitcnt vmcnt(6)
  v_pk_add_f32 v[48:49], v[48:49], v[220:221]
  v_pk_add_f32 v[50:51], v[50:51], v[222:223]
  v_cvt_pk_bf16_f32 v48, v48, v49
  v_cvt_pk_bf16_f32 v49, v50, v51
  s_mov_b32 s65, 65536
  buffer_store_dwordx2 v[48:49], v249, s[44:47], s65 offen
  s_waitcnt vmcnt(6)
  v_pk_add_f32 v[64:65], v[64:65], v[224:225]
  v_pk_add_f32 v[66:67], v[66:67], v[226:227]
  v_cvt_pk_bf16_f32 v64, v64, v65
  v_cvt_pk_bf16_f32 v65, v66, v67
  s_mov_b32 s65, 98304
  buffer_store_dwordx2 v[64:65], v249, s[44:47], s65 offen
  s_waitcnt vmcnt(6)
  v_pk_add_f32 v[80:81], v[80:81], v[228:229]
  v_pk_add_f32 v[82:83], v[82:83], v[230:231]
  v_cvt_pk_bf16_f32 v80, v80, v81
  v_cvt_pk_bf16_f32 v81, v82, v83
  s_mov_b32 s65, 131072
  buffer_store_dwordx2 v[80:81], v249, s[44:47], s65 offen
  s_waitcnt vmcnt(6)
  v_pk_add_f32 v[96:97], v[96:97], v[232:233]
  v_pk_add_f32 v[98:99], v[98:99], v[234:235]
  v_cvt_pk_bf16_f32 v96, v96, v97
  v_cvt_pk_bf16_f32 v97, v98, v99
  s_mov_b32 s65, 163840
  buffer_store_dwordx2 v[96:97], v249, s[44:47], s65 offen
  s_waitcnt vmcnt(6)
  v_pk_add_f32 v[112:113], v[112:113], v[236:237]
  v_pk_add_f32 v[114:115], v[114:115], v[238:239]
  v_cvt_pk_bf16_f32 v112, v112, v113
  v_cvt_pk_bf16_f32 v113, v114, v115
  s_mov_b32 s65, 196608
  buffer_store_dwordx2 v[112:113], v249, s[44:47], s65 offen
L_end:
  s_endpgm
L_slow:
  s_waitcnt vmcnt(0) lgkmcnt(0)
  s_barrier
  s_mov_b32 s64, 1
  v_lshrrev_b32 v2, 3, v1
  v_and_b32 v3, 7, v1
  v_and_b32 v4, 6, v2
  v_xor_b32 v4, v4, v3
  v_lshlrev_b32 v4, 4, v4
  v_lshl_add_u32 v240, v2, 11, v4
  s_mul_i32 s65, s48, 114688
  v_add_u32 v240, s65, v240
  v_add_u32 v241, 15360, v240
  v_add_u32 v242, 30720, v240
  v_add_u32 v243, 46080, v240
  v_add_u32 v244, 65536, v240
  v_add_u32 v245, 80896, v240
  v_add_u32 v246, 96256, v240
  v_and_b32 v4, 2, v2
  v_lshlrev_b32 v4, 1, v4
  v_xor_b32 v4, v4, v3
  v_lshlrev_b32 v4, 4, v4
  v_lshl_add_u32 v10, v2, 13, v4
  s_lshl_b32 s65, s51, 17
  s_lshl_b32 s61, s52, 7
  s_add_u32 s65, s65, s61
  v_add_u32 v10, s65, v10
  v_add_u32 v11, 64512, v10
  s_branch L_restart
L_maxpass:
  s_waitcnt vmcnt(0) lgkmcnt(0)
  s_barrier
  ds_read_b128 a[96:99], v3 offset:16384
  ds_read_b128 a[100:103], v3 offset:17408
  ds_read_b128 a[104:107], v3 offset:20480
  ds_read_b128 a[108:111], v3 offset:21504
  s_mov_b32 s55, 16
  s_mov_b32 s63, 0
  s_mov_b32 s62, 8192
  v_mfma_f32_32x32x16_bf16 a[176:191], v[12:15], v[12:15], 0
  v_mfma_f32_32x32x16_bf16 a[192:207], v[12:15], v[12:15], 0
  v_mfma_f32_32x32x16_bf16 a[208:223], v[12:15], v[12:15], 0
  s_nop 7
  v_mov_b32 v128, 0xff800000
  v_mov_b32 v132, 0xff800000
  v_mov_b32 v136, 0xff800000
  v_mov_b32 v140, 0xff800000
  v_mov_b32 v144, 0xff800000
  v_mov_b32 v148, 0xff800000
  v_mov_b32 v152, 0xff800000
L_slow_loop:
  s_add_u32 m0, s57, 4294836224
  s_nop 0
  buffer_load_dwordx4 v6, s[28:31], s63 offen offset:0 nt lds
  buffer_load_dwordx4 v7, s[28:31], s63 offen offset:1024 nt lds
  s_add_u32 m0, s57, 4294901760
  s_nop 0
  buffer_load_dwordx4 v6, s[28:31], s62 offen offset:0 nt lds
  buffer_load_dwordx4 v7, s[28:31], s62 offen offset:1024 nt lds
  s_add_u32 m0, s57, 4294868992
  s_nop 0
  buffer_load_dwordx4 v6, s[84:87], s63 offen offset:0 nt lds
  buffer_load_dwordx4 v7, s[84:87], s63 offen offset:1024 nt lds
  s_add_u32 m0, s57, 4294934528
  s_nop 0
  buffer_load_dwordx4 v8, s[84:87], s62 offen offset:0 nt lds
  buffer_load_dwordx4 v9, s[84:87], s62 offen offset:1024 nt lds
  s_add_u32 s63, s63, 16384
  s_add_u32 s62, s62, 16384
  s_waitcnt vmcnt(0)
  s_barrier
  ds_read_b128 a[224:227], v240 offset:0
  ds_read_b128 a[228:231], v240 offset:256
  ds_read_b128 a[232:235], v240 offset:512
  ds_read_b128 a[236:239], v240 offset:768
  ds_read_b128 a[240:243], v240 offset:4096
  ds_read_b128 a[244:247], v240 offset:4352
  ds_read_b128 a[248:251], v240 offset:4608
  ds_read_b128 a[252:255], v240 offset:4864
  s_waitcnt lgkmcnt(0)
  s_barrier
  v_mfma_f32_16x16x32_bf16 v[156:159], a[224:227], a[0:3], 0
  v_mfma_f32_16x16x32_bf16 v[156:159], a[228:231], a[4:7], v[156:159]
  v_mfma_f32_16x16x32_bf16 v[156:159], a[232:235], a[8:11], v[156:159]
  v_mfma_f32_16x16x32_bf16 v[156:159], a[236:239], a[12:15], v[156:159]
  v_mfma_f32_16x16x32_bf16 v[160:163], a[240:243], a[0:3], 0
  v_mfma_f32_16x16x32_bf16 v[160:163], a[244:247], a[4:7], v[160:163]
  v_mfma_f32_16x16x32_bf16 v[160:163], a[248:251], a[8:11], v[160:163]
  v_mfma_f32_16x16x32_bf16 v[160:163], a[252:255], a[12:15], v[160:163]
  s_nop 7
  v_max3_f32 v128, v128, v156, v157
  v_max3_f32 v128, v128, v158, v159
  v_max3_f32 v128, v128, v160, v161
  v_max3_f32 v128, v128, v162, v163
  v_mfma_f32_16x16x32_bf16 v[156:159], a[224:227], a[16:19], 0
  v_mfma_f32_16x16x32_bf16 v[156:159], a[228:231], a[20:23], v[156:159]
  v_mfma_f32_16x16x32_bf16 v[156:159], a[232:235], a[24:27], v[156:159]
  v_mfma_f32_16x16x32_bf16 v[156:159], a[236:239], a[28:31], v[156:159]
  v_mfma_f32_16x16x32_bf16 v[160:163], a[240:243], a[16:19], 0
  v_mfma_f32_16x16x32_bf16 v[160:163], a[244:247], a[20:23], v[160:163]
  v_mfma_f32_16x16x32_bf16 v[160:163], a[248:251], a[24:27], v[160:163]
  v_mfma_f32_16x16x32_bf16 v[160:163], a[252:255], a[28:31], v[160:163]
  s_nop 7
  v_max3_f32 v132, v132, v156, v157
  v_max3_f32 v132, v132, v158, v159
  v_max3_f32 v132, v132, v160, v161
  v_max3_f32 v132, v132, v162, v163
  v_mfma_f32_16x16x32_bf16 v[156:159], a[224:227], a[32:35], 0
  v_mfma_f32_16x16x32_bf16 v[156:159], a[228:231], a[36:39], v[156:159]
  v_mfma_f32_16x16x32_bf16 v[156:159], a[232:235], a[40:43], v[156:159]
  v_mfma_f32_16x16x32_bf16 v[156:159], a[236:239], a[44:47], v[156:159]
  v_mfma_f32_16x16x32_bf16 v[160:163], a[240:243], a[32:35], 0
  v_mfma_f32_16x16x32_bf16 v[160:163], a[244:247], a[36:39], v[160:163]
  v_mfma_f32_16x16x32_bf16 v[160:163], a[248:251], a[40:43], v[160:163]
  v_mfma_f32_16x16x32_bf16 v[160:163], a[252:255], a[44:47], v[160:163]
  s_nop 7
  v_max3_f32 v136, v136, v156, v157
  v_max3_f32 v136, v136, v158, v159
  v_max3_f32 v136, v136, v160, v161
  v_max3_f32 v136, v136, v162, v163
  v_mfma_f32_16x16x32_bf16 v[156:159], a[224:227], a[48:51], 0
  v_mfma_f32_16x16x32_bf16 v[156:159], a[228:231], a[52:55], v[156:159]
  v_mfma_f32_16x16x32_bf16 v[156:159], a[232:235], a[56:59], v[156:159]
  v_mfma_f32_16x16x32_bf16 v[156:159], a[236:239], a[60:63], v[156:159]
  v_mfma_f32_16x16x32_bf16 v[160:163], a[240:243], a[48:51], 0
  v_mfma_f32_16x16x32_bf16 v[160:163], a[244:247], a[52:55], v[160:163]
  v_mfma_f32_16x16x32_bf16 v[160:163], a[248:251], a[56:59], v[160:163]
  v_mfma_f32_16x16x32_bf16 v[160:163], a[252:255], a[60:63], v[160:163]
  s_nop 7
  v_max3_f32 v140, v140, v156, v157
  v_max3_f32 v140, v140, v158, v159
  v_max3_f32 v140, v140, v160, v161
  v_max3_f32 v140, v140, v162, v163
  v_mfma_f32_16x16x32_bf16 v[156:159], a[224:227], a[64:67], 0
  v_mfma_f32_16x16x32_bf16 v[156:159], a[228:231], a[68:71], v[156:159]
  v_mfma_f32_16x16x32_bf16 v[156:159], a[232:235], a[72:75], v[156:159]
  v_mfma_f32_16x16x32_bf16 v[156:159], a[236:239], a[76:79], v[156:159]
  v_mfma_f32_16x16x32_bf16 v[160:163], a[240:243], a[64:67], 0
  v_mfma_f32_16x16x32_bf16 v[160:163], a[244:247], a[68:71], v[160:163]
  v_mfma_f32_16x16x32_bf16 v[160:163], a[248:251], a[72:75], v[160:163]
  v_mfma_f32_16x16x32_bf16 v[160:163], a[252:255], a[76:79], v[160:163]
  s_nop 7
  v_max3_f32 v144, v144, v156, v157
  v_max3_f32 v144, v144, v158, v159
  v_max3_f32 v144, v144, v160, v161
  v_max3_f32 v144, v144, v162, v163
  v_mfma_f32_16x16x32_bf16 v[156:159], a[224:227], a[80:83], 0
  v_mfma_f32_16x16x32_bf16 v[156:159], a[228:231], a[84:87], v[156:159]
  v_mfma_f32_16x16x32_bf16 v[156:159], a[232:235], a[88:91], v[156:159]
  v_mfma_f32_16x16x32_bf16 v[156:159], a[236:239], a[92:95], v[156:159]
  v_mfma_f32_16x16x32_bf16 v[160:163], a[240:243], a[80:83], 0
  v_mfma_f32_16x16x32_bf16 v[160:163], a[244:247], a[84:87], v[160:163]
  v_mfma_f32_16x16x32_bf16 v[160:163], a[248:251], a[88:91], v[160:163]
  v_mfma_f32_16x16x32_bf16 v[160:163], a[252:255], a[92:95], v[160:163]
  s_nop 7
  v_max3_f32 v148, v148, v156, v157
  v_max3_f32 v148, v148, v158, v159
  v_max3_f32 v148, v148, v160, v161
  v_max3_f32 v148, v148, v162, v163
  v_mfma_f32_16x16x32_bf16 v[156:159], a[224:227], a[96:99], 0
  v_mfma_f32_16x16x32_bf16 v[156:159], a[228:231], a[100:103], v[156:159]
  v_mfma_f32_16x16x32_bf16 v[156:159], a[232:235], a[104:107], v[156:159]
  v_mfma_f32_16x16x32_bf16 v[156:159], a[236:239], a[108:111], v[156:159]
  v_mfma_f32_16x16x32_bf16 v[160:163], a[240:243], a[96:99], 0
  v_mfma_f32_16x16x32_bf16 v[160:163], a[244:247], a[100:103], v[160:163]
  v_mfma_f32_16x16x32_bf16 v[160:163], a[248:251], a[104:107], v[160:163]
  v_mfma_f32_16x16x32_bf16 v[160:163], a[252:255], a[108:111], v[160:163]
  s_nop 7
  v_max3_f32 v152, v152, v156, v157
  v_max3_f32 v152, v152, v158, v159
  v_max3_f32 v152, v152, v160, v161
  v_max3_f32 v152, v152, v162, v163
  s_sub_u32 s55, s55, 1
  s_cmp_lg_u32 s55, 0
  s_cbranch_scc1 L_slow_loop
  v_mov_b32 v129, v128
  v_mov_b32 v133, v132
  v_mov_b32 v137, v136
  v_mov_b32 v141, v140
  v_mov_b32 v145, v144
  v_mov_b32 v149, v148
  v_mov_b32 v153, v152
  v_permlane32_swap_b32 v128, v129
  v_permlane32_swap_b32 v132, v133
  v_permlane32_swap_b32 v136, v137
  v_permlane32_swap_b32 v140, v141
  v_permlane32_swap_b32 v144, v145
  v_permlane32_swap_b32 v148, v149
  v_permlane32_swap_b32 v152, v153
  v_max_f32 v128, v128, v129
  v_max_f32 v132, v132, v133
  v_max_f32 v136, v136, v137
  v_max_f32 v140, v140, v141
  v_max_f32 v144, v144, v145
  v_max_f32 v148, v148, v149
  v_max_f32 v152, v152, v153
  v_mov_b32 v129, v128
  v_mov_b32 v133, v132
  v_mov_b32 v137, v136
  v_mov_b32 v141, v140
  v_mov_b32 v145, v144
  v_mov_b32 v149, v148
  v_mov_b32 v153, v152
  v_permlane16_swap_b32 v128, v129
  v_permlane16_swap_b32 v132, v133
  v_permlane16_swap_b32 v136, v137
  v_permlane16_swap_b32 v140, v141
  v_permlane16_swap_b32 v144, v145
  v_permlane16_swap_b32 v148, v149
  v_permlane16_swap_b32 v152, v153
  v_max_f32 v128, v128, v129
  v_max_f32 v132, v132, v133
  v_max_f32 v136, v136, v137
  v_max_f32 v140, v140, v141
  v_max_f32 v144, v144, v145
  v_max_f32 v148, v148, v149
  v_max_f32 v152, v152, v153
  v_add_u32 v236, s60, v5
  v_xor_b32 v4, 16384, v236
  ds_write_b32 v236, v128 offset:0
  ds_write_b32 v236, v132 offset:1024
  ds_write_b32 v236, v136 offset:2048
  ds_write_b32 v236, v140 offset:3072
  ds_write_b32 v236, v144 offset:4096
  ds_write_b32 v236, v148 offset:5120
  ds_write_b32 v236, v152 offset:6144
  s_waitcnt lgkmcnt(0)
  s_barrier
  ds_read_b32 v129, v4 offset:0
  ds_read_b32 v133, v4 offset:1024
  ds_read_b32 v137, v4 offset:2048
  ds_read_b32 v141, v4 offset:3072
  ds_read_b32 v145, v4 offset:4096
  ds_read_b32 v149, v4 offset:5120
  ds_read_b32 v153, v4 offset:6144
  s_mov_b32 s63, 0
  s_mov_b32 s62, 8192
  s_add_u32 m0, s57, 4294836224
  s_nop 0
  buffer_load_dwordx4 v6, s[28:31], s63 offen offset:0 nt lds
  buffer_load_dwordx4 v7, s[28:31], s63 offen offset:1024 nt lds
  s_add_u32 m0, s57, 4294901760
  s_nop 0
  buffer_load_dwordx4 v6, s[28:31], s62 offen offset:0 nt lds
  buffer_load_dwordx4 v7, s[28:31], s62 offen offset:1024 nt lds
  s_add_u32 m0, s57, 4294868992
  s_nop 0
  buffer_load_dwordx4 v6, s[84:87], s63 offen offset:0 nt lds
  buffer_load_dwordx4 v7, s[84:87], s63 offen offset:1024 nt lds
  s_add_u32 m0, s57, 4294934528
  s_nop 0
  buffer_load_dwordx4 v8, s[84:87], s62 offen offset:0 nt lds
  buffer_load_dwordx4 v9, s[84:87], s62 offen offset:1024 nt lds
  s_add_u32 s63, s63, 16384
  s_add_u32 s62, s62, 16384
  s_add_u32 m0, s57, 4294844416
  s_nop 0
  buffer_load_dwordx4 v6, s[28:31], s63 offen offset:0 nt lds
  buffer_load_dwordx4 v7, s[28:31], s63 offen offset:1024 nt lds
  s_add_u32 m0, s57, 4294909952
  s_nop 0
  buffer_load_dwordx4 v6, s[28:31], s62 offen offset:0 nt lds
  buffer_load_dwordx4 v7, s[28:31], s62 offen offset:1024 nt lds
  s_add_u32 m0, s57, 4294877184
  s_nop 0
  buffer_load_dwordx4 v6, s[84:87], s63 offen offset:0 nt lds
  buffer_load_dwordx4 v7, s[84:87], s63 offen offset:1024 nt lds
  s_add_u32 m0, s57, 4294942720
  s_nop 0
  buffer_load_dwordx4 v8, s[84:87], s62 offen offset:0 nt lds
  buffer_load_dwordx4 v9, s[84:87], s62 offen offset:1024 nt lds
  s_add_u32 s63, s63, 16384
  s_add_u32 s62, s62, 16384
  s_add_u32 m0, s57, 4294852608
  s_nop 0
  buffer_load_dwordx4 v6, s[28:31], s63 offen offset:0 nt lds
  buffer_load_dwordx4 v7, s[28:31], s63 offen offset:1024 nt lds
  s_add_u32 m0, s57, 4294918144
  s_nop 0
  buffer_load_dwordx4 v6, s[28:31], s62 offen offset:0 nt lds
  buffer_load_dwordx4 v7, s[28:31], s62 offen offset:1024 nt lds
  s_add_u32 m0, s57, 4294885376
  s_nop 0
  buffer_load_dwordx4 v6, s[84:87], s63 offen offset:0 nt lds
  buffer_load_dwordx4 v7, s[84:87], s63 offen offset:1024 nt lds
  s_add_u32 m0, s57, 4294950912
  s_nop 0
  buffer_load_dwordx4 v8, s[84:87], s62 offen offset:0 nt lds
  buffer_load_dwordx4 v9, s[84:87], s62 offen offset:1024 nt lds
  s_add_u32 s63, s63, 16384
  s_add_u32 s62, s62, 16384
  s_add_u32 m0, s57, 4294860800
  s_nop 0
  buffer_load_dwordx4 v6, s[28:31], s63 offen offset:0 nt lds
  buffer_load_dwordx4 v7, s[28:31], s63 offen offset:1024 nt lds
  s_add_u32 m0, s57, 4294926336
  s_nop 0
  buffer_load_dwordx4 v6, s[28:31], s62 offen offset:0 nt lds
  buffer_load_dwordx4 v7, s[28:31], s62 offen offset:1024 nt lds
  s_add_u32 m0, s57, 4294893568
  s_nop 0
  buffer_load_dwordx4 v6, s[84:87], s63 offen offset:0 nt lds
  buffer_load_dwordx4 v7, s[84:87], s63 offen offset:1024 nt lds
  s_add_u32 m0, s57, 4294959104
  s_nop 0
  buffer_load_dwordx4 v8, s[84:87], s62 offen offset:0 nt lds
  buffer_load_dwordx4 v9, s[84:87], s62 offen offset:1024 nt lds
  s_add_u32 s63, s63, 16384
  s_add_u32 s62, s62, 16384
  s_waitcnt lgkmcnt(0)
  v_max_f32 v128, v128, v129
  v_max_f32 v132, v132, v133
  v_max_f32 v136, v136, v137
  v_max_f32 v140, v140, v141
  v_max_f32 v144, v144, v145
  v_max_f32 v148, v148, v149
  v_max_f32 v152, v152, v153
  s_waitcnt vmcnt(16)
  s_barrier
  ds_read_b128 a[224:227], v240 offset:0
  ds_read_b128 a[228:231], v240 offset:256
  ds_read_b128 a[232:235], v240 offset:512
  ds_read_b128 a[236:239], v240 offset:768
  ds_read_b128 a[240:243], v240 offset:4096
  ds_read_b128 a[244:247], v240 offset:4352
  ds_read_b128 a[248:251], v240 offset:4608
  ds_read_b128 a[252:255], v240 offset:4864
  v_mfma_f32_32x32x16_bf16 v[188:203], v[12:15], v[12:15], 0
  v_mfma_f32_32x32x16_bf16 v[204:219], v[12:15], v[12:15], 0
  v_sub_f32 v129, 0, v128
  v_sub_f32 v130, 0, v128
  v_sub_f32 v131, 0, v128
  v_sub_f32 v128, 0, v128
  v_sub_f32 v133, 0, v132
  v_sub_f32 v134, 0, v132
  v_sub_f32 v135, 0, v132
  v_sub_f32 v132, 0, v132
  v_sub_f32 v137, 0, v136
  v_sub_f32 v138, 0, v136
  v_sub_f32 v139, 0, v136
  v_sub_f32 v136, 0, v136
  v_sub_f32 v141, 0, v140
  v_sub_f32 v142, 0, v140
  v_sub_f32 v143, 0, v140
  v_sub_f32 v140, 0, v140
  v_sub_f32 v145, 0, v144
  v_sub_f32 v146, 0, v144
  v_sub_f32 v147, 0, v144
  v_sub_f32 v144, 0, v144
  v_sub_f32 v149, 0, v148
  v_sub_f32 v150, 0, v148
  v_sub_f32 v151, 0, v148
  v_sub_f32 v148, 0, v148
  v_sub_f32 v153, 0, v152
  v_sub_f32 v154, 0, v152
  v_sub_f32 v155, 0, v152
  v_sub_f32 v152, 0, v152
  v_mov_b32 v220, 0
  v_mov_b32 v221, 0
  v_mov_b32 v222, 0
  v_mov_b32 v223, 0
  v_mov_b32 v224, 0
  v_mov_b32 v225, 0
  v_mov_b32 v226, 0
  v_mov_b32 v184, 0
  v_mov_b32 v185, 0
  v_mov_b32 v186, 0
  v_mov_b32 v187, 0
  s_mov_b32 s55, 3
  s_waitcnt lgkmcnt(0)
  v_mfma_f32_16x16x32_bf16 v[156:159], a[224:227], a[0:3], v[128:131]
  v_mfma_f32_16x16x32_bf16 v[156:159], a[228:231], a[4:7], v[156:159]
  v_mfma_f32_16x16x32_bf16 v[156:159], a[232:235], a[8:11], v[156:159]
  v_mfma_f32_16x16x32_bf16 v[156:159], a[236:239], a[12:15], v[156:159]
  v_mfma_f32_16x16x32_bf16 v[160:163], a[240:243], a[0:3], v[128:131]
  v_mfma_f32_16x16x32_bf16 v[160:163], a[244:247], a[4:7], v[160:163]
  v_mfma_f32_16x16x32_bf16 v[160:163], a[248:251], a[8:11], v[160:163]
  v_mfma_f32_16x16x32_bf16 v[160:163], a[252:255], a[12:15], v[160:163]
  s_sub_u32 s10, s57, 0x20000
  s_mov_b32 s11, 5
  v_min_u32 v250, L_go-L_last-4, v0
  v_add_u32 v250, L_last-L_pc, v250
  v_mov_b32 v251, s83
  v_add_co_u32 v250, vcc, s82, v250
  s_nop 1
  v_addc_co_u32 v251, vcc, 0, v251, vcc
  s_nop 5
  v_mfma_f32_16x16x32_bf16 v[164:167], a[224:227], a[16:19], v[132:135]
  v_exp_f32 v172, v156
  v_mfma_f32_16x16x32_bf16 v[164:167], a[228:231], a[20:23], v[164:167]
  v_add_f32 v220, v220, v172
  v_mfma_f32_16x16x32_bf16 v[164:167], a[232:235], a[24:27], v[164:167]
  v_exp_f32 v173, v157
  v_mfma_f32_16x16x32_bf16 v[164:167], a[236:239], a[28:31], v[164:167]
  v_cvt_pk_bf16_f32 v180, v172, v173
  v_add_f32 v220, v220, v173
  v_mfma_f32_16x16x32_bf16 v[168:171], a[240:243], a[16:19], v[132:135]
  v_exp_f32 v174, v158
  v_mfma_f32_16x16x32_bf16 v[168:171], a[244:247], a[20:23], v[168:171]
  v_add_f32 v220, v220, v174
  v_mfma_f32_16x16x32_bf16 v[168:171], a[248:251], a[24:27], v[168:171]
  v_exp_f32 v175, v159
  v_mfma_f32_16x16x32_bf16 v[168:171], a[252:255], a[28:31], v[168:171]
  v_cvt_pk_bf16_f32 v181, v174, v175
  v_add_f32 v220, v220, v175
  v_mfma_f32_16x16x32_bf16 v[112:115], v[188:191], v[184:187], v[112:115]
  v_exp_f32 v176, v160
  v_mfma_f32_16x16x32_bf16 v[116:119], v[192:195], v[184:187], v[116:119]
  ds_read_b64_tr_b16 v[188:189], v241 offset:0
  ds_read_b64_tr_b16 v[190:191], v241 offset:4096
  ds_read_b64_tr_b16 v[192:193], v242 offset:0
  v_mfma_f32_16x16x32_bf16 v[120:123], v[196:199], v[184:187], v[120:123]
  v_exp_f32 v177, v161
  v_mfma_f32_16x16x32_bf16 v[124:127], v[200:203], v[184:187], v[124:127]
  ds_read_b64_tr_b16 v[194:195], v242 offset:4096
  ds_read_b64_tr_b16 v[196:197], v241 offset:256
  v_cvt_pk_bf16_f32 v182, v176, v177
  v_mfma_f32_16x16x32_bf16 a[208:211], v[204:207], v[184:187], a[208:211]
  v_exp_f32 v178, v162
  v_mfma_f32_16x16x32_bf16 a[212:215], v[208:211], v[184:187], a[212:215]
  ds_read_b64_tr_b16 v[198:199], v241 offset:4352
  ds_read_b64_tr_b16 v[200:201], v242 offset:256
  ds_read_b64_tr_b16 v[202:203], v242 offset:4352
  v_mfma_f32_16x16x32_bf16 a[216:219], v[212:215], v[184:187], a[216:219]
  v_exp_f32 v179, v163
  v_mfma_f32_16x16x32_bf16 a[220:223], v[216:219], v[184:187], a[220:223]
  ds_read_b64_tr_b16 v[204:205], v241 offset:512
  ds_read_b64_tr_b16 v[206:207], v241 offset:4608
  v_cvt_pk_bf16_f32 v183, v178, v179
  v_mfma_f32_16x16x32_bf16 v[156:159], a[224:227], a[32:35], v[136:139]
  v_exp_f32 v228, v164
  v_mfma_f32_16x16x32_bf16 v[156:159], a[228:231], a[36:39], v[156:159]
  ds_read_b64_tr_b16 v[208:209], v242 offset:512
  ds_read_b64_tr_b16 v[210:211], v242 offset:4608
  v_mfma_f32_16x16x32_bf16 v[156:159], a[232:235], a[40:43], v[156:159]
  v_exp_f32 v229, v165
  v_mfma_f32_16x16x32_bf16 v[156:159], a[236:239], a[44:47], v[156:159]
  ds_read_b64_tr_b16 v[212:213], v241 offset:768
  ds_read_b64_tr_b16 v[214:215], v241 offset:4864
  v_cvt_pk_bf16_f32 v184, v228, v229
  v_mfma_f32_16x16x32_bf16 v[160:163], a[240:243], a[32:35], v[136:139]
  v_exp_f32 v230, v166
  v_mfma_f32_16x16x32_bf16 v[160:163], a[244:247], a[36:39], v[160:163]
  ds_read_b64_tr_b16 v[216:217], v242 offset:768
  ds_read_b64_tr_b16 v[218:219], v242 offset:4864
  v_mfma_f32_16x16x32_bf16 v[160:163], a[248:251], a[40:43], v[160:163]
  v_exp_f32 v231, v167
  v_mfma_f32_16x16x32_bf16 v[160:163], a[252:255], a[44:47], v[160:163]
  s_waitcnt lgkmcnt(4)
  v_cvt_pk_bf16_f32 v185, v230, v231
  v_mfma_f32_16x16x32_bf16 v[16:19], v[188:191], v[180:183], v[16:19]
  v_exp_f32 v232, v168
  v_mfma_f32_16x16x32_bf16 v[20:23], v[192:195], v[180:183], v[20:23]
  v_add_f32 v220, v220, v176
  v_add_f32 v220, v220, v177
  v_mfma_f32_16x16x32_bf16 v[24:27], v[196:199], v[180:183], v[24:27]
  v_exp_f32 v233, v169
  v_mfma_f32_16x16x32_bf16 v[28:31], v[200:203], v[180:183], v[28:31]
  v_cvt_pk_bf16_f32 v186, v232, v233
  v_add_f32 v220, v220, v178
  v_mfma_f32_16x16x32_bf16 a[112:115], v[204:207], v[180:183], a[112:115]
  v_exp_f32 v234, v170
  v_mfma_f32_16x16x32_bf16 a[116:119], v[208:211], v[180:183], a[116:119]
  s_waitcnt lgkmcnt(0)
  v_add_f32 v220, v220, v179
  v_mfma_f32_16x16x32_bf16 a[120:123], v[212:215], v[180:183], a[120:123]
  v_exp_f32 v235, v171
  v_mfma_f32_16x16x32_bf16 a[124:127], v[216:219], v[180:183], a[124:127]
  v_cvt_pk_bf16_f32 v187, v234, v235
  v_add_f32 v221, v221, v228
  v_mfma_f32_16x16x32_bf16 v[164:167], a[224:227], a[48:51], v[140:143]
  v_exp_f32 v172, v156
  v_mfma_f32_16x16x32_bf16 v[164:167], a[228:231], a[52:55], v[164:167]
  v_add_f32 v221, v221, v229
  v_add_f32 v221, v221, v230
  v_mfma_f32_16x16x32_bf16 v[164:167], a[232:235], a[56:59], v[164:167]
  v_exp_f32 v173, v157
  v_mfma_f32_16x16x32_bf16 v[164:167], a[236:239], a[60:63], v[164:167]
  v_cvt_pk_bf16_f32 v180, v172, v173
  v_add_f32 v221, v221, v231
  v_mfma_f32_16x16x32_bf16 v[168:171], a[240:243], a[48:51], v[140:143]
  v_exp_f32 v174, v158
  v_mfma_f32_16x16x32_bf16 v[168:171], a[244:247], a[52:55], v[168:171]
  v_add_f32 v221, v221, v232
  v_add_f32 v221, v221, v233
  v_mfma_f32_16x16x32_bf16 v[168:171], a[248:251], a[56:59], v[168:171]
  v_exp_f32 v175, v159
  v_mfma_f32_16x16x32_bf16 v[168:171], a[252:255], a[60:63], v[168:171]
  v_cvt_pk_bf16_f32 v181, v174, v175
  v_add_f32 v221, v221, v234
  v_mfma_f32_16x16x32_bf16 v[32:35], v[188:191], v[184:187], v[32:35]
  v_exp_f32 v176, v160
  v_mfma_f32_16x16x32_bf16 v[36:39], v[192:195], v[184:187], v[36:39]
  v_add_f32 v221, v221, v235
  v_add_f32 v222, v222, v172
  v_mfma_f32_16x16x32_bf16 v[40:43], v[196:199], v[184:187], v[40:43]
  v_exp_f32 v177, v161
  v_mfma_f32_16x16x32_bf16 v[44:47], v[200:203], v[184:187], v[44:47]
  v_cvt_pk_bf16_f32 v182, v176, v177
  v_add_f32 v222, v222, v173
  v_mfma_f32_16x16x32_bf16 a[128:131], v[204:207], v[184:187], a[128:131]
  v_exp_f32 v178, v162
  v_mfma_f32_16x16x32_bf16 a[132:135], v[208:211], v[184:187], a[132:135]
  v_add_f32 v222, v222, v174
  v_add_f32 v222, v222, v175
  v_mfma_f32_16x16x32_bf16 a[136:139], v[212:215], v[184:187], a[136:139]
  v_exp_f32 v179, v163
  v_mfma_f32_16x16x32_bf16 a[140:143], v[216:219], v[184:187], a[140:143]
  v_cvt_pk_bf16_f32 v183, v178, v179
  v_add_f32 v222, v222, v176
  v_mfma_f32_16x16x32_bf16 v[156:159], a[224:227], a[64:67], v[144:147]
  v_exp_f32 v228, v164
  v_mfma_f32_16x16x32_bf16 v[156:159], a[228:231], a[68:71], v[156:159]
  v_add_f32 v222, v222, v177
  v_add_f32 v222, v222, v178
  v_mfma_f32_16x16x32_bf16 v[156:159], a[232:235], a[72:75], v[156:159]
  v_exp_f32 v229, v165
  v_mfma_f32_16x16x32_bf16 v[156:159], a[236:239], a[76:79], v[156:159]
  v_cvt_pk_bf16_f32 v184, v228, v229
  v_add_f32 v222, v222, v179
  v_mfma_f32_16x16x32_bf16 v[160:163], a[240:243], a[64:67], v[144:147]
  v_exp_f32 v230, v166
  v_mfma_f32_16x16x32_bf16 v[160:163], a[244:247], a[68:71], v[160:163]
  v_add_f32 v223, v223, v228
  v_add_f32 v223, v223, v229
  v_mfma_f32_16x16x32_bf16 v[160:163], a[248:251], a[72:75], v[160:163]
  v_exp_f32 v231, v167
  v_mfma_f32_16x16x32_bf16 v[160:163], a[252:255], a[76:79], v[160:163]
  v_cvt_pk_bf16_f32 v185, v230, v231
  v_add_f32 v223, v223, v230
  v_mfma_f32_16x16x32_bf16 v[48:51], v[188:191], v[180:183], v[48:51]
  v_exp_f32 v232, v168
  v_mfma_f32_16x16x32_bf16 v[52:55], v[192:195], v[180:183], v[52:55]
  v_add_f32 v223, v223, v231
  v_add_f32 v223, v223, v232
  v_mfma_f32_16x16x32_bf16 v[56:59], v[196:199], v[180:183], v[56:59]
  v_exp_f32 v233, v169
  v_mfma_f32_16x16x32_bf16 v[60:63], v[200:203], v[180:183], v[60:63]
  v_cvt_pk_bf16_f32 v186, v232, v233
  v_add_f32 v223, v223, v233
  v_mfma_f32_16x16x32_bf16 a[144:147], v[204:207], v[180:183], a[144:147]
  v_exp_f32 v234, v170
  v_mfma_f32_16x16x32_bf16 a[148:151], v[208:211], v[180:183], a[148:151]
  v_add_f32 v223, v223, v234
  v_mfma_f32_16x16x32_bf16 a[152:155], v[212:215], v[180:183], a[152:155]
  v_exp_f32 v235, v171
  v_mfma_f32_16x16x32_bf16 a[156:159], v[216:219], v[180:183], a[156:159]
  v_cvt_pk_bf16_f32 v187, v234, v235
  v_add_f32 v223, v223, v235
  v_mfma_f32_16x16x32_bf16 v[164:167], a[224:227], a[80:83], v[148:151]
  v_exp_f32 v172, v156
  v_mfma_f32_16x16x32_bf16 v[164:167], a[228:231], a[84:87], v[164:167]
  v_add_f32 v224, v224, v172
  v_mfma_f32_16x16x32_bf16 v[164:167], a[232:235], a[88:91], v[164:167]
  v_exp_f32 v173, v157
  v_mfma_f32_16x16x32_bf16 v[164:167], a[236:239], a[92:95], v[164:167]
  v_cvt_pk_bf16_f32 v180, v172, v173
  v_add_f32 v224, v224, v173
  v_mfma_f32_16x16x32_bf16 v[168:171], a[240:243], a[80:83], v[148:151]
  v_exp_f32 v174, v158
  v_mfma_f32_16x16x32_bf16 v[168:171], a[244:247], a[84:87], v[168:171]
  v_add_f32 v224, v224, v174
  v_mfma_f32_16x16x32_bf16 v[168:171], a[248:251], a[88:91], v[168:171]
  v_exp_f32 v175, v159
  v_mfma_f32_16x16x32_bf16 v[168:171], a[252:255], a[92:95], v[168:171]
  v_cvt_pk_bf16_f32 v181, v174, v175
  v_add_f32 v224, v224, v175
  v_mfma_f32_16x16x32_bf16 v[64:67], v[188:191], v[184:187], v[64:67]
  v_exp_f32 v176, v160
  v_mfma_f32_16x16x32_bf16 v[68:71], v[192:195], v[184:187], v[68:71]
  v_add_f32 v224, v224, v176
  v_mfma_f32_16x16x32_bf16 v[72:75], v[196:199], v[184:187], v[72:75]
  v_exp_f32 v177, v161
  v_mfma_f32_16x16x32_bf16 v[76:79], v[200:203], v[184:187], v[76:79]
  v_cvt_pk_bf16_f32 v182, v176, v177
  v_add_f32 v224, v224, v177
  v_mfma_f32_16x16x32_bf16 a[160:163], v[204:207], v[184:187], a[160:163]
  v_exp_f32 v178, v162
  v_mfma_f32_16x16x32_bf16 a[164:167], v[208:211], v[184:187], a[164:167]
  s_getreg_b32 s66, hwreg(HW_REG_IB_STS, 0, 4)
  v_add_f32 v224, v224, v178
  v_mfma_f32_16x16x32_bf16 a[168:171], v[212:215], v[184:187], a[168:171]
  v_exp_f32 v179, v163
  v_mfma_f32_16x16x32_bf16 a[172:175], v[216:219], v[184:187], a[172:175]
  s_waitcnt vmcnt(8)
  v_cvt_pk_bf16_f32 v183, v178, v179
  v_add_f32 v224, v224, v179
  s_branch L_loop
.section .rodata,"a"
.p2align 6
.amdhsa_kernel standalone__mha_block_cached__near_ridge_kernel
  .amdhsa_next_free_vgpr 512
  .amdhsa_next_free_sgpr 102
  .amdhsa_accum_offset 256
  .amdhsa_group_segment_fixed_size 0
  .amdhsa_kernarg_size 64
  .amdhsa_user_sgpr_count 2
  .amdhsa_user_sgpr_kernarg_segment_ptr 1
  .amdhsa_system_sgpr_workgroup_id_x 1
  .amdhsa_float_denorm_mode_32 3
.end_amdhsa_kernel
```
